```python
import torch

def _softmax(x, axis=-1):
    return torch.softmax(x, dim=axis)

def _gelu(x):
    return torch.nn.functional.gelu(x, approximate='tanh')

def _silu(x):
    return torch.nn.functional.silu(x)

def _sigmoid(x):
    return torch.sigmoid(x)

def _layernorm(x, axis=-1, eps=1e-05):
    m = x.mean(dim=axis, keepdim=True)
    v = x.var(dim=axis, keepdim=True, unbiased=False)
    return (x - m) / torch.sqrt(v + eps)

def _scatter_add(tgt, idx, src, axis=0):
    return tgt.clone().index_add_(axis, idx, src)

def _segment_sum(src, seg, n):
    out = torch.zeros((n,) + src.shape[1:], dtype=src.dtype)
    return out.index_add_(0, seg, src)

def _pad(x, pw):
    flat = tuple((v for pair in reversed(pw) for v in pair))
    return torch.nn.functional.pad(x, flat)
kernel_name = 'adaLN_cond__mha_block__geglu_ffn__prompt'

def setup_inputs():

    _w = lambda a: (lambda t: t.to(torch.bfloat16) if t.is_floating_point() else t)(torch.as_tensor(a))

    def _A_setup():
        B, S, D, H = (1, 2048, 640, 32)
        return {'x': _w((lambda *s: torch.randn(*s, dtype=torch.bfloat16) * 0.05)(B, S, D)), 'wqkv': _w((lambda *s: torch.randn(*s, dtype=torch.bfloat16) * 0.05)(D, 3 * D)), 'wo': _w((lambda *s: torch.randn(*s, dtype=torch.bfloat16) * 0.05)(D, D))}
    _A_in = _A_setup()

    def _B_setup():
        B, S, D, F = (1, 2048, 640, 1536)
        return {'x': _w((lambda *s: torch.randn(*s, dtype=torch.bfloat16) * 0.05)(B, S, D)), 'w_gate': _w((lambda *s: torch.randn(*s, dtype=torch.bfloat16) * 0.05)(D, F)), 'w_up': _w((lambda *s: torch.randn(*s, dtype=torch.bfloat16) * 0.05)(D, F)), 'w_down': _w((lambda *s: torch.randn(*s, dtype=torch.bfloat16) * 0.05)(F, D))}
    _B_in = _B_setup()
    return {'A_x': _A_in['x'], 'A_wqkv': _A_in['wqkv'], 'A_wo': _A_in['wo'], 'B_x': _B_in['x'], 'B_w_gate': _B_in['w_gate'], 'B_w_up': _B_in['w_up'], 'B_w_down': _B_in['w_down'], 'c': _w((lambda *s: torch.randn(*s, dtype=torch.bfloat16) * 0.1)(1, 640) * 8.0), 'w_mod': _w((lambda *s: torch.randn(*s, dtype=torch.bfloat16) * 0.1)(640, 6 * 640) * 640 ** (-0.5) * 8.0)}

def reference(A_x, A_wqkv, A_wo, B_x, B_w_gate, B_w_up, B_w_down, c, w_mod):

    def _A_ref(x, wqkv, wo):
        B, S, D = x.shape
        H = 32
        Dh = D // H
        qkv = (lambda x, *d: x.permute(*d))((x @ wqkv).reshape(B, S, 3, H, Dh), 2, 0, 3, 1, 4)
        q, k, v = (qkv[0], qkv[1], qkv[2])
        scores = torch.einsum('bhqd,bhkd->bhqk', q, k) * Dh ** (-0.5)
        p = _softmax(scores, axis=-1)
        o = torch.einsum('bhqk,bhkd->bhqd', p, v)
        return (lambda x, *d: x.permute(*d))(o, 0, 2, 1, 3).reshape(B, S, D) @ wo

    def _B_ref(x, w_gate, w_up, w_down):
        return _gelu(x @ w_gate) * (x @ w_up) @ w_down
    x = A_x
    mod = (_silu(c) @ w_mod).reshape(c.shape[0], 6, 1, -1)
    sa, ca, ga, sb, cb, gb = (mod[:, 0].clone(), mod[:, 1].clone(), mod[:, 2].clone(), mod[:, 3].clone(), mod[:, 4].clone(), mod[:, 5].clone())
    h = _layernorm(x, axis=-1) * (1 + ca) + sa
    x = x + ga * _A_ref(h, A_wqkv, A_wo)
    h = _layernorm(x, axis=-1) * (1 + cb) + sb
    x = x + gb * _B_ref(h, B_w_gate, B_w_up, B_w_down)
    return x
```

```asm
; @launch grid=(256,1,1) block=(512,1,1) lds=163840
.amdgcn_target "amdgcn-amd-amdhsa--gfx950"
.text
.globl adaLN_cond__mha_block__geglu_ffn__prompt_kernel
.p2align 8
.type adaLN_cond__mha_block__geglu_ffn__prompt_kernel,@function
adaLN_cond__mha_block__geglu_ffn__prompt_kernel:
  s_cmp_ge_u32 s2, 256
  s_cbranch_scc1 F_END
  s_load_dwordx8 s[64:71], s[0:1], 0
  s_load_dwordx8 s[72:79], s[0:1], 32
  s_load_dwordx8 s[80:87], s[0:1], 64
  v_and_b32 v1, 63, v0
  v_lshrrev_b32 v2, 6, v0
  s_nop 0
  v_readfirstlane_b32 s8, v2
  s_and_b32 s31, s8, 3
  s_and_b32 s13, s2, 3
  s_lshr_b32 s14, s2, 2
  v_lshrrev_b32 v5, 3, v0
  v_and_b32 v6, 7, v0
  s_mul_i32 s15, s13, 160
  v_add_u32 v7, s15, v5
  v_mul_u32_u24 v5, 7680, v7
  v_lshlrev_b32 v6, 4, v6
  s_lshl_b32 s15, s14, 7
  v_add3_u32 v5, v5, v6, s15
  v_lshrrev_b32 v3, 4, v0
  s_lshl_b32 s15, s2, 3
  v_add_u32 v3, s15, v3
  v_mul_u32_u24 v3, 1280, v3
  v_and_b32 v4, 15, v0
  v_lshl_add_u32 v3, v4, 4, v3
  v_lshlrev_b32 v6, 1, v7
  v_mov_b32 v28, 0x7ffffff0
  v_cmp_gt_u32 vcc, 256, v0
  s_nop 1
  v_cndmask_b32 v29, v28, v5, vcc
  v_cndmask_b32 v30, v28, v6, vcc
  s_waitcnt lgkmcnt(0)
  s_mov_b32 s36, s80
  s_mov_b32 s37, s81
  s_mov_b32 s38, 4915200
  s_mov_b32 s39, 0x00020000
  s_mov_b32 s32, s78
  s_mov_b32 s33, s79
  s_mov_b32 s34, 1280
  s_mov_b32 s35, 0x00020000
  s_mov_b32 s16, s64
  s_mov_b32 s17, s65
  s_mov_b32 s18, 2621440
  s_mov_b32 s19, 0x00020000
  s_cmp_ge_u32 s2, 80
  s_cbranch_scc1 P0_LATE
  buffer_load_dwordx4 v[40:43], v5, s[36:39], 0 offen nt
  s_mov_b32 s15, 491520
  buffer_load_dwordx4 v[44:47], v5, s[36:39], s15 offen nt
  s_mov_b32 s15, 983040
  buffer_load_dwordx4 v[48:51], v29, s[36:39], s15 offen nt
  buffer_load_ushort v32, v6, s[32:35], 0 offen
  buffer_load_ushort v33, v6, s[32:35], 0 offen offset:128
  buffer_load_ushort v34, v30, s[32:35], 0 offen offset:256
  s_cmp_ge_u32 s8, 2
  s_cbranch_scc1 P0_NOX1
  buffer_load_dwordx4 v[8:11], v3, s[16:19], 0 offen offset:0 nt
  buffer_load_dwordx4 v[12:15], v3, s[16:19], 0 offen offset:256 nt
  buffer_load_dwordx4 v[16:19], v3, s[16:19], 0 offen offset:512 nt
  buffer_load_dwordx4 v[20:23], v3, s[16:19], 0 offen offset:768 nt
  buffer_load_dwordx4 v[24:27], v3, s[16:19], 0 offen offset:1024 nt
P0_NOX1:
  s_branch P0_ISSUED
P0_LATE:
  s_cmp_ge_u32 s8, 2
  s_cbranch_scc1 P0_NOX2
  buffer_load_dwordx4 v[8:11], v3, s[16:19], 0 offen offset:0 nt
  buffer_load_dwordx4 v[12:15], v3, s[16:19], 0 offen offset:256 nt
  buffer_load_dwordx4 v[16:19], v3, s[16:19], 0 offen offset:512 nt
  buffer_load_dwordx4 v[20:23], v3, s[16:19], 0 offen offset:768 nt
  buffer_load_dwordx4 v[24:27], v3, s[16:19], 0 offen offset:1024 nt
P0_NOX2:
  s_waitcnt vmcnt(0)
  s_barrier
  s_cmp_ge_u32 s14, 60
  s_cbranch_scc1 P0_ISSUED
  buffer_load_dwordx4 v[40:43], v5, s[36:39], 0 offen nt
  s_mov_b32 s15, 491520
  buffer_load_dwordx4 v[44:47], v5, s[36:39], s15 offen nt
  s_mov_b32 s15, 983040
  buffer_load_dwordx4 v[48:51], v29, s[36:39], s15 offen nt
  buffer_load_ushort v32, v6, s[32:35], 0 offen
  buffer_load_ushort v33, v6, s[32:35], 0 offen offset:128
  buffer_load_ushort v34, v30, s[32:35], 0 offen offset:256
P0_ISSUED:
  s_add_u32 s20, s86, 29327360
  s_addc_u32 s21, s87, 0
  s_mov_b32 s22, 61440
  s_mov_b32 s23, 0x00020000
  s_add_u32 s24, s86, 65536
  s_addc_u32 s25, s87, 0
  s_mov_b32 s26, 2621440
  s_mov_b32 s27, 0x00020000
  v_mov_b32 v176, 0x7ffffff0
  v_mov_b32 v177, 0x7ffffff0
  v_mov_b32 v178, 0x7ffffff0
  v_mov_b32 v179, 0x7ffffff0
  v_mov_b32 v180, 0x7ffffff0
  v_mov_b32 v181, 0x7ffffff0
  v_mov_b32 v182, 0x7ffffff0
  v_mov_b32 v183, 0x7ffffff0
  v_mov_b32 v184, 0x7ffffff0
  v_mov_b32 v185, 0x7ffffff0
  v_mov_b32 v186, 0x7ffffff0
  v_mov_b32 v187, 0x7ffffff0
  v_mov_b32 v188, 0x7ffffff0
  v_mov_b32 v189, 0x7ffffff0
  v_mov_b32 v190, 0x7ffffff0
  v_mov_b32 v191, 0x7ffffff0
  v_mov_b32 v192, 0x7ffffff0
  v_mov_b32 v193, 0x7ffffff0
  v_mov_b32 v194, 0x7ffffff0
  v_mov_b32 v195, 0x7ffffff0
  v_mov_b32 v196, 0x7ffffff0
  v_mov_b32 v197, 0x7ffffff0
  v_mov_b32 v198, 0x7ffffff0
  v_mov_b32 v199, 0x7ffffff0
  v_mov_b32 v200, 0x7ffffff0
  v_mov_b32 v201, 0x7ffffff0
  v_mov_b32 v202, 0x7ffffff0
  v_mov_b32 v203, 0x7ffffff0
  v_mov_b32 v204, 0x7ffffff0
  v_mov_b32 v205, 0x7ffffff0
  v_mov_b32 v206, 0x7ffffff0
  v_mov_b32 v207, 0x7ffffff0
  v_mov_b32 v208, 0x7ffffff0
  v_mov_b32 v209, 0x7ffffff0
  v_mov_b32 v210, 0x7ffffff0
  v_mov_b32 v211, 0x7ffffff0
  v_mov_b32 v212, 0x7ffffff0
  v_mov_b32 v213, 0x7ffffff0
  v_mov_b32 v214, 0x7ffffff0
  v_mov_b32 v215, 0x7ffffff0
  v_mov_b32 v216, 0x7ffffff0
  v_mov_b32 v217, 0x7ffffff0
  v_mov_b32 v218, 0x7ffffff0
  v_mov_b32 v219, 0x7ffffff0
  v_mov_b32 v220, 0x7ffffff0
  v_mov_b32 v221, 0x7ffffff0
  v_mov_b32 v222, 0x7ffffff0
  v_mov_b32 v223, 0x7ffffff0
  v_mov_b32 v224, 0x7ffffff0
  v_mov_b32 v225, 0x7ffffff0
  v_mov_b32 v226, 0x7ffffff0
  v_mov_b32 v227, 0x7ffffff0
  s_cmp_lg_u32 s8, 3
  s_cbranch_scc1 P0_NOCTL
  v_lshlrev_b32 v11, 2, v1
  v_add_u32 v11, 163584, v11
  v_mov_b32 v12, 0
  ds_write_b32 v11, v12
P0_NOCTL:
  s_cmp_ge_u32 s8, 4
  s_cbranch_scc1 P0_NOSETUP
P2_SETUP:
  s_and_b32 s3, s2, 7
  s_lshr_b32 s13, s2, 3
  s_and_b32 s14, s3, 3
  s_lshl_b32 s14, s14, 2
  s_and_b32 s15, s13, 3
  s_add_u32 s11, s14, s15
  s_lshr_b32 s14, s3, 2
  s_lshl_b32 s14, s14, 3
  s_lshr_b32 s15, s13, 2
  s_add_u32 s12, s14, s15
  s_cmp_ge_u32 s12, 15
  s_cbranch_scc1 P2_SETUP_END
  v_and_b32 v55, 31, v1
  v_lshrrev_b32 v54, 5, v1
  v_bfe_u32 v52, v55, 1, 3
  v_lshlrev_b32 v55, 7, v55
  s_lshl_b32 s10, s8, 12
  v_add_u32 v55, s10, v55
  v_add_u32 v53, 0, v54
  v_xor_b32 v53, v53, v52
  v_lshl_add_u32 v212, v53, 4, v55
  v_add_u32 v216, 65536, v212
  v_add_u32 v53, 2, v54
  v_xor_b32 v53, v53, v52
  v_lshl_add_u32 v213, v53, 4, v55
  v_add_u32 v217, 65536, v213
  v_add_u32 v53, 4, v54
  v_xor_b32 v53, v53, v52
  v_lshl_add_u32 v214, v53, 4, v55
  v_add_u32 v218, 65536, v214
  v_add_u32 v53, 6, v54
  v_xor_b32 v53, v53, v52
  v_lshl_add_u32 v215, v53, 4, v55
  v_add_u32 v219, 65536, v215
  v_lshrrev_b32 v55, 5, v1
  v_bfe_u32 v54, v1, 2, 2
  v_lshl_add_u32 v55, v55, 3, v54
  v_lshlrev_b32 v55, 8, v55
  v_bfe_u32 v52, v1, 4, 1
  v_lshl_add_u32 v55, v52, 5, v55
  v_and_b32 v52, 3, v1
  v_lshl_add_u32 v55, v52, 3, v55
  v_add_u32 v55, 16384, v55
  v_xor_b32 v52, 0, v54
  v_lshl_add_u32 v220, v52, 6, v55
  v_add_u32 v224, 65536, v220
  v_xor_b32 v52, 1, v54
  v_lshl_add_u32 v221, v52, 6, v55
  v_add_u32 v225, 65536, v221
  v_xor_b32 v52, 2, v54
  v_lshl_add_u32 v222, v52, 6, v55
  v_add_u32 v226, 65536, v222
  v_xor_b32 v52, 3, v54
  v_lshl_add_u32 v223, v52, 6, v55
  v_add_u32 v227, 65536, v223
  s_cmp_ge_u32 s12, 10
  s_cbranch_scc1 P2S_V
  s_cmp_ge_u32 s12, 5
  s_cbranch_scc1 P2S_K
  s_mov_b32 s16, 81920
  s_movk_i32 s17, 1280
  s_lshl_b32 s10, s12, 5
  s_mov_b32 s41, 0x3ea52b5c
  s_branch P2S_QK
P2S_K:
  s_mov_b32 s16, 180224
  s_movk_i32 s17, 2816
  s_sub_u32 s10, s12, 5
  s_lshl_b32 s10, s10, 5
  s_mov_b32 s41, 1.0
P2S_QK:
  s_lshl_b32 s42, s11, 2
  s_add_u32 s42, s42, s8
  s_mul_i32 s42, s42, s17
  s_lshl_b32 s43, s8, 14
  s_add_u32 s43, s43, 65536
  s_branch P2_SETUP_END
P2S_V:
  s_lshl_b32 s42, s11, 2
  s_add_u32 s42, s42, s8
  s_mul_i32 s42, s42, 2816
  s_add_u32 s42, s42, 1280
P2_SETUP_END:
  s_lshr_b32 s14, s2, 2
  s_and_b32 s13, s2, 3
P0_NOSETUP:
  s_cmp_ge_u32 s14, 60
  s_cbranch_scc1 P0_BA
  s_cmp_ge_u32 s2, 80
  s_cbranch_scc1 P0_W0
  s_cmp_ge_u32 s8, 2
  s_cbranch_scc1 P0_W0
  s_waitcnt vmcnt(5)
  s_branch P0_W1
P0_W0:
  s_waitcnt vmcnt(0)
P0_W1:
  s_mov_b32 s15, 0xbfb8aa3b
  v_lshlrev_b32 v32, 16, v32
  v_lshlrev_b32 v33, 16, v33
  v_lshlrev_b32 v34, 16, v34
  v_mul_f32 v72, s15, v32
  v_mul_f32 v73, s15, v33
  v_mul_f32 v74, s15, v34
  v_exp_f32 v72, v72
  v_exp_f32 v73, v73
  v_exp_f32 v74, v74
  v_add_f32 v72, 1.0, v72
  v_add_f32 v73, 1.0, v73
  v_add_f32 v74, 1.0, v74
  v_rcp_f32 v72, v72
  v_rcp_f32 v73, v73
  v_rcp_f32 v74, v74
  v_mul_f32 v32, v32, v72
  v_mul_f32 v33, v33, v73
  v_mul_f32 v34, v34, v74
  v_cvt_pk_bf16_f32 v72, v32, v32
  v_lshlrev_b32 v32, 16, v72
  v_cvt_pk_bf16_f32 v72, v33, v33
  v_lshlrev_b32 v33, 16, v72
  v_cvt_pk_bf16_f32 v72, v34, v34
  v_lshlrev_b32 v34, 16, v72
  v_lshlrev_b32 v72, 16, v40
  v_and_b32 v73, 0xffff0000, v40
  v_mul_f32 v64, v32, v72
  v_mul_f32 v65, v32, v73
  v_lshlrev_b32 v72, 16, v41
  v_and_b32 v73, 0xffff0000, v41
  v_mul_f32 v66, v32, v72
  v_mul_f32 v67, v32, v73
  v_lshlrev_b32 v72, 16, v42
  v_and_b32 v73, 0xffff0000, v42
  v_mul_f32 v68, v32, v72
  v_mul_f32 v69, v32, v73
  v_lshlrev_b32 v72, 16, v43
  v_and_b32 v73, 0xffff0000, v43
  v_mul_f32 v70, v32, v72
  v_mul_f32 v71, v32, v73
  v_lshlrev_b32 v72, 16, v44
  v_and_b32 v73, 0xffff0000, v44
  v_fmac_f32 v64, v33, v72
  v_fmac_f32 v65, v33, v73
  v_lshlrev_b32 v72, 16, v45
  v_and_b32 v73, 0xffff0000, v45
  v_fmac_f32 v66, v33, v72
  v_fmac_f32 v67, v33, v73
  v_lshlrev_b32 v72, 16, v46
  v_and_b32 v73, 0xffff0000, v46
  v_fmac_f32 v68, v33, v72
  v_fmac_f32 v69, v33, v73
  v_lshlrev_b32 v72, 16, v47
  v_and_b32 v73, 0xffff0000, v47
  v_fmac_f32 v70, v33, v72
  v_fmac_f32 v71, v33, v73
  v_lshlrev_b32 v72, 16, v48
  v_and_b32 v73, 0xffff0000, v48
  v_fmac_f32 v64, v34, v72
  v_fmac_f32 v65, v34, v73
  v_lshlrev_b32 v72, 16, v49
  v_and_b32 v73, 0xffff0000, v49
  v_fmac_f32 v66, v34, v72
  v_fmac_f32 v67, v34, v73
  v_lshlrev_b32 v72, 16, v50
  v_and_b32 v73, 0xffff0000, v50
  v_fmac_f32 v68, v34, v72
  v_fmac_f32 v69, v34, v73
  v_lshlrev_b32 v72, 16, v51
  v_and_b32 v73, 0xffff0000, v51
  v_fmac_f32 v70, v34, v72
  v_fmac_f32 v71, v34, v73
  v_add_f32_dpp v64, v64, v64 row_ror:8 row_mask:0xf bank_mask:0xf
  v_add_f32_dpp v65, v65, v65 row_ror:8 row_mask:0xf bank_mask:0xf
  v_add_f32_dpp v66, v66, v66 row_ror:8 row_mask:0xf bank_mask:0xf
  v_add_f32_dpp v67, v67, v67 row_ror:8 row_mask:0xf bank_mask:0xf
  v_add_f32_dpp v68, v68, v68 row_ror:8 row_mask:0xf bank_mask:0xf
  v_add_f32_dpp v69, v69, v69 row_ror:8 row_mask:0xf bank_mask:0xf
  v_add_f32_dpp v70, v70, v70 row_ror:8 row_mask:0xf bank_mask:0xf
  v_add_f32_dpp v71, v71, v71 row_ror:8 row_mask:0xf bank_mask:0xf
  v_mov_b32 v72, v64
  v_mov_b32 v73, v65
  v_mov_b32 v74, v66
  v_mov_b32 v75, v67
  v_mov_b32 v76, v68
  v_mov_b32 v77, v69
  v_mov_b32 v78, v70
  v_mov_b32 v79, v71
  v_permlane16_swap_b32 v64, v72
  v_permlane16_swap_b32 v65, v73
  v_permlane16_swap_b32 v66, v74
  v_permlane16_swap_b32 v67, v75
  v_permlane16_swap_b32 v68, v76
  v_permlane16_swap_b32 v69, v77
  v_permlane16_swap_b32 v70, v78
  v_permlane16_swap_b32 v71, v79
  v_add_f32 v64, v64, v72
  v_add_f32 v65, v65, v73
  v_add_f32 v66, v66, v74
  v_add_f32 v67, v67, v75
  v_add_f32 v68, v68, v76
  v_add_f32 v69, v69, v77
  v_add_f32 v70, v70, v78
  v_add_f32 v71, v71, v79
  v_mov_b32 v72, v64
  v_mov_b32 v73, v65
  v_mov_b32 v74, v66
  v_mov_b32 v75, v67
  v_mov_b32 v76, v68
  v_mov_b32 v77, v69
  v_mov_b32 v78, v70
  v_mov_b32 v79, v71
  v_permlane32_swap_b32 v64, v72
  v_permlane32_swap_b32 v65, v73
  v_permlane32_swap_b32 v66, v74
  v_permlane32_swap_b32 v67, v75
  v_permlane32_swap_b32 v68, v76
  v_permlane32_swap_b32 v69, v77
  v_permlane32_swap_b32 v70, v78
  v_permlane32_swap_b32 v71, v79
  v_add_f32 v64, v64, v72
  v_add_f32 v65, v65, v73
  v_add_f32 v66, v66, v74
  v_add_f32 v67, v67, v75
  v_add_f32 v68, v68, v76
  v_add_f32 v69, v69, v77
  v_add_f32 v70, v70, v78
  v_add_f32 v71, v71, v79
  v_lshrrev_b32 v5, 6, v0
  v_lshlrev_b32 v5, 8, v5
  v_and_b32 v6, 7, v0
  v_lshl_add_u32 v5, v6, 5, v5
  v_add_u32 v5, 131072, v5
  v_cmp_gt_u32 vcc, 8, v1
  s_and_saveexec_b64 s[34:35], vcc
  ds_write_b128 v5, v[64:67]
  ds_write_b128 v5, v[68:71] offset:16
  s_mov_b64 exec, s[34:35]
P0_BA:
  s_waitcnt lgkmcnt(0)
  s_barrier
  s_cmp_lt_u32 s8, 2
  s_cbranch_scc1 P1_LNA
  s_cmp_eq_u32 s8, 2
  s_cbranch_scc1 P0_FINAL
  s_cmp_eq_u32 s8, 3
  s_cbranch_scc1 P0_ONES
  s_branch P0_LOADERS
P0_FINAL:
  s_cmp_ge_u32 s14, 60
  s_cbranch_scc1 P1_BA2
  s_memrealtime s[46:47]
  v_lshlrev_b32 v7, 2, v1
  v_add_u32 v6, 131072, v7
  ds_read_b32 v40, v6 offset:0
  ds_read_b32 v41, v6 offset:256
  ds_read_b32 v42, v6 offset:512
  ds_read_b32 v43, v6 offset:768
  ds_read_b32 v44, v6 offset:1024
  ds_read_b32 v45, v6 offset:1280
  ds_read_b32 v46, v6 offset:1536
  ds_read_b32 v47, v6 offset:1792
  s_waitcnt lgkmcnt(0)
  v_add_f32 v40, v40, v44
  v_add_f32 v41, v41, v45
  v_add_f32 v42, v42, v46
  v_add_f32 v43, v43, v47
  v_add_f32 v40, v40, v42
  v_add_f32 v41, v41, v43
  v_add_f32 v40, v40, v41
  s_mul_i32 s15, s13, 15360
  s_lshl_b32 s34, s14, 8
  s_add_u32 s15, s15, s34
  buffer_store_dword v40, v7, s[20:23], s15 offen sc1
  s_waitcnt vmcnt(0)
  s_cmp_ge_u32 s14, 20
  s_cbranch_scc1 P1_BA2
  s_mov_b64 exec, 1
  v_mov_b32 v5, 0
  v_mov_b32 v6, 1
  global_atomic_add v7, v5, v6, s[84:85] sc0 sc1
  s_waitcnt vmcnt(0)
  v_readfirstlane_b32 s15, v7
  s_cmp_lg_u32 s15, 79
  s_cbranch_scc1 P0_NOFLAG
  s_or_b32 s46, s46, 1
  v_mov_b32 v6, s46
  global_store_dword v5, v6, s[84:85] offset:128 sc1
P0_NOFLAG:
  s_mov_b64 exec, -1
  s_branch P1_BA2
P0_ONES:
  s_add_u32 s32, s86, 5308416
  s_addc_u32 s33, s87, 0
  s_mov_b32 s34, 5767168
  s_mov_b32 s35, 0x00020000
  s_lshl_b32 s13, s2, 5
  v_add_u32 v5, s13, v1
  v_lshrrev_b32 v6, 2, v5
  v_mul_u32_u24 v6, 2816, v6
  v_and_b32 v7, 3, v5
  v_mul_u32_u24 v7, 384, v7
  v_add_u32 v6, 1600, v6
  v_add_u32 v6, v6, v7
  v_mov_b32 v8, 0x3f803f80
  v_mov_b32 v9, 0x3f803f80
  v_mov_b32 v10, 0x3f803f80
  v_mov_b32 v11, 0x3f803f80
  s_mov_b32 exec_hi, 0
  buffer_store_dwordx4 v[8:11], v6, s[32:35], 0 offen sc1
  s_add_u32 s36, s86, 16384
  s_addc_u32 s37, s87, 0
  s_mov_b32 s38, 24576
  s_mov_b32 s39, 0x00020000
  s_mul_i32 s13, s2, 96
  v_lshlrev_b32 v5, 2, v1
  v_mov_b32 v12, 0
  s_mov_b32 exec_lo, 0xffffff
  buffer_store_dword v12, v5, s[36:39], s13 offen sc1
  s_mov_b64 exec, -1
  s_waitcnt vmcnt(0)
  s_branch P1_BA2
P1_LNA:
  s_barrier
P1_LN:
  s_waitcnt vmcnt(0)
  v_lshlrev_b32 v32, 16, v8
  v_and_b32 v33, 0xffff0000, v8
  v_lshlrev_b32 v34, 16, v9
  v_and_b32 v35, 0xffff0000, v9
  v_lshlrev_b32 v36, 16, v10
  v_and_b32 v37, 0xffff0000, v10
  v_lshlrev_b32 v38, 16, v11
  v_and_b32 v39, 0xffff0000, v11
  v_lshlrev_b32 v40, 16, v12
  v_and_b32 v41, 0xffff0000, v12
  v_lshlrev_b32 v42, 16, v13
  v_and_b32 v43, 0xffff0000, v13
  v_lshlrev_b32 v44, 16, v14
  v_and_b32 v45, 0xffff0000, v14
  v_lshlrev_b32 v46, 16, v15
  v_and_b32 v47, 0xffff0000, v15
  v_lshlrev_b32 v48, 16, v16
  v_and_b32 v49, 0xffff0000, v16
  v_lshlrev_b32 v50, 16, v17
  v_and_b32 v51, 0xffff0000, v17
  v_lshlrev_b32 v52, 16, v18
  v_and_b32 v53, 0xffff0000, v18
  v_lshlrev_b32 v54, 16, v19
  v_and_b32 v55, 0xffff0000, v19
  v_lshlrev_b32 v56, 16, v20
  v_and_b32 v57, 0xffff0000, v20
  v_lshlrev_b32 v58, 16, v21
  v_and_b32 v59, 0xffff0000, v21
  v_lshlrev_b32 v60, 16, v22
  v_and_b32 v61, 0xffff0000, v22
  v_lshlrev_b32 v62, 16, v23
  v_and_b32 v63, 0xffff0000, v23
  v_lshlrev_b32 v64, 16, v24
  v_and_b32 v65, 0xffff0000, v24
  v_lshlrev_b32 v66, 16, v25
  v_and_b32 v67, 0xffff0000, v25
  v_lshlrev_b32 v68, 16, v26
  v_and_b32 v69, 0xffff0000, v26
  v_lshlrev_b32 v70, 16, v27
  v_and_b32 v71, 0xffff0000, v27
  v_add_f32 v5, v32, v33
  v_add_f32 v6, v34, v35
  v_add_f32 v5, v5, v36
  v_add_f32 v6, v6, v37
  v_add_f32 v5, v5, v38
  v_add_f32 v6, v6, v39
  v_add_f32 v5, v5, v40
  v_add_f32 v6, v6, v41
  v_add_f32 v5, v5, v42
  v_add_f32 v6, v6, v43
  v_add_f32 v5, v5, v44
  v_add_f32 v6, v6, v45
  v_add_f32 v5, v5, v46
  v_add_f32 v6, v6, v47
  v_add_f32 v5, v5, v48
  v_add_f32 v6, v6, v49
  v_add_f32 v5, v5, v50
  v_add_f32 v6, v6, v51
  v_add_f32 v5, v5, v52
  v_add_f32 v6, v6, v53
  v_add_f32 v5, v5, v54
  v_add_f32 v6, v6, v55
  v_add_f32 v5, v5, v56
  v_add_f32 v6, v6, v57
  v_add_f32 v5, v5, v58
  v_add_f32 v6, v6, v59
  v_add_f32 v5, v5, v60
  v_add_f32 v6, v6, v61
  v_add_f32 v5, v5, v62
  v_add_f32 v6, v6, v63
  v_add_f32 v5, v5, v64
  v_add_f32 v6, v6, v65
  v_add_f32 v5, v5, v66
  v_add_f32 v6, v6, v67
  v_add_f32 v5, v5, v68
  v_add_f32 v6, v6, v69
  v_add_f32 v5, v5, v70
  v_add_f32 v6, v6, v71
  v_add_f32 v5, v5, v6
  s_nop 1
  v_add_f32_dpp v5, v5, v5 row_ror:1 row_mask:0xf bank_mask:0xf
  s_nop 1
  v_add_f32_dpp v5, v5, v5 row_ror:2 row_mask:0xf bank_mask:0xf
  s_nop 1
  v_add_f32_dpp v5, v5, v5 row_ror:4 row_mask:0xf bank_mask:0xf
  s_nop 1
  v_add_f32_dpp v5, v5, v5 row_ror:8 row_mask:0xf bank_mask:0xf
  s_mov_b32 s13, 0x3acccccd
  v_mul_f32 v5, s13, v5
  v_sub_f32 v32, v32, v5
  v_sub_f32 v33, v33, v5
  v_sub_f32 v34, v34, v5
  v_sub_f32 v35, v35, v5
  v_sub_f32 v36, v36, v5
  v_sub_f32 v37, v37, v5
  v_sub_f32 v38, v38, v5
  v_sub_f32 v39, v39, v5
  v_sub_f32 v40, v40, v5
  v_sub_f32 v41, v41, v5
  v_sub_f32 v42, v42, v5
  v_sub_f32 v43, v43, v5
  v_sub_f32 v44, v44, v5
  v_sub_f32 v45, v45, v5
  v_sub_f32 v46, v46, v5
  v_sub_f32 v47, v47, v5
  v_sub_f32 v48, v48, v5
  v_sub_f32 v49, v49, v5
  v_sub_f32 v50, v50, v5
  v_sub_f32 v51, v51, v5
  v_sub_f32 v52, v52, v5
  v_sub_f32 v53, v53, v5
  v_sub_f32 v54, v54, v5
  v_sub_f32 v55, v55, v5
  v_sub_f32 v56, v56, v5
  v_sub_f32 v57, v57, v5
  v_sub_f32 v58, v58, v5
  v_sub_f32 v59, v59, v5
  v_sub_f32 v60, v60, v5
  v_sub_f32 v61, v61, v5
  v_sub_f32 v62, v62, v5
  v_sub_f32 v63, v63, v5
  v_sub_f32 v64, v64, v5
  v_sub_f32 v65, v65, v5
  v_sub_f32 v66, v66, v5
  v_sub_f32 v67, v67, v5
  v_sub_f32 v68, v68, v5
  v_sub_f32 v69, v69, v5
  v_sub_f32 v70, v70, v5
  v_sub_f32 v71, v71, v5
  v_mul_f32 v6, v32, v32
  v_mul_f32 v7, v33, v33
  v_fmac_f32 v6, v34, v34
  v_fmac_f32 v7, v35, v35
  v_fmac_f32 v6, v36, v36
  v_fmac_f32 v7, v37, v37
  v_fmac_f32 v6, v38, v38
  v_fmac_f32 v7, v39, v39
  v_fmac_f32 v6, v40, v40
  v_fmac_f32 v7, v41, v41
  v_fmac_f32 v6, v42, v42
  v_fmac_f32 v7, v43, v43
  v_fmac_f32 v6, v44, v44
  v_fmac_f32 v7, v45, v45
  v_fmac_f32 v6, v46, v46
  v_fmac_f32 v7, v47, v47
  v_fmac_f32 v6, v48, v48
  v_fmac_f32 v7, v49, v49
  v_fmac_f32 v6, v50, v50
  v_fmac_f32 v7, v51, v51
  v_fmac_f32 v6, v52, v52
  v_fmac_f32 v7, v53, v53
  v_fmac_f32 v6, v54, v54
  v_fmac_f32 v7, v55, v55
  v_fmac_f32 v6, v56, v56
  v_fmac_f32 v7, v57, v57
  v_fmac_f32 v6, v58, v58
  v_fmac_f32 v7, v59, v59
  v_fmac_f32 v6, v60, v60
  v_fmac_f32 v7, v61, v61
  v_fmac_f32 v6, v62, v62
  v_fmac_f32 v7, v63, v63
  v_fmac_f32 v6, v64, v64
  v_fmac_f32 v7, v65, v65
  v_fmac_f32 v6, v66, v66
  v_fmac_f32 v7, v67, v67
  v_fmac_f32 v6, v68, v68
  v_fmac_f32 v7, v69, v69
  v_fmac_f32 v6, v70, v70
  v_fmac_f32 v7, v71, v71
  v_add_f32 v6, v6, v7
  s_nop 1
  v_add_f32_dpp v6, v6, v6 row_ror:1 row_mask:0xf bank_mask:0xf
  s_nop 1
  v_add_f32_dpp v6, v6, v6 row_ror:2 row_mask:0xf bank_mask:0xf
  s_nop 1
  v_add_f32_dpp v6, v6, v6 row_ror:4 row_mask:0xf bank_mask:0xf
  s_nop 1
  v_add_f32_dpp v6, v6, v6 row_ror:8 row_mask:0xf bank_mask:0xf
  v_mov_b32 v7, 0x3727c5ac
  v_fmac_f32 v7, s13, v6
  v_rsq_f32 v7, v7
  s_nop 0
  v_mul_f32 v32, v32, v7
  v_mul_f32 v33, v33, v7
  v_mul_f32 v34, v34, v7
  v_mul_f32 v35, v35, v7
  v_mul_f32 v36, v36, v7
  v_mul_f32 v37, v37, v7
  v_mul_f32 v38, v38, v7
  v_mul_f32 v39, v39, v7
  v_mul_f32 v40, v40, v7
  v_mul_f32 v41, v41, v7
  v_mul_f32 v42, v42, v7
  v_mul_f32 v43, v43, v7
  v_mul_f32 v44, v44, v7
  v_mul_f32 v45, v45, v7
  v_mul_f32 v46, v46, v7
  v_mul_f32 v47, v47, v7
  v_mul_f32 v48, v48, v7
  v_mul_f32 v49, v49, v7
  v_mul_f32 v50, v50, v7
  v_mul_f32 v51, v51, v7
  v_mul_f32 v52, v52, v7
  v_mul_f32 v53, v53, v7
  v_mul_f32 v54, v54, v7
  v_mul_f32 v55, v55, v7
  v_mul_f32 v56, v56, v7
  v_mul_f32 v57, v57, v7
  v_mul_f32 v58, v58, v7
  v_mul_f32 v59, v59, v7
  v_mul_f32 v60, v60, v7
  v_mul_f32 v61, v61, v7
  v_mul_f32 v62, v62, v7
  v_mul_f32 v63, v63, v7
  v_mul_f32 v64, v64, v7
  v_mul_f32 v65, v65, v7
  v_mul_f32 v66, v66, v7
  v_mul_f32 v67, v67, v7
  v_mul_f32 v68, v68, v7
  v_mul_f32 v69, v69, v7
  v_mul_f32 v70, v70, v7
  v_mul_f32 v71, v71, v7
  v_mov_b32 v5, 0
  s_mov_b32 s14, 0
P1_POLL:
  s_mov_b64 exec, 1
  global_load_dword v6, v5, s[84:85] offset:128 sc1
  s_waitcnt vmcnt(0)
  v_readfirstlane_b32 s60, v6
  s_mov_b64 exec, -1
  s_cmp_lg_u32 s60, 0
  s_cbranch_scc1 P1_READY
  s_add_u32 s14, s14, 1
  s_cmp_gt_u32 s14, 30000
  s_cbranch_scc1 P1_READY
  s_sleep 1
  s_branch P1_POLL
P1_READY:
  s_mul_i32 s15, s8, 2560
  v_lshlrev_b32 v5, 4, v1
  v_mov_b32 v8, 0x7ffffff0
  v_cmp_gt_u32 vcc, 32, v1
  v_add_u32 v6, s15, v5
  v_add_u32 v9, 2048, v6
  v_cndmask_b32 v9, v8, v9, vcc
  s_mov_b32 s34, 0
  buffer_load_dwordx4 v[80:83], v6, s[20:23], s34 offen sc1
  buffer_load_dwordx4 v[84:87], v6, s[20:23], s34 offen offset:1024 sc1
  buffer_load_dwordx4 v[88:91], v9, s[20:23], s34 offen sc1
  s_mov_b32 s34, 15360
  buffer_load_dwordx4 v[92:95], v6, s[20:23], s34 offen sc1
  buffer_load_dwordx4 v[96:99], v6, s[20:23], s34 offen offset:1024 sc1
  buffer_load_dwordx4 v[100:103], v9, s[20:23], s34 offen sc1
  s_mov_b32 s34, 30720
  buffer_load_dwordx4 v[104:107], v6, s[20:23], s34 offen sc1
  buffer_load_dwordx4 v[108:111], v6, s[20:23], s34 offen offset:1024 sc1
  buffer_load_dwordx4 v[112:115], v9, s[20:23], s34 offen sc1
  s_mov_b32 s34, 46080
  buffer_load_dwordx4 v[116:119], v6, s[20:23], s34 offen sc1
  buffer_load_dwordx4 v[120:123], v6, s[20:23], s34 offen offset:1024 sc1
  buffer_load_dwordx4 v[124:127], v9, s[20:23], s34 offen sc1
  v_mov_b32 v10, 163584
  v_mov_b32 v11, s60
  ds_write_b32 v10, v11
  s_waitcnt vmcnt(0)
  v_add_f32 v80, v80, v92
  v_add_f32 v104, v104, v116
  v_add_f32 v81, v81, v93
  v_add_f32 v105, v105, v117
  v_add_f32 v82, v82, v94
  v_add_f32 v106, v106, v118
  v_add_f32 v83, v83, v95
  v_add_f32 v107, v107, v119
  v_add_f32 v84, v84, v96
  v_add_f32 v108, v108, v120
  v_add_f32 v85, v85, v97
  v_add_f32 v109, v109, v121
  v_add_f32 v86, v86, v98
  v_add_f32 v110, v110, v122
  v_add_f32 v87, v87, v99
  v_add_f32 v111, v111, v123
  v_add_f32 v88, v88, v100
  v_add_f32 v112, v112, v124
  v_add_f32 v89, v89, v101
  v_add_f32 v113, v113, v125
  v_add_f32 v90, v90, v102
  v_add_f32 v114, v114, v126
  v_add_f32 v91, v91, v103
  v_add_f32 v115, v115, v127
  v_add_f32 v80, v80, v104
  v_add_f32 v81, v81, v105
  v_add_f32 v82, v82, v106
  v_add_f32 v83, v83, v107
  v_add_f32 v84, v84, v108
  v_add_f32 v85, v85, v109
  v_add_f32 v86, v86, v110
  v_add_f32 v87, v87, v111
  v_add_f32 v88, v88, v112
  v_add_f32 v89, v89, v113
  v_add_f32 v90, v90, v114
  v_add_f32 v91, v91, v115
  v_cvt_pk_bf16_f32 v92, v80, v80
  v_lshlrev_b32 v80, 16, v92
  v_cvt_pk_bf16_f32 v92, v81, v81
  v_lshlrev_b32 v81, 16, v92
  v_cvt_pk_bf16_f32 v92, v82, v82
  v_lshlrev_b32 v82, 16, v92
  v_cvt_pk_bf16_f32 v92, v83, v83
  v_lshlrev_b32 v83, 16, v92
  v_cvt_pk_bf16_f32 v92, v84, v84
  v_lshlrev_b32 v84, 16, v92
  v_cvt_pk_bf16_f32 v92, v85, v85
  v_lshlrev_b32 v85, 16, v92
  v_cvt_pk_bf16_f32 v92, v86, v86
  v_lshlrev_b32 v86, 16, v92
  v_cvt_pk_bf16_f32 v92, v87, v87
  v_lshlrev_b32 v87, 16, v92
  v_cvt_pk_bf16_f32 v92, v88, v88
  v_lshlrev_b32 v88, 16, v92
  v_cvt_pk_bf16_f32 v92, v89, v89
  v_lshlrev_b32 v89, 16, v92
  v_cvt_pk_bf16_f32 v92, v90, v90
  v_lshlrev_b32 v90, 16, v92
  v_cvt_pk_bf16_f32 v92, v91, v91
  v_lshlrev_b32 v91, 16, v92
  s_cmp_eq_u32 s8, 0
  s_cbranch_scc1 P1_NOONE
  v_add_f32 v80, 1.0, v80
  v_add_f32 v81, 1.0, v81
  v_add_f32 v82, 1.0, v82
  v_add_f32 v83, 1.0, v83
  v_add_f32 v84, 1.0, v84
  v_add_f32 v85, 1.0, v85
  v_add_f32 v86, 1.0, v86
  v_add_f32 v87, 1.0, v87
  v_add_f32 v88, 1.0, v88
  v_add_f32 v89, 1.0, v89
  v_add_f32 v90, 1.0, v90
  v_add_f32 v91, 1.0, v91
  v_cvt_pk_bf16_f32 v92, v80, v80
  v_lshlrev_b32 v80, 16, v92
  v_cvt_pk_bf16_f32 v92, v81, v81
  v_lshlrev_b32 v81, 16, v92
  v_cvt_pk_bf16_f32 v92, v82, v82
  v_lshlrev_b32 v82, 16, v92
  v_cvt_pk_bf16_f32 v92, v83, v83
  v_lshlrev_b32 v83, 16, v92
  v_cvt_pk_bf16_f32 v92, v84, v84
  v_lshlrev_b32 v84, 16, v92
  v_cvt_pk_bf16_f32 v92, v85, v85
  v_lshlrev_b32 v85, 16, v92
  v_cvt_pk_bf16_f32 v92, v86, v86
  v_lshlrev_b32 v86, 16, v92
  v_cvt_pk_bf16_f32 v92, v87, v87
  v_lshlrev_b32 v87, 16, v92
  v_cvt_pk_bf16_f32 v92, v88, v88
  v_lshlrev_b32 v88, 16, v92
  v_cvt_pk_bf16_f32 v92, v89, v89
  v_lshlrev_b32 v89, 16, v92
  v_cvt_pk_bf16_f32 v92, v90, v90
  v_lshlrev_b32 v90, 16, v92
  v_cvt_pk_bf16_f32 v92, v91, v91
  v_lshlrev_b32 v91, 16, v92
P1_NOONE:
  s_mul_i32 s15, s8, 2560
  v_add_u32 v5, s15, v5
  v_add_u32 v5, 139264, v5
  ds_write_b128 v5, v[80:83]
  ds_write_b128 v5, v[84:87] offset:1024
  s_mov_b32 exec_hi, 0
  ds_write_b128 v5, v[88:91] offset:2048
  s_mov_b64 exec, -1
  s_waitcnt lgkmcnt(0)
  s_barrier
  v_and_b32 v4, 15, v0
  v_lshlrev_b32 v4, 5, v4
  v_add_u32 v4, 139264, v4
  ds_read_b128 v[136:139], v4 offset:0
  ds_read_b128 v[96:99], v4 offset:2560
  ds_read_b128 v[140:143], v4 offset:16
  ds_read_b128 v[100:103], v4 offset:2576
  ds_read_b128 v[144:147], v4 offset:512
  ds_read_b128 v[104:107], v4 offset:3072
  ds_read_b128 v[148:151], v4 offset:528
  ds_read_b128 v[108:111], v4 offset:3088
  ds_read_b128 v[152:155], v4 offset:1024
  ds_read_b128 v[112:115], v4 offset:3584
  ds_read_b128 v[156:159], v4 offset:1040
  ds_read_b128 v[116:119], v4 offset:3600
  ds_read_b128 v[160:163], v4 offset:1536
  ds_read_b128 v[120:123], v4 offset:4096
  ds_read_b128 v[164:167], v4 offset:1552
  ds_read_b128 v[124:127], v4 offset:4112
  ds_read_b128 v[168:171], v4 offset:2048
  ds_read_b128 v[128:131], v4 offset:4608
  ds_read_b128 v[172:175], v4 offset:2064
  ds_read_b128 v[132:135], v4 offset:4624
  s_waitcnt lgkmcnt(0)
  v_fma_f32 v32, v32, v96, v136
  v_fma_f32 v33, v33, v97, v137
  v_fma_f32 v34, v34, v98, v138
  v_fma_f32 v35, v35, v99, v139
  v_fma_f32 v36, v36, v100, v140
  v_fma_f32 v37, v37, v101, v141
  v_fma_f32 v38, v38, v102, v142
  v_fma_f32 v39, v39, v103, v143
  v_fma_f32 v40, v40, v104, v144
  v_fma_f32 v41, v41, v105, v145
  v_fma_f32 v42, v42, v106, v146
  v_fma_f32 v43, v43, v107, v147
  v_fma_f32 v44, v44, v108, v148
  v_fma_f32 v45, v45, v109, v149
  v_fma_f32 v46, v46, v110, v150
  v_fma_f32 v47, v47, v111, v151
  v_fma_f32 v48, v48, v112, v152
  v_fma_f32 v49, v49, v113, v153
  v_fma_f32 v50, v50, v114, v154
  v_fma_f32 v51, v51, v115, v155
  v_fma_f32 v52, v52, v116, v156
  v_fma_f32 v53, v53, v117, v157
  v_fma_f32 v54, v54, v118, v158
  v_fma_f32 v55, v55, v119, v159
  v_fma_f32 v56, v56, v120, v160
  v_fma_f32 v57, v57, v121, v161
  v_fma_f32 v58, v58, v122, v162
  v_fma_f32 v59, v59, v123, v163
  v_fma_f32 v60, v60, v124, v164
  v_fma_f32 v61, v61, v125, v165
  v_fma_f32 v62, v62, v126, v166
  v_fma_f32 v63, v63, v127, v167
  v_fma_f32 v64, v64, v128, v168
  v_fma_f32 v65, v65, v129, v169
  v_fma_f32 v66, v66, v130, v170
  v_fma_f32 v67, v67, v131, v171
  v_fma_f32 v68, v68, v132, v172
  v_fma_f32 v69, v69, v133, v173
  v_fma_f32 v70, v70, v134, v174
  v_fma_f32 v71, v71, v135, v175
  v_cvt_pk_bf16_f32 v8, v32, v33
  v_cvt_pk_bf16_f32 v9, v34, v35
  v_cvt_pk_bf16_f32 v10, v36, v37
  v_cvt_pk_bf16_f32 v11, v38, v39
  v_cvt_pk_bf16_f32 v12, v40, v41
  v_cvt_pk_bf16_f32 v13, v42, v43
  v_cvt_pk_bf16_f32 v14, v44, v45
  v_cvt_pk_bf16_f32 v15, v46, v47
  v_cvt_pk_bf16_f32 v16, v48, v49
  v_cvt_pk_bf16_f32 v17, v50, v51
  v_cvt_pk_bf16_f32 v18, v52, v53
  v_cvt_pk_bf16_f32 v19, v54, v55
  v_cvt_pk_bf16_f32 v20, v56, v57
  v_cvt_pk_bf16_f32 v21, v58, v59
  v_cvt_pk_bf16_f32 v22, v60, v61
  v_cvt_pk_bf16_f32 v23, v62, v63
  v_cvt_pk_bf16_f32 v24, v64, v65
  v_cvt_pk_bf16_f32 v25, v66, v67
  v_cvt_pk_bf16_f32 v26, v68, v69
  v_cvt_pk_bf16_f32 v27, v70, v71
  buffer_store_dwordx4 v[8:11], v3, s[24:27], 0 offen offset:0 sc1
  buffer_store_dwordx4 v[12:15], v3, s[24:27], 0 offen offset:256 sc1
  buffer_store_dwordx4 v[16:19], v3, s[24:27], 0 offen offset:512 sc1
  buffer_store_dwordx4 v[20:23], v3, s[24:27], 0 offen offset:768 sc1
  buffer_store_dwordx4 v[24:27], v3, s[24:27], 0 offen offset:1024 sc1
  s_waitcnt vmcnt(0)
  s_barrier
  s_cmp_lg_u32 s8, 0
  s_cbranch_scc1 P2_START
  s_add_u32 s56, s86, 29655040
  s_addc_u32 s57, s87, 0
  s_mov_b32 s58, 229376
  s_mov_b32 s59, 0x00020000
  s_lshl_b32 s9, s2, 7
  s_add_u32 s9, s9, 0
  v_mov_b32 v20, s9
  v_mov_b32 v21, s60
  s_mov_b64 exec, 1
  buffer_store_dword v21, v20, s[56:59], 0 offen sc1
  s_mov_b64 exec, -1
  s_branch P2_START
P1_BA2:
  s_barrier
P1_BB:
  s_barrier
  v_mov_b32 v10, 163584
  ds_read_b32 v11, v10
  s_waitcnt lgkmcnt(0)
  v_readfirstlane_b32 s60, v11
  s_barrier
  s_branch P2_START
P0_LOADERS:
  s_barrier
  s_cmp_lg_u32 s8, 7
  s_cbranch_scc1 F_NOCPF
  s_getpc_b64 s[34:35]
F_PC:
  s_lshr_b32 s9, s2, 3
  s_mul_i32 s9, s9, 18
  v_add_u32 v2, s9, v1
  v_lshlrev_b32 v2, 7, v2
  v_cmp_gt_u32 vcc, 18, v1
  s_mov_b32 s10, F_END-F_PC
  v_cmp_gt_u32 s[36:37], s10, v2
  s_and_b64 vcc, vcc, s[36:37]
  s_and_saveexec_b64 s[36:37], vcc
  s_cbranch_execz F_CPFX
  global_load_dword v231, v2, s[34:35]
F_CPFX:
  s_mov_b64 exec, s[36:37]
F_NOCPF:
  s_cmp_lg_u32 s8, 6
  s_cbranch_scc1 F_NOTLB
  s_mov_b32 s16, s86
  s_mov_b32 s17, s87
  s_mov_b32 s18, 29917184
  s_mov_b32 s19, 0x00020000
  s_mov_b32 s20, s82
  s_mov_b32 s21, s83
  s_mov_b32 s22, 2621440
  s_mov_b32 s23, 0x00020000
  s_lshr_b32 s9, s2, 3
  s_lshl_b32 s9, s9, 4
  v_add_u32 v2, s9, v1
  v_lshlrev_b32 v2, 16, v2
  s_mov_b64 exec, 0xffff
  buffer_load_dword v229, v2, s[16:19], 0 offen
  s_mov_b64 exec, -1
  s_lshr_b32 s9, s2, 3
  v_mov_b32 v2, s9
  v_lshlrev_b32 v2, 17, v2
  s_mov_b64 exec, 1
  buffer_load_dword v228, v2, s[20:23], 0 offen
  s_mov_b64 exec, -1
F_NOTLB:
  s_and_b32 s3, s2, 7
  s_lshr_b32 s13, s2, 3
  s_and_b32 s14, s3, 3
  s_lshl_b32 s14, s14, 2
  s_and_b32 s15, s13, 3
  s_add_u32 s11, s14, s15
  s_lshr_b32 s14, s3, 2
  s_lshl_b32 s14, s14, 3
  s_lshr_b32 s15, s13, 2
  s_add_u32 s12, s14, s15
  s_lshl_b32 s9, s11, 7
  s_lshl_b32 s10, s31, 5
  s_add_u32 s9, s9, s10
  v_lshrrev_b32 v2, 3, v1
  v_lshrrev_b32 v3, 4, v1
  v_and_b32 v4, 7, v1
  v_add_u32 v2, s9, v2
  s_mov_b32 s10, 1280
  v_mul_lo_u32 v2, s10, v2
  v_xor_b32 v5, 0, v3
  v_xor_b32 v5, v5, v4
  v_lshlrev_b32 v5, 4, v5
  v_add_u32 v5, 0, v5
  v_add_u32 v8, v2, v5
  v_xor_b32 v5, 4, v3
  v_xor_b32 v5, v5, v4
  v_lshlrev_b32 v5, 4, v5
  v_add_u32 v5, 9216, v5
  v_add_u32 v9, v2, v5
  v_xor_b32 v5, 0, v3
  v_xor_b32 v5, v5, v4
  v_lshlrev_b32 v5, 4, v5
  v_add_u32 v5, 18432, v5
  v_add_u32 v10, v2, v5
  v_xor_b32 v5, 4, v3
  v_xor_b32 v5, v5, v4
  v_lshlrev_b32 v5, 4, v5
  v_add_u32 v5, 27648, v5
  v_add_u32 v11, v2, v5
  v_lshrrev_b32 v2, 4, v1
  v_bfe_u32 v3, v1, 2, 2
  v_xor_b32 v3, v3, v2
  v_lshlrev_b32 v3, 6, v3
  v_and_b32 v4, 3, v1
  v_lshl_add_u32 v3, v4, 4, v3
  s_lshl_b32 s9, s31, 4
  v_add_u32 v2, s9, v2
  v_mul_u32_u24 v2, 3840, v2
  s_lshl_b32 s9, s12, 8
  v_add3_u32 v2, v2, v3, s9
  v_add_u32 v12, 0, v2
  v_add_u32 v13, 14336, v2
  v_add_u32 v14, 28672, v2
  v_add_u32 v15, 43008, v2
  s_lshl_b32 s13, s31, 12
  s_add_u32 s16, s86, 65536
  s_addc_u32 s17, s87, 0
  s_mov_b32 s18, 2621440
  s_mov_b32 s19, 0x00020000
  s_mov_b32 s20, s66
  s_mov_b32 s21, s67
  s_mov_b32 s22, 2457600
  s_mov_b32 s23, 0x00020000
  s_cmp_ge_u32 s12, 15
  s_cbranch_scc1 P2L_NOTILE
  s_add_u32 m0, s13, 16384
  s_mov_b32 s14, 0
  buffer_load_dwordx4 v12, s[20:23], s14 offen offset:0 lds
  buffer_load_dwordx4 v13, s[20:23], s14 offen offset:1024 lds
  buffer_load_dwordx4 v14, s[20:23], s14 offen offset:2048 lds
  buffer_load_dwordx4 v15, s[20:23], s14 offen offset:3072 lds
  s_add_u32 m0, s13, 49152
  s_mov_b32 s14, 245760
  buffer_load_dwordx4 v12, s[20:23], s14 offen offset:0 lds
  buffer_load_dwordx4 v13, s[20:23], s14 offen offset:1024 lds
  buffer_load_dwordx4 v14, s[20:23], s14 offen offset:2048 lds
  buffer_load_dwordx4 v15, s[20:23], s14 offen offset:3072 lds
  s_add_u32 m0, s13, 81920
  s_mov_b32 s14, 491520
  buffer_load_dwordx4 v12, s[20:23], s14 offen offset:0 lds
  buffer_load_dwordx4 v13, s[20:23], s14 offen offset:1024 lds
  buffer_load_dwordx4 v14, s[20:23], s14 offen offset:2048 lds
  buffer_load_dwordx4 v15, s[20:23], s14 offen offset:3072 lds
  s_and_b32 s9, s11, 3
  s_mul_i32 s9, s9, 224
  s_mul_i32 s10, s31, 56
  s_add_u32 s9, s9, s10
  v_add_u32 v16, s9, v1
  v_lshrrev_b32 v17, 1, v16
  v_add_u32 v17, 192, v17
  v_mul_u32_u24 v17, 3840, v17
  v_and_b32 v16, 1, v16
  v_lshl_add_u32 v17, v16, 7, v17
  s_lshl_b32 s9, s12, 8
  v_add_u32 v17, s9, v17
  v_cmp_gt_u32 vcc, 56, v1
  v_mov_b32 v16, 0x7ffffff0
  s_nop 0
  v_cndmask_b32 v17, v16, v17, vcc
  buffer_load_dword v231, v17, s[20:23], 0 offen
P2L_NOTILE:
  s_cmp_ge_u32 s12, 15
  s_cbranch_scc1 P2T_END
  v_lshlrev_b32 v30, 4, v1
  v_add_u32 v30, 144384, v30
  s_cmp_ge_u32 s12, 10
  s_cbranch_scc1 P2T_V
  s_cmp_ge_u32 s12, 5
  s_cselect_b32 s10, 5, 0
  s_cselect_b32 s44, 180224, 0
  s_cselect_b32 s45, 0, 81920
  s_or_b32 s44, s44, s45
  s_sub_u32 s10, s12, s10
  s_lshl_b32 s10, s10, 5
  s_mul_hi_u32 s35, s10, 858993460
  v_and_b32 v25, 31, v1
  v_lshrrev_b32 v24, 5, v1
  v_add_u32 v24, s10, v24
  v_lshlrev_b32 v26, 4, v25
  v_lshlrev_b32 v27, 3, v25
  v_add_u32 v27, 1024, v27
  s_lshl_b32 s9, s31, 3
  s_add_u32 s9, s9, 0
  v_add_u32 v18, s9, v24
  v_mul_u32_u24 v19, 205, v18
  v_lshrrev_b32 v19, 10, v19
  v_mad_i32_i24 v20, v19, -5, v18
  v_lshrrev_b32 v21, 1, v20
  v_lshl_add_u32 v21, v21, 9, v26
  v_and_b32 v22, 1, v20
  v_lshl_add_u32 v21, v22, 3, v21
  v_cmp_eq_u32 vcc, 4, v20
  v_subrev_u32 v19, s35, v19
  s_nop 0
  v_cndmask_b32 v21, v21, v27, vcc
  v_mul_u32_u24 v19, 1280, v19
  v_add_u32 v32, v21, v19
  s_lshl_b32 s9, s31, 3
  s_add_u32 s9, s9, 2
  v_add_u32 v18, s9, v24
  v_mul_u32_u24 v19, 205, v18
  v_lshrrev_b32 v19, 10, v19
  v_mad_i32_i24 v20, v19, -5, v18
  v_lshrrev_b32 v21, 1, v20
  v_lshl_add_u32 v21, v21, 9, v26
  v_and_b32 v22, 1, v20
  v_lshl_add_u32 v21, v22, 3, v21
  v_cmp_eq_u32 vcc, 4, v20
  v_subrev_u32 v19, s35, v19
  s_nop 0
  v_cndmask_b32 v21, v21, v27, vcc
  v_mul_u32_u24 v19, 1280, v19
  v_add_u32 v33, v21, v19
  s_lshl_b32 s9, s31, 3
  s_add_u32 s9, s9, 4
  v_add_u32 v18, s9, v24
  v_mul_u32_u24 v19, 205, v18
  v_lshrrev_b32 v19, 10, v19
  v_mad_i32_i24 v20, v19, -5, v18
  v_lshrrev_b32 v21, 1, v20
  v_lshl_add_u32 v21, v21, 9, v26
  v_and_b32 v22, 1, v20
  v_lshl_add_u32 v21, v22, 3, v21
  v_cmp_eq_u32 vcc, 4, v20
  v_subrev_u32 v19, s35, v19
  s_nop 0
  v_cndmask_b32 v21, v21, v27, vcc
  v_mul_u32_u24 v19, 1280, v19
  v_add_u32 v34, v21, v19
  s_lshl_b32 s9, s31, 3
  s_add_u32 s9, s9, 6
  v_add_u32 v18, s9, v24
  v_mul_u32_u24 v19, 205, v18
  v_lshrrev_b32 v19, 10, v19
  v_mad_i32_i24 v20, v19, -5, v18
  v_lshrrev_b32 v21, 1, v20
  v_lshl_add_u32 v21, v21, 9, v26
  v_and_b32 v22, 1, v20
  v_lshl_add_u32 v21, v22, 3, v21
  v_cmp_eq_u32 vcc, 4, v20
  v_subrev_u32 v19, s35, v19
  s_nop 0
  v_cndmask_b32 v21, v21, v27, vcc
  v_mul_u32_u24 v19, 1280, v19
  v_add_u32 v35, v21, v19
  s_lshl_b32 s9, s31, 10
  v_add_u32 v31, s9, v30
  ds_write_b128 v31, v[32:35]
  s_mul_i32 s9, s31, 3
  s_add_u32 s9, s9, 0
  s_lshl_b32 s14, s9, 6
  v_add_u32 v18, s14, v1
  v_mul_u32_u24 v19, 52429, v18
  v_lshrrev_b32 v19, 22, v19
  v_mul_u32_u24 v20, 80, v19
  v_sub_u32 v20, v18, v20
  v_lshrrev_b32 v21, 5, v20
  v_lshlrev_b32 v21, 1, v21
  v_add_u32 v19, s35, v19
  v_mad_u32_u24 v22, v19, 5, v21
  v_cmp_gt_u32 vcc, 4, v21
  s_nop 1
  v_addc_co_u32 v23, vcc, 0, v22, vcc
  v_subrev_u32 v22, s10, v22
  v_subrev_u32 v23, s10, v23
  v_max_u32 v22, v22, v23
  v_cmp_gt_u32 vcc, 32, v22
  v_mul_lo_u32 v19, s44, v19
  v_lshl_add_u32 v19, v20, 4, v19
  v_mov_b32 v22, 0x7ffffff0
  v_cndmask_b32 v19, v22, v19, vcc
  s_add_u32 s9, s9, 16
  s_lshr_b32 s14, s9, 2
  s_lshl_b32 s14, s14, 10
  s_and_b32 s9, s9, 3
  s_lshl_b32 s9, s9, 2
  s_add_u32 s9, s9, s14
  v_add_u32 v31, s9, v30
  ds_write_b32 v31, v19
  s_mul_i32 s9, s31, 3
  s_add_u32 s9, s9, 1
  s_lshl_b32 s14, s9, 6
  v_add_u32 v18, s14, v1
  v_mul_u32_u24 v19, 52429, v18
  v_lshrrev_b32 v19, 22, v19
  v_mul_u32_u24 v20, 80, v19
  v_sub_u32 v20, v18, v20
  v_lshrrev_b32 v21, 5, v20
  v_lshlrev_b32 v21, 1, v21
  v_add_u32 v19, s35, v19
  v_mad_u32_u24 v22, v19, 5, v21
  v_cmp_gt_u32 vcc, 4, v21
  s_nop 1
  v_addc_co_u32 v23, vcc, 0, v22, vcc
  v_subrev_u32 v22, s10, v22
  v_subrev_u32 v23, s10, v23
  v_max_u32 v22, v22, v23
  v_cmp_gt_u32 vcc, 32, v22
  v_mul_lo_u32 v19, s44, v19
  v_lshl_add_u32 v19, v20, 4, v19
  v_mov_b32 v22, 0x7ffffff0
  v_cndmask_b32 v19, v22, v19, vcc
  s_add_u32 s9, s9, 16
  s_lshr_b32 s14, s9, 2
  s_lshl_b32 s14, s14, 10
  s_and_b32 s9, s9, 3
  s_lshl_b32 s9, s9, 2
  s_add_u32 s9, s9, s14
  v_add_u32 v31, s9, v30
  ds_write_b32 v31, v19
  s_mul_i32 s9, s31, 3
  s_add_u32 s9, s9, 2
  s_lshl_b32 s14, s9, 6
  v_add_u32 v18, s14, v1
  v_mul_u32_u24 v19, 52429, v18
  v_lshrrev_b32 v19, 22, v19
  v_mul_u32_u24 v20, 80, v19
  v_sub_u32 v20, v18, v20
  v_lshrrev_b32 v21, 5, v20
  v_lshlrev_b32 v21, 1, v21
  v_add_u32 v19, s35, v19
  v_mad_u32_u24 v22, v19, 5, v21
  v_cmp_gt_u32 vcc, 4, v21
  s_nop 1
  v_addc_co_u32 v23, vcc, 0, v22, vcc
  v_subrev_u32 v22, s10, v22
  v_subrev_u32 v23, s10, v23
  v_max_u32 v22, v22, v23
  v_cmp_gt_u32 vcc, 32, v22
  v_mul_lo_u32 v19, s44, v19
  v_lshl_add_u32 v19, v20, 4, v19
  v_mov_b32 v22, 0x7ffffff0
  v_cndmask_b32 v19, v22, v19, vcc
  s_add_u32 s9, s9, 16
  s_lshr_b32 s14, s9, 2
  s_lshl_b32 s14, s14, 10
  s_and_b32 s9, s9, 3
  s_lshl_b32 s9, s9, 2
  s_add_u32 s9, s9, s14
  v_add_u32 v31, s9, v30
  ds_write_b32 v31, v19
  s_cmp_lg_u32 s31, 3
  s_cbranch_scc1 P2T_END
  v_lshrrev_b32 v18, 5, v1
  v_lshlrev_b32 v19, 5, v18
  v_add_u32 v19, s10, v19
  v_add_u32 v19, -1, v19
  v_max_i32 v20, 0, v19
  v_mul_u32_u24 v21, 205, v20
  v_lshrrev_b32 v21, 10, v21
  v_mad_i32_i24 v22, v21, -5, v20
  v_and_b32 v23, 5, v22
  v_cmp_eq_u32 vcc, 0, v23
  v_cmp_le_i32 s[62:63], 0, v19
  s_and_b64 vcc, vcc, s[62:63]
  v_lshrrev_b32 v22, 1, v22
  v_lshlrev_b32 v22, 9, v22
  v_and_b32 v23, 31, v1
  v_lshl_add_u32 v22, v23, 4, v22
  v_xor_b32 v23, 1, v18
  v_lshl_add_u32 v22, v23, 3, v22
  v_subrev_u32 v23, s35, v21
  v_max_i32 v23, 0, v23
  v_mul_u32_u24 v23, 1280, v23
  v_add_u32 v23, v23, v22
  v_mul_lo_u32 v21, s44, v21
  v_add_u32 v21, v21, v22
  v_mov_b32 v22, 0x7ffffff0
  v_cndmask_b32 v21, v22, v21, vcc
  v_add_u32 v31, 6152, v30
  ds_write_b32 v31, v21
  ds_write_b32 v31, v23 offset:4
  s_branch P2T_END
P2T_V:
  v_and_b32 v25, 31, v1
  v_lshrrev_b32 v24, 5, v1
  v_mul_u32_u24 v24, 384, v24
  s_sub_u32 s10, s12, 10
  s_lshl_b32 s10, s10, 7
  s_lshl_b32 s9, s31, 5
  s_add_u32 s10, s10, s9
  v_add_u32 v18, s10, v25
  v_mul_u32_u24 v19, 3277, v18
  v_lshrrev_b32 v19, 16, v19
  v_mul_u32_u24 v20, 20, v19
  v_sub_u32 v20, v18, v20
  s_mov_b32 s10, 180224
  v_mul_lo_u32 v19, s10, v19
  v_lshlrev_b32 v20, 4, v20
  v_add3_u32 v19, v19, v20, v24
  s_lshl_b32 s9, s31, 2
  v_add_u32 v31, s9, v30
  ds_write_b32 v31, v19
P2T_END:
  s_waitcnt lgkmcnt(0)
  s_barrier
  v_mov_b32 v16, 163584
  ds_read_b32 v17, v16
  s_waitcnt lgkmcnt(0)
  v_readfirstlane_b32 s60, v17
  s_barrier
  s_cmp_ge_u32 s12, 15
  s_cbranch_scc1 P2_SPARE
  s_cmp_lg_u32 s8, 4
  s_cbranch_scc1 P2L_GO
  s_add_u32 s56, s86, 29655040
  s_addc_u32 s57, s87, 0
  s_mov_b32 s58, 229376
  s_mov_b32 s59, 0x00020000
  s_lshl_b32 s9, s11, 4
  v_and_b32 v20, 63, v0
  v_add_u32 v20, s9, v20
  v_lshlrev_b32 v20, 7, v20
  s_mov_b32 s14, 0
  s_mov_b64 exec, 0xffff
  s_waitcnt vmcnt(0)
  buffer_load_dword v226, v20, s[56:59], 0 offen sc1
P2L_H_P:
  buffer_load_dword v227, v20, s[56:59], 0 offen sc1
  s_waitcnt vmcnt(1)
  v_cmp_ne_u32 vcc, s60, v226
  s_cmp_eq_u64 vcc, 0
  s_cbranch_scc1 P2L_H_R
  buffer_load_dword v226, v20, s[56:59], 0 offen sc1
  s_waitcnt vmcnt(1)
  v_cmp_ne_u32 vcc, s60, v227
  s_cmp_eq_u64 vcc, 0
  s_cbranch_scc1 P2L_H_R
  s_add_u32 s14, s14, 1
  s_cmp_gt_u32 s14, 30000
  s_cbranch_scc0 P2L_H_P
P2L_H_R:
  s_mov_b64 exec, -1
P2L_GO:
  s_barrier
  s_add_u32 m0, s13, 0
  s_mov_b32 s14, 0
  buffer_load_dwordx4 v8, s[16:19], s14 offen offset:0 sc1 lds
  buffer_load_dwordx4 v9, s[16:19], s14 offen offset:1024 sc1 lds
  buffer_load_dwordx4 v10, s[16:19], s14 offen offset:2048 sc1 lds
  buffer_load_dwordx4 v11, s[16:19], s14 offen offset:3072 sc1 lds
  s_add_u32 m0, s13, 32768
  s_mov_b32 s14, 128
  buffer_load_dwordx4 v8, s[16:19], s14 offen offset:0 sc1 lds
  buffer_load_dwordx4 v9, s[16:19], s14 offen offset:1024 sc1 lds
  buffer_load_dwordx4 v10, s[16:19], s14 offen offset:2048 sc1 lds
  buffer_load_dwordx4 v11, s[16:19], s14 offen offset:3072 sc1 lds
  s_add_u32 m0, s13, 65536
  s_mov_b32 s14, 256
  buffer_load_dwordx4 v8, s[16:19], s14 offen offset:0 sc1 lds
  buffer_load_dwordx4 v9, s[16:19], s14 offen offset:1024 sc1 lds
  buffer_load_dwordx4 v10, s[16:19], s14 offen offset:2048 sc1 lds
  buffer_load_dwordx4 v11, s[16:19], s14 offen offset:3072 sc1 lds
  s_waitcnt vmcnt(8)
  s_barrier
  s_waitcnt vmcnt(4)
  s_barrier
  s_add_u32 m0, s13, 98304
  s_mov_b32 s14, 384
  buffer_load_dwordx4 v8, s[16:19], s14 offen offset:0 sc1 lds
  buffer_load_dwordx4 v9, s[16:19], s14 offen offset:1024 sc1 lds
  buffer_load_dwordx4 v10, s[16:19], s14 offen offset:2048 sc1 lds
  buffer_load_dwordx4 v11, s[16:19], s14 offen offset:3072 sc1 lds
  s_add_u32 m0, s13, 114688
  s_mov_b32 s14, 737280
  buffer_load_dwordx4 v12, s[20:23], s14 offen offset:0 lds
  buffer_load_dwordx4 v13, s[20:23], s14 offen offset:1024 lds
  buffer_load_dwordx4 v14, s[20:23], s14 offen offset:2048 lds
  buffer_load_dwordx4 v15, s[20:23], s14 offen offset:3072 lds
  s_waitcnt vmcnt(8)
  s_barrier
  s_add_u32 m0, s13, 0
  s_mov_b32 s14, 512
  buffer_load_dwordx4 v8, s[16:19], s14 offen offset:0 sc1 lds
  buffer_load_dwordx4 v9, s[16:19], s14 offen offset:1024 sc1 lds
  buffer_load_dwordx4 v10, s[16:19], s14 offen offset:2048 sc1 lds
  buffer_load_dwordx4 v11, s[16:19], s14 offen offset:3072 sc1 lds
  s_add_u32 m0, s13, 16384
  s_mov_b32 s14, 983040
  buffer_load_dwordx4 v12, s[20:23], s14 offen offset:0 lds
  buffer_load_dwordx4 v13, s[20:23], s14 offen offset:1024 lds
  buffer_load_dwordx4 v14, s[20:23], s14 offen offset:2048 lds
  buffer_load_dwordx4 v15, s[20:23], s14 offen offset:3072 lds
  s_waitcnt vmcnt(8)
  s_barrier
  s_add_u32 m0, s13, 32768
  s_mov_b32 s14, 640
  buffer_load_dwordx4 v8, s[16:19], s14 offen offset:0 sc1 lds
  buffer_load_dwordx4 v9, s[16:19], s14 offen offset:1024 sc1 lds
  buffer_load_dwordx4 v10, s[16:19], s14 offen offset:2048 sc1 lds
  buffer_load_dwordx4 v11, s[16:19], s14 offen offset:3072 sc1 lds
  s_add_u32 m0, s13, 49152
  s_mov_b32 s14, 1228800
  buffer_load_dwordx4 v12, s[20:23], s14 offen offset:0 lds
  buffer_load_dwordx4 v13, s[20:23], s14 offen offset:1024 lds
  buffer_load_dwordx4 v14, s[20:23], s14 offen offset:2048 lds
  buffer_load_dwordx4 v15, s[20:23], s14 offen offset:3072 lds
  s_waitcnt vmcnt(8)
  s_barrier
  s_add_u32 m0, s13, 65536
  s_mov_b32 s14, 768
  buffer_load_dwordx4 v8, s[16:19], s14 offen offset:0 sc1 lds
  buffer_load_dwordx4 v9, s[16:19], s14 offen offset:1024 sc1 lds
  buffer_load_dwordx4 v10, s[16:19], s14 offen offset:2048 sc1 lds
  buffer_load_dwordx4 v11, s[16:19], s14 offen offset:3072 sc1 lds
  s_add_u32 m0, s13, 81920
  s_mov_b32 s14, 1474560
  buffer_load_dwordx4 v12, s[20:23], s14 offen offset:0 lds
  buffer_load_dwordx4 v13, s[20:23], s14 offen offset:1024 lds
  buffer_load_dwordx4 v14, s[20:23], s14 offen offset:2048 lds
  buffer_load_dwordx4 v15, s[20:23], s14 offen offset:3072 lds
  s_waitcnt vmcnt(8)
  s_barrier
  s_add_u32 m0, s13, 98304
  s_mov_b32 s14, 896
  buffer_load_dwordx4 v8, s[16:19], s14 offen offset:0 sc1 lds
  buffer_load_dwordx4 v9, s[16:19], s14 offen offset:1024 sc1 lds
  buffer_load_dwordx4 v10, s[16:19], s14 offen offset:2048 sc1 lds
  buffer_load_dwordx4 v11, s[16:19], s14 offen offset:3072 sc1 lds
  s_add_u32 m0, s13, 114688
  s_mov_b32 s14, 1720320
  buffer_load_dwordx4 v12, s[20:23], s14 offen offset:0 lds
  buffer_load_dwordx4 v13, s[20:23], s14 offen offset:1024 lds
  buffer_load_dwordx4 v14, s[20:23], s14 offen offset:2048 lds
  buffer_load_dwordx4 v15, s[20:23], s14 offen offset:3072 lds
  s_waitcnt vmcnt(8)
  s_barrier
  s_add_u32 m0, s13, 0
  s_mov_b32 s14, 1024
  buffer_load_dwordx4 v8, s[16:19], s14 offen offset:0 sc1 lds
  buffer_load_dwordx4 v9, s[16:19], s14 offen offset:1024 sc1 lds
  buffer_load_dwordx4 v10, s[16:19], s14 offen offset:2048 sc1 lds
  buffer_load_dwordx4 v11, s[16:19], s14 offen offset:3072 sc1 lds
  s_add_u32 m0, s13, 16384
  s_mov_b32 s14, 1966080
  buffer_load_dwordx4 v12, s[20:23], s14 offen offset:0 lds
  buffer_load_dwordx4 v13, s[20:23], s14 offen offset:1024 lds
  buffer_load_dwordx4 v14, s[20:23], s14 offen offset:2048 lds
  buffer_load_dwordx4 v15, s[20:23], s14 offen offset:3072 lds
  s_waitcnt vmcnt(8)
  s_barrier
  s_add_u32 m0, s13, 32768
  s_mov_b32 s14, 1152
  buffer_load_dwordx4 v8, s[16:19], s14 offen offset:0 sc1 lds
  buffer_load_dwordx4 v9, s[16:19], s14 offen offset:1024 sc1 lds
  buffer_load_dwordx4 v10, s[16:19], s14 offen offset:2048 sc1 lds
  buffer_load_dwordx4 v11, s[16:19], s14 offen offset:3072 sc1 lds
  s_add_u32 m0, s13, 49152
  s_mov_b32 s14, 2211840
  buffer_load_dwordx4 v12, s[20:23], s14 offen offset:0 lds
  buffer_load_dwordx4 v13, s[20:23], s14 offen offset:1024 lds
  buffer_load_dwordx4 v14, s[20:23], s14 offen offset:2048 lds
  buffer_load_dwordx4 v15, s[20:23], s14 offen offset:3072 lds
  s_waitcnt vmcnt(8)
  s_barrier
  s_waitcnt vmcnt(0)
  s_barrier
  s_barrier
  s_mul_hi_u32 s55, s2, 858993460
  s_mul_i32 s54, s55, 5
  s_sub_u32 s54, s2, s54
  s_lshl_b32 s54, s54, 7
  s_cmp_ge_u32 s55, 24
  s_cselect_b32 s52, 1, 0
  s_mul_i32 s53, s52, 24
  s_sub_u32 s53, s55, s53
  v_and_b32 v191, 255, v0
  v_and_b32 v188, 7, v191
  v_lshrrev_b32 v189, 3, v191
  v_add_u32 v189, s54, v189
  v_mul_u32_u24 v190, 3072, v189
  s_lshl_b32 s55, s53, 7
  v_lshl_add_u32 v190, v188, 4, v190
  v_add_u32 v190, s55, v190
  s_cmp_ge_u32 s2, 240
  s_cselect_b32 s55, 0, 1966080
  s_cmp_eq_u32 s52, 0
  s_cselect_b32 s44, s72, s74
  s_cselect_b32 s45, s73, s75
  s_mov_b32 s46, s55
  s_mov_b32 s47, 0x00020000
  s_mov_b32 s55, 0
  buffer_load_dwordx4 v[136:139], v190, s[44:47], s55 offen nt
  s_mov_b32 s55, 98304
  buffer_load_dwordx4 v[140:143], v190, s[44:47], s55 offen nt
  s_mov_b32 s55, 196608
  buffer_load_dwordx4 v[144:147], v190, s[44:47], s55 offen nt
  s_mov_b32 s55, 294912
  buffer_load_dwordx4 v[148:151], v190, s[44:47], s55 offen nt
  s_lshl_b32 s55, s2, 8
  v_add_u32 v191, s55, v191
  v_lshlrev_b32 v190, 4, v191
  s_mov_b32 s48, s68
  s_mov_b32 s49, s69
  s_mov_b32 s50, 819200
  s_mov_b32 s51, 0x00020000
  buffer_load_dwordx4 v[184:187], v190, s[48:51], 0 offen nt
  s_add_u32 s56, s86, 29655040
  s_addc_u32 s57, s87, 0
  s_mov_b32 s58, 229376
  s_mov_b32 s59, 0x00020000
  v_and_b32 v192, 3, v1
  v_lshlrev_b32 v192, 7, v192
  v_add_u32 v192, 196608, v192
  buffer_load_dword v193, v192, s[56:59], 0 offen sc1
  s_waitcnt vmcnt(0)
  v_cmp_ne_u32 vcc, s60, v193
  s_cmp_eq_u64 vcc, 0
  s_cbranch_scc1 P2LJ_MOK
  s_mov_b32 s14, 0
  s_mov_b64 exec, -1
  s_waitcnt vmcnt(0)
  buffer_load_dword v226, v192, s[56:59], 0 offen sc1
P2LJ_M_P:
  buffer_load_dword v227, v192, s[56:59], 0 offen sc1
  s_waitcnt vmcnt(1)
  v_cmp_ne_u32 vcc, s60, v226
  s_cmp_eq_u64 vcc, 0
  s_cbranch_scc1 P2LJ_M_R
  buffer_load_dword v226, v192, s[56:59], 0 offen sc1
  s_waitcnt vmcnt(1)
  v_cmp_ne_u32 vcc, s60, v227
  s_cmp_eq_u64 vcc, 0
  s_cbranch_scc1 P2LJ_M_R
  s_add_u32 s14, s14, 1
  s_cmp_gt_u32 s14, 30000
  s_cbranch_scc0 P2LJ_M_P
P2LJ_M_R:
  s_mov_b64 exec, -1
P2LJ_MOK:
  s_mov_b32 s48, s86
  s_mov_b32 s49, s87
  s_mov_b32 s50, 15360
  s_mov_b32 s51, 0x00020000
  v_lshlrev_b32 v190, 2, v189
  s_movk_i32 s55, 7680
  buffer_load_dword v152, v190, s[48:51], s55 offen offset:0 sc1
  s_movk_i32 s55, 10240
  buffer_load_dword v153, v190, s[48:51], s55 offen offset:0 sc1
  s_movk_i32 s55, 7680
  buffer_load_dword v154, v190, s[48:51], s55 offen offset:128 sc1
  s_movk_i32 s55, 10240
  buffer_load_dword v155, v190, s[48:51], s55 offen offset:128 sc1
  s_movk_i32 s55, 7680
  buffer_load_dword v156, v190, s[48:51], s55 offen offset:256 sc1
  s_movk_i32 s55, 10240
  buffer_load_dword v157, v190, s[48:51], s55 offen offset:256 sc1
  s_movk_i32 s55, 7680
  buffer_load_dword v158, v190, s[48:51], s55 offen offset:384 sc1
  s_movk_i32 s55, 10240
  buffer_load_dword v159, v190, s[48:51], s55 offen offset:384 sc1
  v_mov_b32 v160, 0
  v_mov_b32 v161, 0
  v_mov_b32 v162, 0
  v_mov_b32 v163, 0
  v_mov_b32 v164, 0
  v_mov_b32 v165, 0
  v_mov_b32 v166, 0
  v_mov_b32 v167, 0
  v_mov_b32 v168, 0
  v_mov_b32 v169, 0
  v_mov_b32 v170, 0
  v_mov_b32 v171, 0
  v_mov_b32 v172, 0
  v_mov_b32 v173, 0
  v_mov_b32 v174, 0
  v_mov_b32 v175, 0
  s_lshl_b32 s55, s53, 3
  v_add_u32 v190, s55, v188
  v_mul_u32_u24 v194, 5462, v190
  v_lshrrev_b32 v194, 16, v194
  v_mul_u32_u24 v195, 12, v194
  v_sub_u32 v195, v190, v195
  s_mov_b32 s55, 245760
  v_mul_lo_u32 v196, s55, v194
  s_mul_i32 s55, s52, 12288
  v_lshl_add_u32 v196, v195, 4, v196
  v_add_u32 v196, s55, v196
  v_add_u32 v190, 0, v189
  v_lshrrev_b32 v197, 6, v190
  v_mul_u32_u24 v190, 192, v190
  v_mul_u32_u24 v197, 12288, v197
  v_add3_u32 v199, v190, v197, v196
  v_add_u32 v190, 32, v189
  v_lshrrev_b32 v197, 6, v190
  v_mul_u32_u24 v190, 192, v190
  v_mul_u32_u24 v197, 12288, v197
  v_add3_u32 v200, v190, v197, v196
  v_add_u32 v190, 64, v189
  v_lshrrev_b32 v197, 6, v190
  v_mul_u32_u24 v190, 192, v190
  v_mul_u32_u24 v197, 12288, v197
  v_add3_u32 v201, v190, v197, v196
  v_add_u32 v190, 96, v189
  v_lshrrev_b32 v197, 6, v190
  v_mul_u32_u24 v190, 192, v190
  v_mul_u32_u24 v197, 12288, v197
  v_add3_u32 v202, v190, v197, v196
  v_mul_u32_u24 v190, 384, v194
  v_lshl_add_u32 v190, v195, 3, v190
  v_lshrrev_b32 v197, 3, v1
  v_add_u32 v190, v190, v197
  s_mul_i32 s55, s52, 96
  v_add_u32 v190, s55, v190
  v_lshlrev_b32 v203, 2, v190
  s_mov_b32 s55, 53687092
  v_mul_hi_u32 v190, s55, v191
  v_mul_u32_u24 v197, 80, v190
  v_sub_u32 v197, v191, v197
  s_mov_b32 s55, 429496730
  v_mul_hi_u32 v198, s55, v197
  v_mul_u32_u24 v194, 10, v198
  v_sub_u32 v197, v197, v194
  v_and_b32 v194, 0xfffffff3, v190
  v_bfe_u32 v195, v190, 2, 1
  v_lshl_or_b32 v194, v195, 3, v194
  v_bfe_u32 v195, v190, 3, 1
  v_lshl_or_b32 v194, v195, 2, v194
  s_mov_b32 s55, 102400
  v_mul_lo_u32 v198, s55, v198
  v_mul_u32_u24 v194, 160, v194
  v_lshlrev_b32 v197, 4, v197
  v_add3_u32 v198, v198, v197, v194
  s_mov_b32 s55, 51200
  v_cmp_gt_u32 vcc, s55, v191
  v_mov_b32 v194, 0x7ffffff0
  s_nop 0
  v_cndmask_b32 v204, v194, v198, vcc
  s_waitcnt vmcnt(0)
  v_lshlrev_b32 v176, 16, v136
  v_and_b32 v177, 0xffff0000, v136
  v_lshlrev_b32 v178, 16, v137
  v_and_b32 v179, 0xffff0000, v137
  v_lshlrev_b32 v180, 16, v138
  v_and_b32 v181, 0xffff0000, v138
  v_lshlrev_b32 v182, 16, v139
  v_and_b32 v183, 0xffff0000, v139
  v_pk_fma_f32 v[168:169], v[176:177], v[152:153], v[168:169] op_sel:[0,0,0] op_sel_hi:[1,0,1]
  v_pk_fma_f32 v[170:171], v[178:179], v[152:153], v[170:171] op_sel:[0,0,0] op_sel_hi:[1,0,1]
  v_pk_fma_f32 v[172:173], v[180:181], v[152:153], v[172:173] op_sel:[0,0,0] op_sel_hi:[1,0,1]
  v_pk_fma_f32 v[174:175], v[182:183], v[152:153], v[174:175] op_sel:[0,0,0] op_sel_hi:[1,0,1]
  v_pk_mul_f32 v[176:177], v[176:177], v[152:153] op_sel:[0,1] op_sel_hi:[1,1]
  v_pk_mul_f32 v[178:179], v[178:179], v[152:153] op_sel:[0,1] op_sel_hi:[1,1]
  v_pk_mul_f32 v[180:181], v[180:181], v[152:153] op_sel:[0,1] op_sel_hi:[1,1]
  v_pk_mul_f32 v[182:183], v[182:183], v[152:153] op_sel:[0,1] op_sel_hi:[1,1]
  v_pk_add_f32 v[160:161], v[160:161], v[176:177]
  v_pk_add_f32 v[162:163], v[162:163], v[178:179]
  v_pk_add_f32 v[164:165], v[164:165], v[180:181]
  v_pk_add_f32 v[166:167], v[166:167], v[182:183]
  v_cvt_pk_bf16_f32 v136, v176, v177
  v_cvt_pk_bf16_f32 v137, v178, v179
  v_cvt_pk_bf16_f32 v138, v180, v181
  v_cvt_pk_bf16_f32 v139, v182, v183
  v_lshlrev_b32 v176, 16, v140
  v_and_b32 v177, 0xffff0000, v140
  v_lshlrev_b32 v178, 16, v141
  v_and_b32 v179, 0xffff0000, v141
  v_lshlrev_b32 v180, 16, v142
  v_and_b32 v181, 0xffff0000, v142
  v_lshlrev_b32 v182, 16, v143
  v_and_b32 v183, 0xffff0000, v143
  v_pk_fma_f32 v[168:169], v[176:177], v[154:155], v[168:169] op_sel:[0,0,0] op_sel_hi:[1,0,1]
  v_pk_fma_f32 v[170:171], v[178:179], v[154:155], v[170:171] op_sel:[0,0,0] op_sel_hi:[1,0,1]
  v_pk_fma_f32 v[172:173], v[180:181], v[154:155], v[172:173] op_sel:[0,0,0] op_sel_hi:[1,0,1]
  v_pk_fma_f32 v[174:175], v[182:183], v[154:155], v[174:175] op_sel:[0,0,0] op_sel_hi:[1,0,1]
  v_pk_mul_f32 v[176:177], v[176:177], v[154:155] op_sel:[0,1] op_sel_hi:[1,1]
  v_pk_mul_f32 v[178:179], v[178:179], v[154:155] op_sel:[0,1] op_sel_hi:[1,1]
  v_pk_mul_f32 v[180:181], v[180:181], v[154:155] op_sel:[0,1] op_sel_hi:[1,1]
  v_pk_mul_f32 v[182:183], v[182:183], v[154:155] op_sel:[0,1] op_sel_hi:[1,1]
  v_pk_add_f32 v[160:161], v[160:161], v[176:177]
  v_pk_add_f32 v[162:163], v[162:163], v[178:179]
  v_pk_add_f32 v[164:165], v[164:165], v[180:181]
  v_pk_add_f32 v[166:167], v[166:167], v[182:183]
  v_cvt_pk_bf16_f32 v140, v176, v177
  v_cvt_pk_bf16_f32 v141, v178, v179
  v_cvt_pk_bf16_f32 v142, v180, v181
  v_cvt_pk_bf16_f32 v143, v182, v183
  v_lshlrev_b32 v176, 16, v144
  v_and_b32 v177, 0xffff0000, v144
  v_lshlrev_b32 v178, 16, v145
  v_and_b32 v179, 0xffff0000, v145
  v_lshlrev_b32 v180, 16, v146
  v_and_b32 v181, 0xffff0000, v146
  v_lshlrev_b32 v182, 16, v147
  v_and_b32 v183, 0xffff0000, v147
  v_pk_fma_f32 v[168:169], v[176:177], v[156:157], v[168:169] op_sel:[0,0,0] op_sel_hi:[1,0,1]
  v_pk_fma_f32 v[170:171], v[178:179], v[156:157], v[170:171] op_sel:[0,0,0] op_sel_hi:[1,0,1]
  v_pk_fma_f32 v[172:173], v[180:181], v[156:157], v[172:173] op_sel:[0,0,0] op_sel_hi:[1,0,1]
  v_pk_fma_f32 v[174:175], v[182:183], v[156:157], v[174:175] op_sel:[0,0,0] op_sel_hi:[1,0,1]
  v_pk_mul_f32 v[176:177], v[176:177], v[156:157] op_sel:[0,1] op_sel_hi:[1,1]
  v_pk_mul_f32 v[178:179], v[178:179], v[156:157] op_sel:[0,1] op_sel_hi:[1,1]
  v_pk_mul_f32 v[180:181], v[180:181], v[156:157] op_sel:[0,1] op_sel_hi:[1,1]
  v_pk_mul_f32 v[182:183], v[182:183], v[156:157] op_sel:[0,1] op_sel_hi:[1,1]
  v_pk_add_f32 v[160:161], v[160:161], v[176:177]
  v_pk_add_f32 v[162:163], v[162:163], v[178:179]
  v_pk_add_f32 v[164:165], v[164:165], v[180:181]
  v_pk_add_f32 v[166:167], v[166:167], v[182:183]
  v_cvt_pk_bf16_f32 v144, v176, v177
  v_cvt_pk_bf16_f32 v145, v178, v179
  v_cvt_pk_bf16_f32 v146, v180, v181
  v_cvt_pk_bf16_f32 v147, v182, v183
  v_lshlrev_b32 v176, 16, v148
  v_and_b32 v177, 0xffff0000, v148
  v_lshlrev_b32 v178, 16, v149
  v_and_b32 v179, 0xffff0000, v149
  v_lshlrev_b32 v180, 16, v150
  v_and_b32 v181, 0xffff0000, v150
  v_lshlrev_b32 v182, 16, v151
  v_and_b32 v183, 0xffff0000, v151
  v_pk_fma_f32 v[168:169], v[176:177], v[158:159], v[168:169] op_sel:[0,0,0] op_sel_hi:[1,0,1]
  v_pk_fma_f32 v[170:171], v[178:179], v[158:159], v[170:171] op_sel:[0,0,0] op_sel_hi:[1,0,1]
  v_pk_fma_f32 v[172:173], v[180:181], v[158:159], v[172:173] op_sel:[0,0,0] op_sel_hi:[1,0,1]
  v_pk_fma_f32 v[174:175], v[182:183], v[158:159], v[174:175] op_sel:[0,0,0] op_sel_hi:[1,0,1]
  v_pk_mul_f32 v[176:177], v[176:177], v[158:159] op_sel:[0,1] op_sel_hi:[1,1]
  v_pk_mul_f32 v[178:179], v[178:179], v[158:159] op_sel:[0,1] op_sel_hi:[1,1]
  v_pk_mul_f32 v[180:181], v[180:181], v[158:159] op_sel:[0,1] op_sel_hi:[1,1]
  v_pk_mul_f32 v[182:183], v[182:183], v[158:159] op_sel:[0,1] op_sel_hi:[1,1]
  v_pk_add_f32 v[160:161], v[160:161], v[176:177]
  v_pk_add_f32 v[162:163], v[162:163], v[178:179]
  v_pk_add_f32 v[164:165], v[164:165], v[180:181]
  v_pk_add_f32 v[166:167], v[166:167], v[182:183]
  v_cvt_pk_bf16_f32 v148, v176, v177
  v_cvt_pk_bf16_f32 v149, v178, v179
  v_cvt_pk_bf16_f32 v150, v180, v181
  v_cvt_pk_bf16_f32 v151, v182, v183
  v_and_b32 v190, 8, v1
  v_cmp_ne_u32 vcc, 0, v190
  v_permlane32_swap_b32 v160, v164
  v_add_f32 v160, v160, v164
  v_permlane32_swap_b32 v161, v165
  v_add_f32 v161, v161, v165
  v_permlane32_swap_b32 v162, v166
  v_add_f32 v162, v162, v166
  v_permlane32_swap_b32 v163, v167
  v_add_f32 v163, v163, v167
  v_permlane16_swap_b32 v160, v162
  v_add_f32 v160, v160, v162
  v_permlane16_swap_b32 v161, v163
  v_add_f32 v161, v161, v163
  v_add_f32_dpp v160, v160, v160 row_ror:8 row_mask:0xf bank_mask:0xf
  s_nop 0
  v_add_f32_dpp v161, v161, v161 row_ror:8 row_mask:0xf bank_mask:0xf
  v_cndmask_b32 v160, v160, v161, vcc
  v_permlane32_swap_b32 v168, v172
  v_add_f32 v168, v168, v172
  v_permlane32_swap_b32 v169, v173
  v_add_f32 v169, v169, v173
  v_permlane32_swap_b32 v170, v174
  v_add_f32 v170, v170, v174
  v_permlane32_swap_b32 v171, v175
  v_add_f32 v171, v171, v175
  v_permlane16_swap_b32 v168, v170
  v_add_f32 v168, v168, v170
  v_permlane16_swap_b32 v169, v171
  v_add_f32 v169, v169, v171
  v_add_f32_dpp v168, v168, v168 row_ror:8 row_mask:0xf bank_mask:0xf
  s_nop 0
  v_add_f32_dpp v169, v169, v169 row_ror:8 row_mask:0xf bank_mask:0xf
  v_cndmask_b32 v168, v168, v169, vcc
  s_branch P3_START
P2_SPARE:
  s_cmp_lg_u32 s8, 4
  s_cbranch_scc1 P2S_FLAG
  s_cmp_ge_u32 s11, 4
  s_cbranch_scc1 P2S_FLAG
  s_add_u32 s56, s86, 29655040
  s_addc_u32 s57, s87, 0
  s_mov_b32 s58, 229376
  s_mov_b32 s59, 0x00020000
  v_and_b32 v20, 63, v0
  v_lshlrev_b32 v20, 7, v20
  v_add_u32 v20, 0, v20
  v_add_u32 v21, 8192, v20
  v_add_u32 v22, 16384, v20
  v_add_u32 v23, 24576, v20
  s_mov_b32 s14, 0
P2S_ALLH_P:
  buffer_load_dword v24, v20, s[56:59], 0 offen sc1
  buffer_load_dword v25, v21, s[56:59], 0 offen sc1
  buffer_load_dword v26, v22, s[56:59], 0 offen sc1
  buffer_load_dword v27, v23, s[56:59], 0 offen sc1
  s_waitcnt vmcnt(0)
  v_cmp_ne_u32 vcc, s60, v24
  v_cmp_ne_u32 s[62:63], s60, v25
  s_or_b64 vcc, vcc, s[62:63]
  v_cmp_ne_u32 s[62:63], s60, v26
  s_or_b64 vcc, vcc, s[62:63]
  v_cmp_ne_u32 s[62:63], s60, v27
  s_or_b64 vcc, vcc, s[62:63]
  s_cmp_eq_u64 vcc, 0
  s_cbranch_scc1 P2S_ALLH_R
  s_add_u32 s14, s14, 1
  s_cmp_gt_u32 s14, 30000
  s_cbranch_scc1 P2S_ALLH_R
  s_sleep 2
  s_branch P2S_ALLH_P
P2S_ALLH_R:
  s_add_u32 s9, s11, 2
  s_mul_i32 s9, s9, 2560
  s_add_u32 s16, s86, 29327360
  s_addc_u32 s17, s87, 0
  s_mov_b32 s18, 61440
  s_mov_b32 s19, 0x00020000
  s_mov_b32 s20, s86
  s_mov_b32 s21, s87
  s_mov_b32 s22, 15360
  s_mov_b32 s23, 0x00020000
  v_add_u32 v2, 0, v1
  v_lshlrev_b32 v3, 4, v2
  s_add_u32 s10, s9, 0
  buffer_load_dwordx4 v[8:11], v3, s[16:19], s10 offen sc1
  s_add_u32 s10, s9, 15360
  buffer_load_dwordx4 v[12:15], v3, s[16:19], s10 offen sc1
  s_add_u32 s10, s9, 30720
  buffer_load_dwordx4 v[16:19], v3, s[16:19], s10 offen sc1
  s_add_u32 s10, s9, 46080
  buffer_load_dwordx4 v[20:23], v3, s[16:19], s10 offen sc1
  v_add_u32 v2, 64, v1
  v_lshlrev_b32 v4, 4, v2
  s_add_u32 s10, s9, 0
  buffer_load_dwordx4 v[24:27], v4, s[16:19], s10 offen sc1
  s_add_u32 s10, s9, 15360
  buffer_load_dwordx4 v[28:31], v4, s[16:19], s10 offen sc1
  s_add_u32 s10, s9, 30720
  buffer_load_dwordx4 v[32:35], v4, s[16:19], s10 offen sc1
  s_add_u32 s10, s9, 46080
  buffer_load_dwordx4 v[36:39], v4, s[16:19], s10 offen sc1
  v_add_u32 v2, 128, v1
  v_lshlrev_b32 v5, 4, v2
  v_cmp_gt_u32 vcc, 160, v2
  v_mov_b32 v6, 0x7ffffff0
  s_nop 0
  v_cndmask_b32 v5, v6, v5, vcc
  s_add_u32 s10, s9, 0
  buffer_load_dwordx4 v[40:43], v5, s[16:19], s10 offen sc1
  s_add_u32 s10, s9, 15360
  buffer_load_dwordx4 v[44:47], v5, s[16:19], s10 offen sc1
  s_add_u32 s10, s9, 30720
  buffer_load_dwordx4 v[48:51], v5, s[16:19], s10 offen sc1
  s_add_u32 s10, s9, 46080
  buffer_load_dwordx4 v[52:55], v5, s[16:19], s10 offen sc1
  s_waitcnt vmcnt(0)
  v_add_f32 v8, v8, v12
  v_add_f32 v16, v16, v20
  v_add_f32 v9, v9, v13
  v_add_f32 v17, v17, v21
  v_add_f32 v10, v10, v14
  v_add_f32 v18, v18, v22
  v_add_f32 v11, v11, v15
  v_add_f32 v19, v19, v23
  v_add_f32 v8, v8, v16
  v_add_f32 v9, v9, v17
  v_add_f32 v10, v10, v18
  v_add_f32 v11, v11, v19
  v_cvt_pk_bf16_f32 v60, v8, v8
  v_lshlrev_b32 v8, 16, v60
  v_cvt_pk_bf16_f32 v60, v9, v9
  v_lshlrev_b32 v9, 16, v60
  v_cvt_pk_bf16_f32 v60, v10, v10
  v_lshlrev_b32 v10, 16, v60
  v_cvt_pk_bf16_f32 v60, v11, v11
  v_lshlrev_b32 v11, 16, v60
  v_add_f32 v24, v24, v28
  v_add_f32 v32, v32, v36
  v_add_f32 v25, v25, v29
  v_add_f32 v33, v33, v37
  v_add_f32 v26, v26, v30
  v_add_f32 v34, v34, v38
  v_add_f32 v27, v27, v31
  v_add_f32 v35, v35, v39
  v_add_f32 v24, v24, v32
  v_add_f32 v25, v25, v33
  v_add_f32 v26, v26, v34
  v_add_f32 v27, v27, v35
  v_cvt_pk_bf16_f32 v60, v24, v24
  v_lshlrev_b32 v24, 16, v60
  v_cvt_pk_bf16_f32 v60, v25, v25
  v_lshlrev_b32 v25, 16, v60
  v_cvt_pk_bf16_f32 v60, v26, v26
  v_lshlrev_b32 v26, 16, v60
  v_cvt_pk_bf16_f32 v60, v27, v27
  v_lshlrev_b32 v27, 16, v60
  v_add_f32 v40, v40, v44
  v_add_f32 v48, v48, v52
  v_add_f32 v41, v41, v45
  v_add_f32 v49, v49, v53
  v_add_f32 v42, v42, v46
  v_add_f32 v50, v50, v54
  v_add_f32 v43, v43, v47
  v_add_f32 v51, v51, v55
  v_add_f32 v40, v40, v48
  v_add_f32 v41, v41, v49
  v_add_f32 v42, v42, v50
  v_add_f32 v43, v43, v51
  v_cvt_pk_bf16_f32 v60, v40, v40
  v_lshlrev_b32 v40, 16, v60
  v_cvt_pk_bf16_f32 v60, v41, v41
  v_lshlrev_b32 v41, 16, v60
  v_cvt_pk_bf16_f32 v60, v42, v42
  v_lshlrev_b32 v42, 16, v60
  v_cvt_pk_bf16_f32 v60, v43, v43
  v_lshlrev_b32 v43, 16, v60
  s_cmp_lg_u32 s11, 2
  s_cbranch_scc1 P2S_NOONE
  v_add_f32 v8, 1.0, v8
  v_add_f32 v9, 1.0, v9
  v_add_f32 v10, 1.0, v10
  v_add_f32 v11, 1.0, v11
  v_cvt_pk_bf16_f32 v60, v8, v8
  v_lshlrev_b32 v8, 16, v60
  v_cvt_pk_bf16_f32 v60, v9, v9
  v_lshlrev_b32 v9, 16, v60
  v_cvt_pk_bf16_f32 v60, v10, v10
  v_lshlrev_b32 v10, 16, v60
  v_cvt_pk_bf16_f32 v60, v11, v11
  v_lshlrev_b32 v11, 16, v60
  v_add_f32 v24, 1.0, v24
  v_add_f32 v25, 1.0, v25
  v_add_f32 v26, 1.0, v26
  v_add_f32 v27, 1.0, v27
  v_cvt_pk_bf16_f32 v60, v24, v24
  v_lshlrev_b32 v24, 16, v60
  v_cvt_pk_bf16_f32 v60, v25, v25
  v_lshlrev_b32 v25, 16, v60
  v_cvt_pk_bf16_f32 v60, v26, v26
  v_lshlrev_b32 v26, 16, v60
  v_cvt_pk_bf16_f32 v60, v27, v27
  v_lshlrev_b32 v27, 16, v60
  v_add_f32 v40, 1.0, v40
  v_add_f32 v41, 1.0, v41
  v_add_f32 v42, 1.0, v42
  v_add_f32 v43, 1.0, v43
  v_cvt_pk_bf16_f32 v60, v40, v40
  v_lshlrev_b32 v40, 16, v60
  v_cvt_pk_bf16_f32 v60, v41, v41
  v_lshlrev_b32 v41, 16, v60
  v_cvt_pk_bf16_f32 v60, v42, v42
  v_lshlrev_b32 v42, 16, v60
  v_cvt_pk_bf16_f32 v60, v43, v43
  v_lshlrev_b32 v43, 16, v60
P2S_NOONE:
  buffer_store_dwordx4 v[8:11], v3, s[20:23], s9 offen sc1
  buffer_store_dwordx4 v[24:27], v4, s[20:23], s9 offen sc1
  buffer_store_dwordx4 v[40:43], v5, s[20:23], s9 offen sc1
  s_waitcnt vmcnt(0)
  s_add_u32 s56, s86, 29655040
  s_addc_u32 s57, s87, 0
  s_mov_b32 s58, 229376
  s_mov_b32 s59, 0x00020000
  s_lshl_b32 s9, s11, 7
  s_add_u32 s9, s9, 196608
  v_mov_b32 v20, s9
  v_mov_b32 v21, s60
  s_mov_b64 exec, 1
  buffer_store_dword v21, v20, s[56:59], 0 offen sc1
  s_mov_b64 exec, -1
P2S_FLAG:
  s_mul_hi_u32 s55, s2, 858993460
  s_mul_i32 s54, s55, 5
  s_sub_u32 s54, s2, s54
  s_lshl_b32 s54, s54, 7
  s_cmp_ge_u32 s55, 24
  s_cselect_b32 s52, 1, 0
  s_mul_i32 s53, s52, 24
  s_sub_u32 s53, s55, s53
  v_and_b32 v191, 255, v0
  v_and_b32 v188, 7, v191
  v_lshrrev_b32 v189, 3, v191
  v_add_u32 v189, s54, v189
  v_mul_u32_u24 v190, 3072, v189
  s_lshl_b32 s55, s53, 7
  v_lshl_add_u32 v190, v188, 4, v190
  v_add_u32 v190, s55, v190
  s_cmp_ge_u32 s2, 240
  s_cselect_b32 s55, 0, 1966080
  s_cmp_eq_u32 s52, 0
  s_cselect_b32 s44, s72, s74
  s_cselect_b32 s45, s73, s75
  s_mov_b32 s46, s55
  s_mov_b32 s47, 0x00020000
  s_mov_b32 s55, 0
  buffer_load_dwordx4 v[136:139], v190, s[44:47], s55 offen nt
  s_mov_b32 s55, 98304
  buffer_load_dwordx4 v[140:143], v190, s[44:47], s55 offen nt
  s_mov_b32 s55, 196608
  buffer_load_dwordx4 v[144:147], v190, s[44:47], s55 offen nt
  s_mov_b32 s55, 294912
  buffer_load_dwordx4 v[148:151], v190, s[44:47], s55 offen nt
  s_lshl_b32 s55, s2, 8
  v_add_u32 v191, s55, v191
  v_lshlrev_b32 v190, 4, v191
  s_mov_b32 s48, s68
  s_mov_b32 s49, s69
  s_mov_b32 s50, 819200
  s_mov_b32 s51, 0x00020000
  buffer_load_dwordx4 v[184:187], v190, s[48:51], 0 offen nt
  s_add_u32 s56, s86, 29655040
  s_addc_u32 s57, s87, 0
  s_mov_b32 s58, 229376
  s_mov_b32 s59, 0x00020000
  v_and_b32 v192, 3, v1
  v_lshlrev_b32 v192, 7, v192
  v_add_u32 v192, 196608, v192
  buffer_load_dword v193, v192, s[56:59], 0 offen sc1
  s_waitcnt vmcnt(0)
  v_cmp_ne_u32 vcc, s60, v193
  s_cmp_eq_u64 vcc, 0
  s_cbranch_scc1 P2SJ_MOK
  s_mov_b32 s14, 0
  s_mov_b64 exec, -1
  s_waitcnt vmcnt(0)
  buffer_load_dword v226, v192, s[56:59], 0 offen sc1
P2SJ_M_P:
  buffer_load_dword v227, v192, s[56:59], 0 offen sc1
  s_waitcnt vmcnt(1)
  v_cmp_ne_u32 vcc, s60, v226
  s_cmp_eq_u64 vcc, 0
  s_cbranch_scc1 P2SJ_M_R
  buffer_load_dword v226, v192, s[56:59], 0 offen sc1
  s_waitcnt vmcnt(1)
  v_cmp_ne_u32 vcc, s60, v227
  s_cmp_eq_u64 vcc, 0
  s_cbranch_scc1 P2SJ_M_R
  s_add_u32 s14, s14, 1
  s_cmp_gt_u32 s14, 30000
  s_cbranch_scc0 P2SJ_M_P
P2SJ_M_R:
  s_mov_b64 exec, -1
P2SJ_MOK:
  s_mov_b32 s48, s86
  s_mov_b32 s49, s87
  s_mov_b32 s50, 15360
  s_mov_b32 s51, 0x00020000
  v_lshlrev_b32 v190, 2, v189
  s_movk_i32 s55, 7680
  buffer_load_dword v152, v190, s[48:51], s55 offen offset:0 sc1
  s_movk_i32 s55, 10240
  buffer_load_dword v153, v190, s[48:51], s55 offen offset:0 sc1
  s_movk_i32 s55, 7680
  buffer_load_dword v154, v190, s[48:51], s55 offen offset:128 sc1
  s_movk_i32 s55, 10240
  buffer_load_dword v155, v190, s[48:51], s55 offen offset:128 sc1
  s_movk_i32 s55, 7680
  buffer_load_dword v156, v190, s[48:51], s55 offen offset:256 sc1
  s_movk_i32 s55, 10240
  buffer_load_dword v157, v190, s[48:51], s55 offen offset:256 sc1
  s_movk_i32 s55, 7680
  buffer_load_dword v158, v190, s[48:51], s55 offen offset:384 sc1
  s_movk_i32 s55, 10240
  buffer_load_dword v159, v190, s[48:51], s55 offen offset:384 sc1
  v_mov_b32 v160, 0
  v_mov_b32 v161, 0
  v_mov_b32 v162, 0
  v_mov_b32 v163, 0
  v_mov_b32 v164, 0
  v_mov_b32 v165, 0
  v_mov_b32 v166, 0
  v_mov_b32 v167, 0
  v_mov_b32 v168, 0
  v_mov_b32 v169, 0
  v_mov_b32 v170, 0
  v_mov_b32 v171, 0
  v_mov_b32 v172, 0
  v_mov_b32 v173, 0
  v_mov_b32 v174, 0
  v_mov_b32 v175, 0
  s_lshl_b32 s55, s53, 3
  v_add_u32 v190, s55, v188
  v_mul_u32_u24 v194, 5462, v190
  v_lshrrev_b32 v194, 16, v194
  v_mul_u32_u24 v195, 12, v194
  v_sub_u32 v195, v190, v195
  s_mov_b32 s55, 245760
  v_mul_lo_u32 v196, s55, v194
  s_mul_i32 s55, s52, 12288
  v_lshl_add_u32 v196, v195, 4, v196
  v_add_u32 v196, s55, v196
  v_add_u32 v190, 0, v189
  v_lshrrev_b32 v197, 6, v190
  v_mul_u32_u24 v190, 192, v190
  v_mul_u32_u24 v197, 12288, v197
  v_add3_u32 v199, v190, v197, v196
  v_add_u32 v190, 32, v189
  v_lshrrev_b32 v197, 6, v190
  v_mul_u32_u24 v190, 192, v190
  v_mul_u32_u24 v197, 12288, v197
  v_add3_u32 v200, v190, v197, v196
  v_add_u32 v190, 64, v189
  v_lshrrev_b32 v197, 6, v190
  v_mul_u32_u24 v190, 192, v190
  v_mul_u32_u24 v197, 12288, v197
  v_add3_u32 v201, v190, v197, v196
  v_add_u32 v190, 96, v189
  v_lshrrev_b32 v197, 6, v190
  v_mul_u32_u24 v190, 192, v190
  v_mul_u32_u24 v197, 12288, v197
  v_add3_u32 v202, v190, v197, v196
  v_mul_u32_u24 v190, 384, v194
  v_lshl_add_u32 v190, v195, 3, v190
  v_lshrrev_b32 v197, 3, v1
  v_add_u32 v190, v190, v197
  s_mul_i32 s55, s52, 96
  v_add_u32 v190, s55, v190
  v_lshlrev_b32 v203, 2, v190
  s_mov_b32 s55, 53687092
  v_mul_hi_u32 v190, s55, v191
  v_mul_u32_u24 v197, 80, v190
  v_sub_u32 v197, v191, v197
  s_mov_b32 s55, 429496730
  v_mul_hi_u32 v198, s55, v197
  v_mul_u32_u24 v194, 10, v198
  v_sub_u32 v197, v197, v194
  v_and_b32 v194, 0xfffffff3, v190
  v_bfe_u32 v195, v190, 2, 1
  v_lshl_or_b32 v194, v195, 3, v194
  v_bfe_u32 v195, v190, 3, 1
  v_lshl_or_b32 v194, v195, 2, v194
  s_mov_b32 s55, 102400
  v_mul_lo_u32 v198, s55, v198
  v_mul_u32_u24 v194, 160, v194
  v_lshlrev_b32 v197, 4, v197
  v_add3_u32 v198, v198, v197, v194
  s_mov_b32 s55, 51200
  v_cmp_gt_u32 vcc, s55, v191
  v_mov_b32 v194, 0x7ffffff0
  s_nop 0
  v_cndmask_b32 v204, v194, v198, vcc
  s_waitcnt vmcnt(0)
  v_lshlrev_b32 v176, 16, v136
  v_and_b32 v177, 0xffff0000, v136
  v_lshlrev_b32 v178, 16, v137
  v_and_b32 v179, 0xffff0000, v137
  v_lshlrev_b32 v180, 16, v138
  v_and_b32 v181, 0xffff0000, v138
  v_lshlrev_b32 v182, 16, v139
  v_and_b32 v183, 0xffff0000, v139
  v_pk_fma_f32 v[168:169], v[176:177], v[152:153], v[168:169] op_sel:[0,0,0] op_sel_hi:[1,0,1]
  v_pk_fma_f32 v[170:171], v[178:179], v[152:153], v[170:171] op_sel:[0,0,0] op_sel_hi:[1,0,1]
  v_pk_fma_f32 v[172:173], v[180:181], v[152:153], v[172:173] op_sel:[0,0,0] op_sel_hi:[1,0,1]
  v_pk_fma_f32 v[174:175], v[182:183], v[152:153], v[174:175] op_sel:[0,0,0] op_sel_hi:[1,0,1]
  v_pk_mul_f32 v[176:177], v[176:177], v[152:153] op_sel:[0,1] op_sel_hi:[1,1]
  v_pk_mul_f32 v[178:179], v[178:179], v[152:153] op_sel:[0,1] op_sel_hi:[1,1]
  v_pk_mul_f32 v[180:181], v[180:181], v[152:153] op_sel:[0,1] op_sel_hi:[1,1]
  v_pk_mul_f32 v[182:183], v[182:183], v[152:153] op_sel:[0,1] op_sel_hi:[1,1]
  v_pk_add_f32 v[160:161], v[160:161], v[176:177]
  v_pk_add_f32 v[162:163], v[162:163], v[178:179]
  v_pk_add_f32 v[164:165], v[164:165], v[180:181]
  v_pk_add_f32 v[166:167], v[166:167], v[182:183]
  v_cvt_pk_bf16_f32 v136, v176, v177
  v_cvt_pk_bf16_f32 v137, v178, v179
  v_cvt_pk_bf16_f32 v138, v180, v181
  v_cvt_pk_bf16_f32 v139, v182, v183
  v_lshlrev_b32 v176, 16, v140
  v_and_b32 v177, 0xffff0000, v140
  v_lshlrev_b32 v178, 16, v141
  v_and_b32 v179, 0xffff0000, v141
  v_lshlrev_b32 v180, 16, v142
  v_and_b32 v181, 0xffff0000, v142
  v_lshlrev_b32 v182, 16, v143
  v_and_b32 v183, 0xffff0000, v143
  v_pk_fma_f32 v[168:169], v[176:177], v[154:155], v[168:169] op_sel:[0,0,0] op_sel_hi:[1,0,1]
  v_pk_fma_f32 v[170:171], v[178:179], v[154:155], v[170:171] op_sel:[0,0,0] op_sel_hi:[1,0,1]
  v_pk_fma_f32 v[172:173], v[180:181], v[154:155], v[172:173] op_sel:[0,0,0] op_sel_hi:[1,0,1]
  v_pk_fma_f32 v[174:175], v[182:183], v[154:155], v[174:175] op_sel:[0,0,0] op_sel_hi:[1,0,1]
  v_pk_mul_f32 v[176:177], v[176:177], v[154:155] op_sel:[0,1] op_sel_hi:[1,1]
  v_pk_mul_f32 v[178:179], v[178:179], v[154:155] op_sel:[0,1] op_sel_hi:[1,1]
  v_pk_mul_f32 v[180:181], v[180:181], v[154:155] op_sel:[0,1] op_sel_hi:[1,1]
  v_pk_mul_f32 v[182:183], v[182:183], v[154:155] op_sel:[0,1] op_sel_hi:[1,1]
  v_pk_add_f32 v[160:161], v[160:161], v[176:177]
  v_pk_add_f32 v[162:163], v[162:163], v[178:179]
  v_pk_add_f32 v[164:165], v[164:165], v[180:181]
  v_pk_add_f32 v[166:167], v[166:167], v[182:183]
  v_cvt_pk_bf16_f32 v140, v176, v177
  v_cvt_pk_bf16_f32 v141, v178, v179
  v_cvt_pk_bf16_f32 v142, v180, v181
  v_cvt_pk_bf16_f32 v143, v182, v183
  v_lshlrev_b32 v176, 16, v144
  v_and_b32 v177, 0xffff0000, v144
  v_lshlrev_b32 v178, 16, v145
  v_and_b32 v179, 0xffff0000, v145
  v_lshlrev_b32 v180, 16, v146
  v_and_b32 v181, 0xffff0000, v146
  v_lshlrev_b32 v182, 16, v147
  v_and_b32 v183, 0xffff0000, v147
  v_pk_fma_f32 v[168:169], v[176:177], v[156:157], v[168:169] op_sel:[0,0,0] op_sel_hi:[1,0,1]
  v_pk_fma_f32 v[170:171], v[178:179], v[156:157], v[170:171] op_sel:[0,0,0] op_sel_hi:[1,0,1]
  v_pk_fma_f32 v[172:173], v[180:181], v[156:157], v[172:173] op_sel:[0,0,0] op_sel_hi:[1,0,1]
  v_pk_fma_f32 v[174:175], v[182:183], v[156:157], v[174:175] op_sel:[0,0,0] op_sel_hi:[1,0,1]
  v_pk_mul_f32 v[176:177], v[176:177], v[156:157] op_sel:[0,1] op_sel_hi:[1,1]
  v_pk_mul_f32 v[178:179], v[178:179], v[156:157] op_sel:[0,1] op_sel_hi:[1,1]
  v_pk_mul_f32 v[180:181], v[180:181], v[156:157] op_sel:[0,1] op_sel_hi:[1,1]
  v_pk_mul_f32 v[182:183], v[182:183], v[156:157] op_sel:[0,1] op_sel_hi:[1,1]
  v_pk_add_f32 v[160:161], v[160:161], v[176:177]
  v_pk_add_f32 v[162:163], v[162:163], v[178:179]
  v_pk_add_f32 v[164:165], v[164:165], v[180:181]
  v_pk_add_f32 v[166:167], v[166:167], v[182:183]
  v_cvt_pk_bf16_f32 v144, v176, v177
  v_cvt_pk_bf16_f32 v145, v178, v179
  v_cvt_pk_bf16_f32 v146, v180, v181
  v_cvt_pk_bf16_f32 v147, v182, v183
  v_lshlrev_b32 v176, 16, v148
  v_and_b32 v177, 0xffff0000, v148
  v_lshlrev_b32 v178, 16, v149
  v_and_b32 v179, 0xffff0000, v149
  v_lshlrev_b32 v180, 16, v150
  v_and_b32 v181, 0xffff0000, v150
  v_lshlrev_b32 v182, 16, v151
  v_and_b32 v183, 0xffff0000, v151
  v_pk_fma_f32 v[168:169], v[176:177], v[158:159], v[168:169] op_sel:[0,0,0] op_sel_hi:[1,0,1]
  v_pk_fma_f32 v[170:171], v[178:179], v[158:159], v[170:171] op_sel:[0,0,0] op_sel_hi:[1,0,1]
  v_pk_fma_f32 v[172:173], v[180:181], v[158:159], v[172:173] op_sel:[0,0,0] op_sel_hi:[1,0,1]
  v_pk_fma_f32 v[174:175], v[182:183], v[158:159], v[174:175] op_sel:[0,0,0] op_sel_hi:[1,0,1]
  v_pk_mul_f32 v[176:177], v[176:177], v[158:159] op_sel:[0,1] op_sel_hi:[1,1]
  v_pk_mul_f32 v[178:179], v[178:179], v[158:159] op_sel:[0,1] op_sel_hi:[1,1]
  v_pk_mul_f32 v[180:181], v[180:181], v[158:159] op_sel:[0,1] op_sel_hi:[1,1]
  v_pk_mul_f32 v[182:183], v[182:183], v[158:159] op_sel:[0,1] op_sel_hi:[1,1]
  v_pk_add_f32 v[160:161], v[160:161], v[176:177]
  v_pk_add_f32 v[162:163], v[162:163], v[178:179]
  v_pk_add_f32 v[164:165], v[164:165], v[180:181]
  v_pk_add_f32 v[166:167], v[166:167], v[182:183]
  v_cvt_pk_bf16_f32 v148, v176, v177
  v_cvt_pk_bf16_f32 v149, v178, v179
  v_cvt_pk_bf16_f32 v150, v180, v181
  v_cvt_pk_bf16_f32 v151, v182, v183
  v_and_b32 v190, 8, v1
  v_cmp_ne_u32 vcc, 0, v190
  v_permlane32_swap_b32 v160, v164
  v_add_f32 v160, v160, v164
  v_permlane32_swap_b32 v161, v165
  v_add_f32 v161, v161, v165
  v_permlane32_swap_b32 v162, v166
  v_add_f32 v162, v162, v166
  v_permlane32_swap_b32 v163, v167
  v_add_f32 v163, v163, v167
  v_permlane16_swap_b32 v160, v162
  v_add_f32 v160, v160, v162
  v_permlane16_swap_b32 v161, v163
  v_add_f32 v161, v161, v163
  v_add_f32_dpp v160, v160, v160 row_ror:8 row_mask:0xf bank_mask:0xf
  s_nop 0
  v_add_f32_dpp v161, v161, v161 row_ror:8 row_mask:0xf bank_mask:0xf
  v_cndmask_b32 v160, v160, v161, vcc
  v_permlane32_swap_b32 v168, v172
  v_add_f32 v168, v168, v172
  v_permlane32_swap_b32 v169, v173
  v_add_f32 v169, v169, v173
  v_permlane32_swap_b32 v170, v174
  v_add_f32 v170, v170, v174
  v_permlane32_swap_b32 v171, v175
  v_add_f32 v171, v171, v175
  v_permlane16_swap_b32 v168, v170
  v_add_f32 v168, v168, v170
  v_permlane16_swap_b32 v169, v171
  v_add_f32 v169, v169, v171
  v_add_f32_dpp v168, v168, v168 row_ror:8 row_mask:0xf bank_mask:0xf
  s_nop 0
  v_add_f32_dpp v169, v169, v169 row_ror:8 row_mask:0xf bank_mask:0xf
  v_cndmask_b32 v168, v168, v169, vcc
  s_branch P3_START
P2_START:
  s_cmp_ge_u32 s12, 15
  s_cbranch_scc1 P3_START
  v_lshlrev_b32 v2, 4, v1
  v_add_u32 v2, 144384, v2
  ds_read_b128 v[176:179], v2 offset:0
  ds_read_b128 v[180:183], v2 offset:1024
  ds_read_b128 v[184:187], v2 offset:2048
  ds_read_b128 v[188:191], v2 offset:3072
  ds_read_b128 v[192:195], v2 offset:4096
  ds_read_b128 v[196:199], v2 offset:5120
  ds_read_b128 v[200:203], v2 offset:6144
  s_waitcnt lgkmcnt(0)
  s_cmp_ge_u32 s12, 10
  s_cbranch_scc1 P2_V
  v_add_u32 v176, s43, v176
  v_add_u32 v177, s43, v177
  v_add_u32 v178, s43, v178
  v_add_u32 v179, s43, v179
  v_add_u32 v180, s43, v180
  v_add_u32 v181, s43, v181
  v_add_u32 v182, s43, v182
  v_add_u32 v183, s43, v183
  v_add_u32 v184, s43, v184
  v_add_u32 v185, s43, v185
  v_add_u32 v186, s43, v186
  v_add_u32 v187, s43, v187
  v_add_u32 v188, s43, v188
  v_add_u32 v189, s43, v189
  v_add_u32 v190, s43, v190
  v_add_u32 v191, s43, v191
  s_cmp_ge_u32 s12, 5
  s_cbranch_scc1 P2_K
  s_add_u32 s24, s86, 2686976
  s_addc_u32 s25, s87, 0
  s_mov_b32 s26, 2621440
  s_mov_b32 s27, 0x00020000
  s_branch P2_QK
P2_K:
  s_add_u32 s24, s86, 5308416
  s_addc_u32 s25, s87, 0
  s_mov_b32 s26, 5767168
  s_mov_b32 s27, 0x00020000
P2_QK:
  s_barrier
  s_barrier
  ds_read_b128 v[40:43], v212 offset:0
  ds_read_b64_tr_b16 v[48:49], v220 offset:0
  ds_read_b64_tr_b16 v[50:51], v220 offset:1024
  ds_read_b64_tr_b16 v[52:53], v221 offset:0
  ds_read_b64_tr_b16 v[54:55], v221 offset:1024
  ds_read_b64_tr_b16 v[56:57], v222 offset:0
  ds_read_b64_tr_b16 v[58:59], v222 offset:1024
  ds_read_b64_tr_b16 v[60:61], v223 offset:0
  ds_read_b64_tr_b16 v[62:63], v223 offset:1024
  s_waitcnt lgkmcnt(6)
  v_mfma_f32_32x32x16_bf16 v[80:95], v[48:51], v[40:43], 0
  ds_read_b128 v[44:47], v213 offset:0
  ds_read_b64_tr_b16 v[64:65], v220 offset:4096
  ds_read_b64_tr_b16 v[66:67], v220 offset:5120
  s_waitcnt lgkmcnt(7)
  v_mfma_f32_32x32x16_bf16 v[96:111], v[52:55], v[40:43], 0
  ds_read_b64_tr_b16 v[68:69], v221 offset:4096
  ds_read_b64_tr_b16 v[70:71], v221 offset:5120
  s_waitcnt lgkmcnt(7)
  v_mfma_f32_32x32x16_bf16 v[112:127], v[56:59], v[40:43], 0
  ds_read_b64_tr_b16 v[72:73], v222 offset:4096
  ds_read_b64_tr_b16 v[74:75], v222 offset:5120
  s_waitcnt lgkmcnt(7)
  v_mfma_f32_32x32x16_bf16 v[128:143], v[60:63], v[40:43], 0
  ds_read_b64_tr_b16 v[76:77], v223 offset:4096
  ds_read_b64_tr_b16 v[78:79], v223 offset:5120
  s_waitcnt lgkmcnt(6)
  v_mfma_f32_32x32x16_bf16 v[80:95], v[64:67], v[44:47], v[80:95]
  ds_read_b128 v[40:43], v214 offset:0
  ds_read_b64_tr_b16 v[48:49], v220 offset:8192
  ds_read_b64_tr_b16 v[50:51], v220 offset:9216
  s_waitcnt lgkmcnt(7)
  v_mfma_f32_32x32x16_bf16 v[96:111], v[68:71], v[44:47], v[96:111]
  ds_read_b64_tr_b16 v[52:53], v221 offset:8192
  ds_read_b64_tr_b16 v[54:55], v221 offset:9216
  s_waitcnt lgkmcnt(7)
  v_mfma_f32_32x32x16_bf16 v[112:127], v[72:75], v[44:47], v[112:127]
  ds_read_b64_tr_b16 v[56:57], v222 offset:8192
  ds_read_b64_tr_b16 v[58:59], v222 offset:9216
  s_waitcnt lgkmcnt(7)
  v_mfma_f32_32x32x16_bf16 v[128:143], v[76:79], v[44:47], v[128:143]
  ds_read_b64_tr_b16 v[60:61], v223 offset:8192
  ds_read_b64_tr_b16 v[62:63], v223 offset:9216
  s_waitcnt lgkmcnt(6)
  v_mfma_f32_32x32x16_bf16 v[80:95], v[48:51], v[40:43], v[80:95]
  ds_read_b128 v[44:47], v215 offset:0
  ds_read_b64_tr_b16 v[64:65], v220 offset:12288
  ds_read_b64_tr_b16 v[66:67], v220 offset:13312
  s_waitcnt lgkmcnt(7)
  v_mfma_f32_32x32x16_bf16 v[96:111], v[52:55], v[40:43], v[96:111]
  ds_read_b64_tr_b16 v[68:69], v221 offset:12288
  ds_read_b64_tr_b16 v[70:71], v221 offset:13312
  s_waitcnt lgkmcnt(7)
  v_mfma_f32_32x32x16_bf16 v[112:127], v[56:59], v[40:43], v[112:127]
  ds_read_b64_tr_b16 v[72:73], v222 offset:12288
  ds_read_b64_tr_b16 v[74:75], v222 offset:13312
  s_waitcnt lgkmcnt(7)
  v_mfma_f32_32x32x16_bf16 v[128:143], v[60:63], v[40:43], v[128:143]
  ds_read_b64_tr_b16 v[76:77], v223 offset:12288
  ds_read_b64_tr_b16 v[78:79], v223 offset:13312
  s_barrier
  s_waitcnt lgkmcnt(6)
  v_mfma_f32_32x32x16_bf16 v[80:95], v[64:67], v[44:47], v[80:95]
  ds_read_b128 v[40:43], v212 offset:32768
  ds_read_b64_tr_b16 v[48:49], v220 offset:32768
  ds_read_b64_tr_b16 v[50:51], v220 offset:33792
  s_waitcnt lgkmcnt(7)
  v_mfma_f32_32x32x16_bf16 v[96:111], v[68:71], v[44:47], v[96:111]
  ds_read_b64_tr_b16 v[52:53], v221 offset:32768
  ds_read_b64_tr_b16 v[54:55], v221 offset:33792
  s_waitcnt lgkmcnt(7)
  v_mfma_f32_32x32x16_bf16 v[112:127], v[72:75], v[44:47], v[112:127]
  ds_read_b64_tr_b16 v[56:57], v222 offset:32768
  ds_read_b64_tr_b16 v[58:59], v222 offset:33792
  s_waitcnt lgkmcnt(7)
  v_mfma_f32_32x32x16_bf16 v[128:143], v[76:79], v[44:47], v[128:143]
  ds_read_b64_tr_b16 v[60:61], v223 offset:32768
  ds_read_b64_tr_b16 v[62:63], v223 offset:33792
  s_waitcnt lgkmcnt(6)
  v_mfma_f32_32x32x16_bf16 v[80:95], v[48:51], v[40:43], v[80:95]
  ds_read_b128 v[44:47], v213 offset:32768
  ds_read_b64_tr_b16 v[64:65], v220 offset:36864
  ds_read_b64_tr_b16 v[66:67], v220 offset:37888
  s_waitcnt lgkmcnt(7)
  v_mfma_f32_32x32x16_bf16 v[96:111], v[52:55], v[40:43], v[96:111]
  ds_read_b64_tr_b16 v[68:69], v221 offset:36864
  ds_read_b64_tr_b16 v[70:71], v221 offset:37888
  s_waitcnt lgkmcnt(7)
  v_mfma_f32_32x32x16_bf16 v[112:127], v[56:59], v[40:43], v[112:127]
  ds_read_b64_tr_b16 v[72:73], v222 offset:36864
  ds_read_b64_tr_b16 v[74:75], v222 offset:37888
  s_waitcnt lgkmcnt(7)
  v_mfma_f32_32x32x16_bf16 v[128:143], v[60:63], v[40:43], v[128:143]
  ds_read_b64_tr_b16 v[76:77], v223 offset:36864
  ds_read_b64_tr_b16 v[78:79], v223 offset:37888
  s_waitcnt lgkmcnt(6)
  v_mfma_f32_32x32x16_bf16 v[80:95], v[64:67], v[44:47], v[80:95]
  ds_read_b128 v[40:43], v214 offset:32768
  ds_read_b64_tr_b16 v[48:49], v220 offset:40960
  ds_read_b64_tr_b16 v[50:51], v220 offset:41984
  s_waitcnt lgkmcnt(7)
  v_mfma_f32_32x32x16_bf16 v[96:111], v[68:71], v[44:47], v[96:111]
  ds_read_b64_tr_b16 v[52:53], v221 offset:40960
  ds_read_b64_tr_b16 v[54:55], v221 offset:41984
  s_waitcnt lgkmcnt(7)
  v_mfma_f32_32x32x16_bf16 v[112:127], v[72:75], v[44:47], v[112:127]
  ds_read_b64_tr_b16 v[56:57], v222 offset:40960
  ds_read_b64_tr_b16 v[58:59], v222 offset:41984
  s_waitcnt lgkmcnt(7)
  v_mfma_f32_32x32x16_bf16 v[128:143], v[76:79], v[44:47], v[128:143]
  ds_read_b64_tr_b16 v[60:61], v223 offset:40960
  ds_read_b64_tr_b16 v[62:63], v223 offset:41984
  s_waitcnt lgkmcnt(6)
  v_mfma_f32_32x32x16_bf16 v[80:95], v[48:51], v[40:43], v[80:95]
  ds_read_b128 v[44:47], v215 offset:32768
  ds_read_b64_tr_b16 v[64:65], v220 offset:45056
  ds_read_b64_tr_b16 v[66:67], v220 offset:46080
  s_waitcnt lgkmcnt(7)
  v_mfma_f32_32x32x16_bf16 v[96:111], v[52:55], v[40:43], v[96:111]
  ds_read_b64_tr_b16 v[68:69], v221 offset:45056
  ds_read_b64_tr_b16 v[70:71], v221 offset:46080
  s_waitcnt lgkmcnt(7)
  v_mfma_f32_32x32x16_bf16 v[112:127], v[56:59], v[40:43], v[112:127]
  ds_read_b64_tr_b16 v[72:73], v222 offset:45056
  ds_read_b64_tr_b16 v[74:75], v222 offset:46080
  s_waitcnt lgkmcnt(7)
  v_mfma_f32_32x32x16_bf16 v[128:143], v[60:63], v[40:43], v[128:143]
  ds_read_b64_tr_b16 v[76:77], v223 offset:45056
  ds_read_b64_tr_b16 v[78:79], v223 offset:46080
  s_barrier
  s_waitcnt lgkmcnt(6)
  v_mfma_f32_32x32x16_bf16 v[80:95], v[64:67], v[44:47], v[80:95]
  ds_read_b128 v[40:43], v216 offset:0
  ds_read_b64_tr_b16 v[48:49], v224 offset:0
  ds_read_b64_tr_b16 v[50:51], v224 offset:1024
  s_waitcnt lgkmcnt(7)
  v_mfma_f32_32x32x16_bf16 v[96:111], v[68:71], v[44:47], v[96:111]
  ds_read_b64_tr_b16 v[52:53], v225 offset:0
  ds_read_b64_tr_b16 v[54:55], v225 offset:1024
  s_waitcnt lgkmcnt(7)
  v_mfma_f32_32x32x16_bf16 v[112:127], v[72:75], v[44:47], v[112:127]
  ds_read_b64_tr_b16 v[56:57], v226 offset:0
  ds_read_b64_tr_b16 v[58:59], v226 offset:1024
  s_waitcnt lgkmcnt(7)
  v_mfma_f32_32x32x16_bf16 v[128:143], v[76:79], v[44:47], v[128:143]
  ds_read_b64_tr_b16 v[60:61], v227 offset:0
  ds_read_b64_tr_b16 v[62:63], v227 offset:1024
  s_waitcnt lgkmcnt(6)
  v_mfma_f32_32x32x16_bf16 v[80:95], v[48:51], v[40:43], v[80:95]
  ds_read_b128 v[44:47], v217 offset:0
  ds_read_b64_tr_b16 v[64:65], v224 offset:4096
  ds_read_b64_tr_b16 v[66:67], v224 offset:5120
  s_waitcnt lgkmcnt(7)
  v_mfma_f32_32x32x16_bf16 v[96:111], v[52:55], v[40:43], v[96:111]
  ds_read_b64_tr_b16 v[68:69], v225 offset:4096
  ds_read_b64_tr_b16 v[70:71], v225 offset:5120
  s_waitcnt lgkmcnt(7)
  v_mfma_f32_32x32x16_bf16 v[112:127], v[56:59], v[40:43], v[112:127]
  ds_read_b64_tr_b16 v[72:73], v226 offset:4096
  ds_read_b64_tr_b16 v[74:75], v226 offset:5120
  s_waitcnt lgkmcnt(7)
  v_mfma_f32_32x32x16_bf16 v[128:143], v[60:63], v[40:43], v[128:143]
  ds_read_b64_tr_b16 v[76:77], v227 offset:4096
  ds_read_b64_tr_b16 v[78:79], v227 offset:5120
  s_waitcnt lgkmcnt(6)
  v_mfma_f32_32x32x16_bf16 v[80:95], v[64:67], v[44:47], v[80:95]
  ds_read_b128 v[40:43], v218 offset:0
  ds_read_b64_tr_b16 v[48:49], v224 offset:8192
  ds_read_b64_tr_b16 v[50:51], v224 offset:9216
  s_waitcnt lgkmcnt(7)
  v_mfma_f32_32x32x16_bf16 v[96:111], v[68:71], v[44:47], v[96:111]
  ds_read_b64_tr_b16 v[52:53], v225 offset:8192
  ds_read_b64_tr_b16 v[54:55], v225 offset:9216
  s_waitcnt lgkmcnt(7)
  v_mfma_f32_32x32x16_bf16 v[112:127], v[72:75], v[44:47], v[112:127]
  ds_read_b64_tr_b16 v[56:57], v226 offset:8192
  ds_read_b64_tr_b16 v[58:59], v226 offset:9216
  s_waitcnt lgkmcnt(7)
  v_mfma_f32_32x32x16_bf16 v[128:143], v[76:79], v[44:47], v[128:143]
  ds_read_b64_tr_b16 v[60:61], v227 offset:8192
  ds_read_b64_tr_b16 v[62:63], v227 offset:9216
  s_waitcnt lgkmcnt(6)
  v_mfma_f32_32x32x16_bf16 v[80:95], v[48:51], v[40:43], v[80:95]
  ds_read_b128 v[44:47], v219 offset:0
  ds_read_b64_tr_b16 v[64:65], v224 offset:12288
  ds_read_b64_tr_b16 v[66:67], v224 offset:13312
  s_waitcnt lgkmcnt(7)
  v_mfma_f32_32x32x16_bf16 v[96:111], v[52:55], v[40:43], v[96:111]
  ds_read_b64_tr_b16 v[68:69], v225 offset:12288
  ds_read_b64_tr_b16 v[70:71], v225 offset:13312
  s_waitcnt lgkmcnt(7)
  v_mfma_f32_32x32x16_bf16 v[112:127], v[56:59], v[40:43], v[112:127]
  ds_read_b64_tr_b16 v[72:73], v226 offset:12288
  ds_read_b64_tr_b16 v[74:75], v226 offset:13312
  s_waitcnt lgkmcnt(7)
  v_mfma_f32_32x32x16_bf16 v[128:143], v[60:63], v[40:43], v[128:143]
  ds_read_b64_tr_b16 v[76:77], v227 offset:12288
  ds_read_b64_tr_b16 v[78:79], v227 offset:13312
  s_barrier
  s_waitcnt lgkmcnt(6)
  v_mfma_f32_32x32x16_bf16 v[80:95], v[64:67], v[44:47], v[80:95]
  ds_read_b128 v[40:43], v216 offset:32768
  ds_read_b64_tr_b16 v[48:49], v224 offset:32768
  ds_read_b64_tr_b16 v[50:51], v224 offset:33792
  s_waitcnt lgkmcnt(7)
  v_mfma_f32_32x32x16_bf16 v[96:111], v[68:71], v[44:47], v[96:111]
  ds_read_b64_tr_b16 v[52:53], v225 offset:32768
  ds_read_b64_tr_b16 v[54:55], v225 offset:33792
  s_waitcnt lgkmcnt(7)
  v_mfma_f32_32x32x16_bf16 v[112:127], v[72:75], v[44:47], v[112:127]
  ds_read_b64_tr_b16 v[56:57], v226 offset:32768
  ds_read_b64_tr_b16 v[58:59], v226 offset:33792
  s_waitcnt lgkmcnt(7)
  v_mfma_f32_32x32x16_bf16 v[128:143], v[76:79], v[44:47], v[128:143]
  ds_read_b64_tr_b16 v[60:61], v227 offset:32768
  ds_read_b64_tr_b16 v[62:63], v227 offset:33792
  s_waitcnt lgkmcnt(6)
  v_mfma_f32_32x32x16_bf16 v[80:95], v[48:51], v[40:43], v[80:95]
  ds_read_b128 v[44:47], v217 offset:32768
  ds_read_b64_tr_b16 v[64:65], v224 offset:36864
  ds_read_b64_tr_b16 v[66:67], v224 offset:37888
  s_waitcnt lgkmcnt(7)
  v_mfma_f32_32x32x16_bf16 v[96:111], v[52:55], v[40:43], v[96:111]
  ds_read_b64_tr_b16 v[68:69], v225 offset:36864
  ds_read_b64_tr_b16 v[70:71], v225 offset:37888
  s_waitcnt lgkmcnt(7)
  v_mfma_f32_32x32x16_bf16 v[112:127], v[56:59], v[40:43], v[112:127]
  ds_read_b64_tr_b16 v[72:73], v226 offset:36864
  ds_read_b64_tr_b16 v[74:75], v226 offset:37888
  s_waitcnt lgkmcnt(7)
  v_mfma_f32_32x32x16_bf16 v[128:143], v[60:63], v[40:43], v[128:143]
  ds_read_b64_tr_b16 v[76:77], v227 offset:36864
  ds_read_b64_tr_b16 v[78:79], v227 offset:37888
  s_waitcnt lgkmcnt(6)
  v_mfma_f32_32x32x16_bf16 v[80:95], v[64:67], v[44:47], v[80:95]
  ds_read_b128 v[40:43], v218 offset:32768
  ds_read_b64_tr_b16 v[48:49], v224 offset:40960
  ds_read_b64_tr_b16 v[50:51], v224 offset:41984
  s_waitcnt lgkmcnt(7)
  v_mfma_f32_32x32x16_bf16 v[96:111], v[68:71], v[44:47], v[96:111]
  ds_read_b64_tr_b16 v[52:53], v225 offset:40960
  ds_read_b64_tr_b16 v[54:55], v225 offset:41984
  s_waitcnt lgkmcnt(7)
  v_mfma_f32_32x32x16_bf16 v[112:127], v[72:75], v[44:47], v[112:127]
  ds_read_b64_tr_b16 v[56:57], v226 offset:40960
  ds_read_b64_tr_b16 v[58:59], v226 offset:41984
  s_waitcnt lgkmcnt(7)
  v_mfma_f32_32x32x16_bf16 v[128:143], v[76:79], v[44:47], v[128:143]
  ds_read_b64_tr_b16 v[60:61], v227 offset:40960
  ds_read_b64_tr_b16 v[62:63], v227 offset:41984
  s_waitcnt lgkmcnt(6)
  v_mfma_f32_32x32x16_bf16 v[80:95], v[48:51], v[40:43], v[80:95]
  ds_read_b128 v[44:47], v219 offset:32768
  ds_read_b64_tr_b16 v[64:65], v224 offset:45056
  ds_read_b64_tr_b16 v[66:67], v224 offset:46080
  s_waitcnt lgkmcnt(7)
  v_mfma_f32_32x32x16_bf16 v[96:111], v[52:55], v[40:43], v[96:111]
  ds_read_b64_tr_b16 v[68:69], v225 offset:45056
  ds_read_b64_tr_b16 v[70:71], v225 offset:46080
  s_waitcnt lgkmcnt(7)
  v_mfma_f32_32x32x16_bf16 v[112:127], v[56:59], v[40:43], v[112:127]
  ds_read_b64_tr_b16 v[72:73], v226 offset:45056
  ds_read_b64_tr_b16 v[74:75], v226 offset:46080
  s_waitcnt lgkmcnt(7)
  v_mfma_f32_32x32x16_bf16 v[128:143], v[60:63], v[40:43], v[128:143]
  ds_read_b64_tr_b16 v[76:77], v227 offset:45056
  ds_read_b64_tr_b16 v[78:79], v227 offset:46080
  s_barrier
  s_waitcnt lgkmcnt(6)
  v_mfma_f32_32x32x16_bf16 v[80:95], v[64:67], v[44:47], v[80:95]
  ds_read_b128 v[40:43], v212 offset:0
  ds_read_b64_tr_b16 v[48:49], v220 offset:0
  ds_read_b64_tr_b16 v[50:51], v220 offset:1024
  s_waitcnt lgkmcnt(7)
  v_mfma_f32_32x32x16_bf16 v[96:111], v[68:71], v[44:47], v[96:111]
  ds_read_b64_tr_b16 v[52:53], v221 offset:0
  ds_read_b64_tr_b16 v[54:55], v221 offset:1024
  s_waitcnt lgkmcnt(7)
  v_mfma_f32_32x32x16_bf16 v[112:127], v[72:75], v[44:47], v[112:127]
  ds_read_b64_tr_b16 v[56:57], v222 offset:0
  ds_read_b64_tr_b16 v[58:59], v222 offset:1024
  s_waitcnt lgkmcnt(7)
  v_mfma_f32_32x32x16_bf16 v[128:143], v[76:79], v[44:47], v[128:143]
  ds_read_b64_tr_b16 v[60:61], v223 offset:0
  ds_read_b64_tr_b16 v[62:63], v223 offset:1024
  s_waitcnt lgkmcnt(6)
  v_mfma_f32_32x32x16_bf16 v[80:95], v[48:51], v[40:43], v[80:95]
  ds_read_b128 v[44:47], v213 offset:0
  ds_read_b64_tr_b16 v[64:65], v220 offset:4096
  ds_read_b64_tr_b16 v[66:67], v220 offset:5120
  s_waitcnt lgkmcnt(7)
  v_mfma_f32_32x32x16_bf16 v[96:111], v[52:55], v[40:43], v[96:111]
  ds_read_b64_tr_b16 v[68:69], v221 offset:4096
  ds_read_b64_tr_b16 v[70:71], v221 offset:5120
  s_waitcnt lgkmcnt(7)
  v_mfma_f32_32x32x16_bf16 v[112:127], v[56:59], v[40:43], v[112:127]
  ds_read_b64_tr_b16 v[72:73], v222 offset:4096
  ds_read_b64_tr_b16 v[74:75], v222 offset:5120
  s_waitcnt lgkmcnt(7)
  v_mfma_f32_32x32x16_bf16 v[128:143], v[60:63], v[40:43], v[128:143]
  ds_read_b64_tr_b16 v[76:77], v223 offset:4096
  ds_read_b64_tr_b16 v[78:79], v223 offset:5120
  s_waitcnt lgkmcnt(6)
  v_mfma_f32_32x32x16_bf16 v[80:95], v[64:67], v[44:47], v[80:95]
  ds_read_b128 v[40:43], v214 offset:0
  ds_read_b64_tr_b16 v[48:49], v220 offset:8192
  ds_read_b64_tr_b16 v[50:51], v220 offset:9216
  s_waitcnt lgkmcnt(7)
  v_mfma_f32_32x32x16_bf16 v[96:111], v[68:71], v[44:47], v[96:111]
  ds_read_b64_tr_b16 v[52:53], v221 offset:8192
  ds_read_b64_tr_b16 v[54:55], v221 offset:9216
  s_waitcnt lgkmcnt(7)
  v_mfma_f32_32x32x16_bf16 v[112:127], v[72:75], v[44:47], v[112:127]
  ds_read_b64_tr_b16 v[56:57], v222 offset:8192
  ds_read_b64_tr_b16 v[58:59], v222 offset:9216
  s_waitcnt lgkmcnt(7)
  v_mfma_f32_32x32x16_bf16 v[128:143], v[76:79], v[44:47], v[128:143]
  ds_read_b64_tr_b16 v[60:61], v223 offset:8192
  ds_read_b64_tr_b16 v[62:63], v223 offset:9216
  s_waitcnt lgkmcnt(6)
  v_mfma_f32_32x32x16_bf16 v[80:95], v[48:51], v[40:43], v[80:95]
  ds_read_b128 v[44:47], v215 offset:0
  ds_read_b64_tr_b16 v[64:65], v220 offset:12288
  ds_read_b64_tr_b16 v[66:67], v220 offset:13312
  s_waitcnt lgkmcnt(7)
  v_mfma_f32_32x32x16_bf16 v[96:111], v[52:55], v[40:43], v[96:111]
  ds_read_b64_tr_b16 v[68:69], v221 offset:12288
  ds_read_b64_tr_b16 v[70:71], v221 offset:13312
  s_waitcnt lgkmcnt(7)
  v_mfma_f32_32x32x16_bf16 v[112:127], v[56:59], v[40:43], v[112:127]
  ds_read_b64_tr_b16 v[72:73], v222 offset:12288
  ds_read_b64_tr_b16 v[74:75], v222 offset:13312
  s_waitcnt lgkmcnt(7)
  v_mfma_f32_32x32x16_bf16 v[128:143], v[60:63], v[40:43], v[128:143]
  ds_read_b64_tr_b16 v[76:77], v223 offset:12288
  ds_read_b64_tr_b16 v[78:79], v223 offset:13312
  s_barrier
  s_waitcnt lgkmcnt(6)
  v_mfma_f32_32x32x16_bf16 v[80:95], v[64:67], v[44:47], v[80:95]
  ds_read_b128 v[40:43], v212 offset:32768
  ds_read_b64_tr_b16 v[48:49], v220 offset:32768
  ds_read_b64_tr_b16 v[50:51], v220 offset:33792
  s_waitcnt lgkmcnt(7)
  v_mfma_f32_32x32x16_bf16 v[96:111], v[68:71], v[44:47], v[96:111]
  ds_read_b64_tr_b16 v[52:53], v221 offset:32768
  ds_read_b64_tr_b16 v[54:55], v221 offset:33792
  s_waitcnt lgkmcnt(7)
  v_mfma_f32_32x32x16_bf16 v[112:127], v[72:75], v[44:47], v[112:127]
  ds_read_b64_tr_b16 v[56:57], v222 offset:32768
  ds_read_b64_tr_b16 v[58:59], v222 offset:33792
  s_waitcnt lgkmcnt(7)
  v_mfma_f32_32x32x16_bf16 v[128:143], v[76:79], v[44:47], v[128:143]
  ds_read_b64_tr_b16 v[60:61], v223 offset:32768
  ds_read_b64_tr_b16 v[62:63], v223 offset:33792
  s_waitcnt lgkmcnt(6)
  v_mfma_f32_32x32x16_bf16 v[80:95], v[48:51], v[40:43], v[80:95]
  ds_read_b128 v[44:47], v213 offset:32768
  ds_read_b64_tr_b16 v[64:65], v220 offset:36864
  ds_read_b64_tr_b16 v[66:67], v220 offset:37888
  s_waitcnt lgkmcnt(7)
  v_mfma_f32_32x32x16_bf16 v[96:111], v[52:55], v[40:43], v[96:111]
  ds_read_b64_tr_b16 v[68:69], v221 offset:36864
  ds_read_b64_tr_b16 v[70:71], v221 offset:37888
  s_waitcnt lgkmcnt(7)
  v_mfma_f32_32x32x16_bf16 v[112:127], v[56:59], v[40:43], v[112:127]
  ds_read_b64_tr_b16 v[72:73], v222 offset:36864
  ds_read_b64_tr_b16 v[74:75], v222 offset:37888
  s_waitcnt lgkmcnt(7)
  v_mfma_f32_32x32x16_bf16 v[128:143], v[60:63], v[40:43], v[128:143]
  ds_read_b64_tr_b16 v[76:77], v223 offset:36864
  ds_read_b64_tr_b16 v[78:79], v223 offset:37888
  s_waitcnt lgkmcnt(6)
  v_mfma_f32_32x32x16_bf16 v[80:95], v[64:67], v[44:47], v[80:95]
  ds_read_b128 v[40:43], v214 offset:32768
  ds_read_b64_tr_b16 v[48:49], v220 offset:40960
  ds_read_b64_tr_b16 v[50:51], v220 offset:41984
  s_waitcnt lgkmcnt(7)
  v_mfma_f32_32x32x16_bf16 v[96:111], v[68:71], v[44:47], v[96:111]
  ds_read_b64_tr_b16 v[52:53], v221 offset:40960
  ds_read_b64_tr_b16 v[54:55], v221 offset:41984
  s_waitcnt lgkmcnt(7)
  v_mfma_f32_32x32x16_bf16 v[112:127], v[72:75], v[44:47], v[112:127]
  ds_read_b64_tr_b16 v[56:57], v222 offset:40960
  ds_read_b64_tr_b16 v[58:59], v222 offset:41984
  s_waitcnt lgkmcnt(7)
  v_mfma_f32_32x32x16_bf16 v[128:143], v[76:79], v[44:47], v[128:143]
  ds_read_b64_tr_b16 v[60:61], v223 offset:40960
  ds_read_b64_tr_b16 v[62:63], v223 offset:41984
  s_waitcnt lgkmcnt(6)
  v_mfma_f32_32x32x16_bf16 v[80:95], v[48:51], v[40:43], v[80:95]
  ds_read_b128 v[44:47], v215 offset:32768
  ds_read_b64_tr_b16 v[64:65], v220 offset:45056
  ds_read_b64_tr_b16 v[66:67], v220 offset:46080
  s_waitcnt lgkmcnt(7)
  v_mfma_f32_32x32x16_bf16 v[96:111], v[52:55], v[40:43], v[96:111]
  ds_read_b64_tr_b16 v[68:69], v221 offset:45056
  ds_read_b64_tr_b16 v[70:71], v221 offset:46080
  s_waitcnt lgkmcnt(7)
  v_mfma_f32_32x32x16_bf16 v[112:127], v[56:59], v[40:43], v[112:127]
  ds_read_b64_tr_b16 v[72:73], v222 offset:45056
  ds_read_b64_tr_b16 v[74:75], v222 offset:46080
  s_waitcnt lgkmcnt(7)
  v_mfma_f32_32x32x16_bf16 v[128:143], v[60:63], v[40:43], v[128:143]
  ds_read_b64_tr_b16 v[76:77], v223 offset:45056
  ds_read_b64_tr_b16 v[78:79], v223 offset:46080
  s_barrier
  s_waitcnt lgkmcnt(6)
  v_mfma_f32_32x32x16_bf16 v[80:95], v[64:67], v[44:47], v[80:95]
  ds_read_b128 v[40:43], v216 offset:0
  ds_read_b64_tr_b16 v[48:49], v224 offset:0
  ds_read_b64_tr_b16 v[50:51], v224 offset:1024
  s_waitcnt lgkmcnt(7)
  v_mfma_f32_32x32x16_bf16 v[96:111], v[68:71], v[44:47], v[96:111]
  ds_read_b64_tr_b16 v[52:53], v225 offset:0
  ds_read_b64_tr_b16 v[54:55], v225 offset:1024
  s_waitcnt lgkmcnt(7)
  v_mfma_f32_32x32x16_bf16 v[112:127], v[72:75], v[44:47], v[112:127]
  ds_read_b64_tr_b16 v[56:57], v226 offset:0
  ds_read_b64_tr_b16 v[58:59], v226 offset:1024
  s_waitcnt lgkmcnt(7)
  v_mfma_f32_32x32x16_bf16 v[128:143], v[76:79], v[44:47], v[128:143]
  ds_read_b64_tr_b16 v[60:61], v227 offset:0
  ds_read_b64_tr_b16 v[62:63], v227 offset:1024
  s_waitcnt lgkmcnt(6)
  v_mfma_f32_32x32x16_bf16 v[80:95], v[48:51], v[40:43], v[80:95]
  ds_read_b128 v[44:47], v217 offset:0
  ds_read_b64_tr_b16 v[64:65], v224 offset:4096
  ds_read_b64_tr_b16 v[66:67], v224 offset:5120
  s_waitcnt lgkmcnt(7)
  v_mfma_f32_32x32x16_bf16 v[96:111], v[52:55], v[40:43], v[96:111]
  ds_read_b64_tr_b16 v[68:69], v225 offset:4096
  ds_read_b64_tr_b16 v[70:71], v225 offset:5120
  s_waitcnt lgkmcnt(7)
  v_mfma_f32_32x32x16_bf16 v[112:127], v[56:59], v[40:43], v[112:127]
  ds_read_b64_tr_b16 v[72:73], v226 offset:4096
  ds_read_b64_tr_b16 v[74:75], v226 offset:5120
  s_waitcnt lgkmcnt(7)
  v_mfma_f32_32x32x16_bf16 v[128:143], v[60:63], v[40:43], v[128:143]
  ds_read_b64_tr_b16 v[76:77], v227 offset:4096
  ds_read_b64_tr_b16 v[78:79], v227 offset:5120
  s_waitcnt lgkmcnt(6)
  v_mfma_f32_32x32x16_bf16 v[80:95], v[64:67], v[44:47], v[80:95]
  ds_read_b128 v[40:43], v218 offset:0
  ds_read_b64_tr_b16 v[48:49], v224 offset:8192
  ds_read_b64_tr_b16 v[50:51], v224 offset:9216
  s_waitcnt lgkmcnt(7)
  v_mfma_f32_32x32x16_bf16 v[96:111], v[68:71], v[44:47], v[96:111]
  ds_read_b64_tr_b16 v[52:53], v225 offset:8192
  ds_read_b64_tr_b16 v[54:55], v225 offset:9216
  s_waitcnt lgkmcnt(7)
  v_mfma_f32_32x32x16_bf16 v[112:127], v[72:75], v[44:47], v[112:127]
  ds_read_b64_tr_b16 v[56:57], v226 offset:8192
  ds_read_b64_tr_b16 v[58:59], v226 offset:9216
  s_waitcnt lgkmcnt(7)
  v_mfma_f32_32x32x16_bf16 v[128:143], v[76:79], v[44:47], v[128:143]
  ds_read_b64_tr_b16 v[60:61], v227 offset:8192
  ds_read_b64_tr_b16 v[62:63], v227 offset:9216
  s_waitcnt lgkmcnt(6)
  v_mfma_f32_32x32x16_bf16 v[80:95], v[48:51], v[40:43], v[80:95]
  ds_read_b128 v[44:47], v219 offset:0
  ds_read_b64_tr_b16 v[64:65], v224 offset:12288
  ds_read_b64_tr_b16 v[66:67], v224 offset:13312
  s_waitcnt lgkmcnt(7)
  v_mfma_f32_32x32x16_bf16 v[96:111], v[52:55], v[40:43], v[96:111]
  ds_read_b64_tr_b16 v[68:69], v225 offset:12288
  ds_read_b64_tr_b16 v[70:71], v225 offset:13312
  s_waitcnt lgkmcnt(7)
  v_mfma_f32_32x32x16_bf16 v[112:127], v[56:59], v[40:43], v[112:127]
  ds_read_b64_tr_b16 v[72:73], v226 offset:12288
  ds_read_b64_tr_b16 v[74:75], v226 offset:13312
  s_waitcnt lgkmcnt(7)
  v_mfma_f32_32x32x16_bf16 v[128:143], v[60:63], v[40:43], v[128:143]
  ds_read_b64_tr_b16 v[76:77], v227 offset:12288
  ds_read_b64_tr_b16 v[78:79], v227 offset:13312
  s_barrier
  s_waitcnt lgkmcnt(6)
  v_mfma_f32_32x32x16_bf16 v[80:95], v[64:67], v[44:47], v[80:95]
  ds_read_b128 v[40:43], v216 offset:32768
  ds_read_b64_tr_b16 v[48:49], v224 offset:32768
  ds_read_b64_tr_b16 v[50:51], v224 offset:33792
  s_waitcnt lgkmcnt(7)
  v_mfma_f32_32x32x16_bf16 v[96:111], v[68:71], v[44:47], v[96:111]
  ds_read_b64_tr_b16 v[52:53], v225 offset:32768
  ds_read_b64_tr_b16 v[54:55], v225 offset:33792
  s_waitcnt lgkmcnt(7)
  v_mfma_f32_32x32x16_bf16 v[112:127], v[72:75], v[44:47], v[112:127]
  ds_read_b64_tr_b16 v[56:57], v226 offset:32768
  ds_read_b64_tr_b16 v[58:59], v226 offset:33792
  s_waitcnt lgkmcnt(7)
  v_mfma_f32_32x32x16_bf16 v[128:143], v[76:79], v[44:47], v[128:143]
  ds_read_b64_tr_b16 v[60:61], v227 offset:32768
  ds_read_b64_tr_b16 v[62:63], v227 offset:33792
  s_waitcnt lgkmcnt(6)
  v_mfma_f32_32x32x16_bf16 v[80:95], v[48:51], v[40:43], v[80:95]
  ds_read_b128 v[44:47], v217 offset:32768
  ds_read_b64_tr_b16 v[64:65], v224 offset:36864
  ds_read_b64_tr_b16 v[66:67], v224 offset:37888
  s_waitcnt lgkmcnt(7)
  v_mfma_f32_32x32x16_bf16 v[96:111], v[52:55], v[40:43], v[96:111]
  ds_read_b64_tr_b16 v[68:69], v225 offset:36864
  ds_read_b64_tr_b16 v[70:71], v225 offset:37888
  s_waitcnt lgkmcnt(7)
  v_mfma_f32_32x32x16_bf16 v[112:127], v[56:59], v[40:43], v[112:127]
  ds_read_b64_tr_b16 v[72:73], v226 offset:36864
  ds_read_b64_tr_b16 v[74:75], v226 offset:37888
  s_waitcnt lgkmcnt(7)
  v_mfma_f32_32x32x16_bf16 v[128:143], v[60:63], v[40:43], v[128:143]
  ds_read_b64_tr_b16 v[76:77], v227 offset:36864
  ds_read_b64_tr_b16 v[78:79], v227 offset:37888
  s_waitcnt lgkmcnt(6)
  v_mfma_f32_32x32x16_bf16 v[80:95], v[64:67], v[44:47], v[80:95]
  ds_read_b128 v[40:43], v218 offset:32768
  ds_read_b64_tr_b16 v[48:49], v224 offset:40960
  ds_read_b64_tr_b16 v[50:51], v224 offset:41984
  s_waitcnt lgkmcnt(7)
  v_mfma_f32_32x32x16_bf16 v[96:111], v[68:71], v[44:47], v[96:111]
  ds_read_b64_tr_b16 v[52:53], v225 offset:40960
  ds_read_b64_tr_b16 v[54:55], v225 offset:41984
  s_waitcnt lgkmcnt(7)
  v_mfma_f32_32x32x16_bf16 v[112:127], v[72:75], v[44:47], v[112:127]
  ds_read_b64_tr_b16 v[56:57], v226 offset:40960
  ds_read_b64_tr_b16 v[58:59], v226 offset:41984
  s_waitcnt lgkmcnt(7)
  v_mfma_f32_32x32x16_bf16 v[128:143], v[76:79], v[44:47], v[128:143]
  ds_read_b64_tr_b16 v[60:61], v227 offset:40960
  ds_read_b64_tr_b16 v[62:63], v227 offset:41984
  s_waitcnt lgkmcnt(6)
  v_mfma_f32_32x32x16_bf16 v[80:95], v[48:51], v[40:43], v[80:95]
  ds_read_b128 v[44:47], v219 offset:32768
  ds_read_b64_tr_b16 v[64:65], v224 offset:45056
  ds_read_b64_tr_b16 v[66:67], v224 offset:46080
  s_waitcnt lgkmcnt(7)
  v_mfma_f32_32x32x16_bf16 v[96:111], v[52:55], v[40:43], v[96:111]
  ds_read_b64_tr_b16 v[68:69], v225 offset:45056
  ds_read_b64_tr_b16 v[70:71], v225 offset:46080
  s_waitcnt lgkmcnt(7)
  v_mfma_f32_32x32x16_bf16 v[112:127], v[56:59], v[40:43], v[112:127]
  ds_read_b64_tr_b16 v[72:73], v226 offset:45056
  ds_read_b64_tr_b16 v[74:75], v226 offset:46080
  s_waitcnt lgkmcnt(7)
  v_mfma_f32_32x32x16_bf16 v[128:143], v[60:63], v[40:43], v[128:143]
  ds_read_b64_tr_b16 v[76:77], v227 offset:45056
  ds_read_b64_tr_b16 v[78:79], v227 offset:46080
  s_barrier
  s_waitcnt lgkmcnt(6)
  v_mfma_f32_32x32x16_bf16 v[80:95], v[64:67], v[44:47], v[80:95]
  ds_read_b128 v[40:43], v212 offset:0
  ds_read_b64_tr_b16 v[48:49], v220 offset:0
  ds_read_b64_tr_b16 v[50:51], v220 offset:1024
  s_waitcnt lgkmcnt(7)
  v_mfma_f32_32x32x16_bf16 v[96:111], v[68:71], v[44:47], v[96:111]
  ds_read_b64_tr_b16 v[52:53], v221 offset:0
  ds_read_b64_tr_b16 v[54:55], v221 offset:1024
  s_waitcnt lgkmcnt(7)
  v_mfma_f32_32x32x16_bf16 v[112:127], v[72:75], v[44:47], v[112:127]
  ds_read_b64_tr_b16 v[56:57], v222 offset:0
  ds_read_b64_tr_b16 v[58:59], v222 offset:1024
  s_waitcnt lgkmcnt(7)
  v_mfma_f32_32x32x16_bf16 v[128:143], v[76:79], v[44:47], v[128:143]
  ds_read_b64_tr_b16 v[60:61], v223 offset:0
  ds_read_b64_tr_b16 v[62:63], v223 offset:1024
  s_waitcnt lgkmcnt(6)
  v_mfma_f32_32x32x16_bf16 v[80:95], v[48:51], v[40:43], v[80:95]
  ds_read_b128 v[44:47], v213 offset:0
  ds_read_b64_tr_b16 v[64:65], v220 offset:4096
  ds_read_b64_tr_b16 v[66:67], v220 offset:5120
  s_waitcnt lgkmcnt(7)
  v_mfma_f32_32x32x16_bf16 v[96:111], v[52:55], v[40:43], v[96:111]
  ds_read_b64_tr_b16 v[68:69], v221 offset:4096
  ds_read_b64_tr_b16 v[70:71], v221 offset:5120
  s_waitcnt lgkmcnt(7)
  v_mfma_f32_32x32x16_bf16 v[112:127], v[56:59], v[40:43], v[112:127]
  ds_read_b64_tr_b16 v[72:73], v222 offset:4096
  ds_read_b64_tr_b16 v[74:75], v222 offset:5120
  s_waitcnt lgkmcnt(7)
  v_mfma_f32_32x32x16_bf16 v[128:143], v[60:63], v[40:43], v[128:143]
  ds_read_b64_tr_b16 v[76:77], v223 offset:4096
  ds_read_b64_tr_b16 v[78:79], v223 offset:5120
  s_waitcnt lgkmcnt(6)
  v_mfma_f32_32x32x16_bf16 v[80:95], v[64:67], v[44:47], v[80:95]
  ds_read_b128 v[40:43], v214 offset:0
  ds_read_b64_tr_b16 v[48:49], v220 offset:8192
  ds_read_b64_tr_b16 v[50:51], v220 offset:9216
  s_waitcnt lgkmcnt(7)
  v_mfma_f32_32x32x16_bf16 v[96:111], v[68:71], v[44:47], v[96:111]
  ds_read_b64_tr_b16 v[52:53], v221 offset:8192
  ds_read_b64_tr_b16 v[54:55], v221 offset:9216
  s_waitcnt lgkmcnt(7)
  v_mfma_f32_32x32x16_bf16 v[112:127], v[72:75], v[44:47], v[112:127]
  ds_read_b64_tr_b16 v[56:57], v222 offset:8192
  ds_read_b64_tr_b16 v[58:59], v222 offset:9216
  s_waitcnt lgkmcnt(7)
  v_mfma_f32_32x32x16_bf16 v[128:143], v[76:79], v[44:47], v[128:143]
  ds_read_b64_tr_b16 v[60:61], v223 offset:8192
  ds_read_b64_tr_b16 v[62:63], v223 offset:9216
  s_waitcnt lgkmcnt(6)
  v_mfma_f32_32x32x16_bf16 v[80:95], v[48:51], v[40:43], v[80:95]
  ds_read_b128 v[44:47], v215 offset:0
  ds_read_b64_tr_b16 v[64:65], v220 offset:12288
  ds_read_b64_tr_b16 v[66:67], v220 offset:13312
  s_waitcnt lgkmcnt(7)
  v_mfma_f32_32x32x16_bf16 v[96:111], v[52:55], v[40:43], v[96:111]
  ds_read_b64_tr_b16 v[68:69], v221 offset:12288
  ds_read_b64_tr_b16 v[70:71], v221 offset:13312
  s_waitcnt lgkmcnt(7)
  v_mfma_f32_32x32x16_bf16 v[112:127], v[56:59], v[40:43], v[112:127]
  ds_read_b64_tr_b16 v[72:73], v222 offset:12288
  ds_read_b64_tr_b16 v[74:75], v222 offset:13312
  s_waitcnt lgkmcnt(7)
  v_mfma_f32_32x32x16_bf16 v[128:143], v[60:63], v[40:43], v[128:143]
  ds_read_b64_tr_b16 v[76:77], v223 offset:12288
  ds_read_b64_tr_b16 v[78:79], v223 offset:13312
  s_barrier
  s_waitcnt lgkmcnt(6)
  v_mfma_f32_32x32x16_bf16 v[80:95], v[64:67], v[44:47], v[80:95]
  ds_read_b128 v[40:43], v212 offset:32768
  ds_read_b64_tr_b16 v[48:49], v220 offset:32768
  ds_read_b64_tr_b16 v[50:51], v220 offset:33792
  s_waitcnt lgkmcnt(7)
  v_mfma_f32_32x32x16_bf16 v[96:111], v[68:71], v[44:47], v[96:111]
  ds_read_b64_tr_b16 v[52:53], v221 offset:32768
  ds_read_b64_tr_b16 v[54:55], v221 offset:33792
  s_waitcnt lgkmcnt(7)
  v_mfma_f32_32x32x16_bf16 v[112:127], v[72:75], v[44:47], v[112:127]
  ds_read_b64_tr_b16 v[56:57], v222 offset:32768
  ds_read_b64_tr_b16 v[58:59], v222 offset:33792
  s_waitcnt lgkmcnt(7)
  v_mfma_f32_32x32x16_bf16 v[128:143], v[76:79], v[44:47], v[128:143]
  ds_read_b64_tr_b16 v[60:61], v223 offset:32768
  ds_read_b64_tr_b16 v[62:63], v223 offset:33792
  s_waitcnt lgkmcnt(6)
  v_mfma_f32_32x32x16_bf16 v[80:95], v[48:51], v[40:43], v[80:95]
  ds_read_b128 v[44:47], v213 offset:32768
  ds_read_b64_tr_b16 v[64:65], v220 offset:36864
  ds_read_b64_tr_b16 v[66:67], v220 offset:37888
  s_waitcnt lgkmcnt(7)
  v_mfma_f32_32x32x16_bf16 v[96:111], v[52:55], v[40:43], v[96:111]
  ds_read_b64_tr_b16 v[68:69], v221 offset:36864
  ds_read_b64_tr_b16 v[70:71], v221 offset:37888
  s_waitcnt lgkmcnt(7)
  v_mfma_f32_32x32x16_bf16 v[112:127], v[56:59], v[40:43], v[112:127]
  ds_read_b64_tr_b16 v[72:73], v222 offset:36864
  ds_read_b64_tr_b16 v[74:75], v222 offset:37888
  s_waitcnt lgkmcnt(7)
  v_mfma_f32_32x32x16_bf16 v[128:143], v[60:63], v[40:43], v[128:143]
  ds_read_b64_tr_b16 v[76:77], v223 offset:36864
  ds_read_b64_tr_b16 v[78:79], v223 offset:37888
  s_waitcnt lgkmcnt(6)
  v_mfma_f32_32x32x16_bf16 v[80:95], v[64:67], v[44:47], v[80:95]
  ds_read_b128 v[40:43], v214 offset:32768
  ds_read_b64_tr_b16 v[48:49], v220 offset:40960
  ds_read_b64_tr_b16 v[50:51], v220 offset:41984
  s_waitcnt lgkmcnt(7)
  v_mfma_f32_32x32x16_bf16 v[96:111], v[68:71], v[44:47], v[96:111]
  ds_read_b64_tr_b16 v[52:53], v221 offset:40960
  ds_read_b64_tr_b16 v[54:55], v221 offset:41984
  s_waitcnt lgkmcnt(7)
  v_mfma_f32_32x32x16_bf16 v[112:127], v[72:75], v[44:47], v[112:127]
  ds_read_b64_tr_b16 v[56:57], v222 offset:40960
  ds_read_b64_tr_b16 v[58:59], v222 offset:41984
  s_waitcnt lgkmcnt(7)
  v_mfma_f32_32x32x16_bf16 v[128:143], v[76:79], v[44:47], v[128:143]
  ds_read_b64_tr_b16 v[60:61], v223 offset:40960
  ds_read_b64_tr_b16 v[62:63], v223 offset:41984
  s_waitcnt lgkmcnt(6)
  v_mfma_f32_32x32x16_bf16 v[80:95], v[48:51], v[40:43], v[80:95]
  ds_read_b128 v[44:47], v215 offset:32768
  ds_read_b64_tr_b16 v[64:65], v220 offset:45056
  ds_read_b64_tr_b16 v[66:67], v220 offset:46080
  s_waitcnt lgkmcnt(7)
  v_mfma_f32_32x32x16_bf16 v[96:111], v[52:55], v[40:43], v[96:111]
  ds_read_b64_tr_b16 v[68:69], v221 offset:45056
  ds_read_b64_tr_b16 v[70:71], v221 offset:46080
  s_waitcnt lgkmcnt(7)
  v_mfma_f32_32x32x16_bf16 v[112:127], v[56:59], v[40:43], v[112:127]
  ds_read_b64_tr_b16 v[72:73], v222 offset:45056
  ds_read_b64_tr_b16 v[74:75], v222 offset:46080
  s_waitcnt lgkmcnt(7)
  v_mfma_f32_32x32x16_bf16 v[128:143], v[60:63], v[40:43], v[128:143]
  ds_read_b64_tr_b16 v[76:77], v223 offset:45056
  ds_read_b64_tr_b16 v[78:79], v223 offset:46080
  s_waitcnt lgkmcnt(6)
  v_mfma_f32_32x32x16_bf16 v[80:95], v[64:67], v[44:47], v[80:95]
  s_waitcnt lgkmcnt(4)
  v_mfma_f32_32x32x16_bf16 v[96:111], v[68:71], v[44:47], v[96:111]
  s_waitcnt lgkmcnt(2)
  v_mfma_f32_32x32x16_bf16 v[112:127], v[72:75], v[44:47], v[112:127]
  s_waitcnt lgkmcnt(0)
  v_mfma_f32_32x32x16_bf16 v[128:143], v[76:79], v[44:47], v[128:143]
  v_mov_b32 v2, s41
  v_mov_b32 v3, s41
  s_nop 3
  v_pk_mul_f32 v[80:81], v[80:81], v[2:3]
  v_pk_mul_f32 v[82:83], v[82:83], v[2:3]
  v_cvt_pk_bf16_f32 v28, v80, v81
  v_cvt_pk_bf16_f32 v29, v82, v83
  ds_write_b64 v176, v[28:29]
  v_pk_mul_f32 v[84:85], v[84:85], v[2:3]
  v_pk_mul_f32 v[86:87], v[86:87], v[2:3]
  v_cvt_pk_bf16_f32 v30, v84, v85
  v_cvt_pk_bf16_f32 v31, v86, v87
  ds_write_b64 v177, v[30:31]
  v_pk_mul_f32 v[88:89], v[88:89], v[2:3]
  v_pk_mul_f32 v[90:91], v[90:91], v[2:3]
  v_cvt_pk_bf16_f32 v32, v88, v89
  v_cvt_pk_bf16_f32 v33, v90, v91
  ds_write_b64 v178, v[32:33]
  v_pk_mul_f32 v[92:93], v[92:93], v[2:3]
  v_pk_mul_f32 v[94:95], v[94:95], v[2:3]
  v_cvt_pk_bf16_f32 v34, v92, v93
  v_cvt_pk_bf16_f32 v35, v94, v95
  ds_write_b64 v179, v[34:35]
  v_pk_mul_f32 v[96:97], v[96:97], v[2:3]
  v_pk_mul_f32 v[98:99], v[98:99], v[2:3]
  v_cvt_pk_bf16_f32 v28, v96, v97
  v_cvt_pk_bf16_f32 v29, v98, v99
  ds_write_b64 v180, v[28:29]
  v_pk_mul_f32 v[100:101], v[100:101], v[2:3]
  v_pk_mul_f32 v[102:103], v[102:103], v[2:3]
  v_cvt_pk_bf16_f32 v30, v100, v101
  v_cvt_pk_bf16_f32 v31, v102, v103
  ds_write_b64 v181, v[30:31]
  v_pk_mul_f32 v[104:105], v[104:105], v[2:3]
  v_pk_mul_f32 v[106:107], v[106:107], v[2:3]
  v_cvt_pk_bf16_f32 v32, v104, v105
  v_cvt_pk_bf16_f32 v33, v106, v107
  ds_write_b64 v182, v[32:33]
  v_pk_mul_f32 v[108:109], v[108:109], v[2:3]
  v_pk_mul_f32 v[110:111], v[110:111], v[2:3]
  v_cvt_pk_bf16_f32 v34, v108, v109
  v_cvt_pk_bf16_f32 v35, v110, v111
  ds_write_b64 v183, v[34:35]
  v_pk_mul_f32 v[112:113], v[112:113], v[2:3]
  v_pk_mul_f32 v[114:115], v[114:115], v[2:3]
  v_cvt_pk_bf16_f32 v28, v112, v113
  v_cvt_pk_bf16_f32 v29, v114, v115
  ds_write_b64 v184, v[28:29]
  v_pk_mul_f32 v[116:117], v[116:117], v[2:3]
  v_pk_mul_f32 v[118:119], v[118:119], v[2:3]
  v_cvt_pk_bf16_f32 v30, v116, v117
  v_cvt_pk_bf16_f32 v31, v118, v119
  ds_write_b64 v185, v[30:31]
  v_pk_mul_f32 v[120:121], v[120:121], v[2:3]
  v_pk_mul_f32 v[122:123], v[122:123], v[2:3]
  v_cvt_pk_bf16_f32 v32, v120, v121
  v_cvt_pk_bf16_f32 v33, v122, v123
  ds_write_b64 v186, v[32:33]
  v_pk_mul_f32 v[124:125], v[124:125], v[2:3]
  v_pk_mul_f32 v[126:127], v[126:127], v[2:3]
  v_cvt_pk_bf16_f32 v34, v124, v125
  v_cvt_pk_bf16_f32 v35, v126, v127
  ds_write_b64 v187, v[34:35]
  v_pk_mul_f32 v[128:129], v[128:129], v[2:3]
  v_pk_mul_f32 v[130:131], v[130:131], v[2:3]
  v_cvt_pk_bf16_f32 v28, v128, v129
  v_cvt_pk_bf16_f32 v29, v130, v131
  ds_write_b64 v188, v[28:29]
  v_pk_mul_f32 v[132:133], v[132:133], v[2:3]
  v_pk_mul_f32 v[134:135], v[134:135], v[2:3]
  v_cvt_pk_bf16_f32 v30, v132, v133
  v_cvt_pk_bf16_f32 v31, v134, v135
  ds_write_b64 v189, v[30:31]
  v_pk_mul_f32 v[136:137], v[136:137], v[2:3]
  v_pk_mul_f32 v[138:139], v[138:139], v[2:3]
  v_cvt_pk_bf16_f32 v32, v136, v137
  v_cvt_pk_bf16_f32 v33, v138, v139
  ds_write_b64 v190, v[32:33]
  v_pk_mul_f32 v[140:141], v[140:141], v[2:3]
  v_pk_mul_f32 v[142:143], v[142:143], v[2:3]
  v_cvt_pk_bf16_f32 v34, v140, v141
  v_cvt_pk_bf16_f32 v35, v142, v143
  ds_write_b64 v191, v[34:35]
  v_lshlrev_b32 v2, 4, v1
  v_add_u32 v2, s43, v2
  v_add_u32 v3, s43, v203
  s_waitcnt lgkmcnt(0)
  ds_read_b128 v[80:83], v2 offset:0
  ds_read_b128 v[84:87], v2 offset:1024
  ds_read_b128 v[88:91], v2 offset:2048
  ds_read_b128 v[92:95], v2 offset:3072
  ds_read_b128 v[96:99], v2 offset:4096
  ds_read_b128 v[100:103], v2 offset:5120
  ds_read_b128 v[104:107], v2 offset:6144
  ds_read_b128 v[108:111], v2 offset:7168
  ds_read_b128 v[112:115], v2 offset:8192
  ds_read_b128 v[116:119], v2 offset:9216
  ds_read_b64 v[120:121], v3
  s_waitcnt lgkmcnt(10)
  buffer_store_dwordx4 v[80:83], v192, s[24:27], s42 offen sc1
  s_waitcnt lgkmcnt(9)
  buffer_store_dwordx4 v[84:87], v193, s[24:27], s42 offen sc1
  s_waitcnt lgkmcnt(8)
  buffer_store_dwordx4 v[88:91], v194, s[24:27], s42 offen sc1
  s_waitcnt lgkmcnt(7)
  buffer_store_dwordx4 v[92:95], v195, s[24:27], s42 offen sc1
  s_waitcnt lgkmcnt(6)
  buffer_store_dwordx4 v[96:99], v196, s[24:27], s42 offen sc1
  s_waitcnt lgkmcnt(5)
  buffer_store_dwordx4 v[100:103], v197, s[24:27], s42 offen sc1
  s_waitcnt lgkmcnt(4)
  buffer_store_dwordx4 v[104:107], v198, s[24:27], s42 offen sc1
  s_waitcnt lgkmcnt(3)
  buffer_store_dwordx4 v[108:111], v199, s[24:27], s42 offen sc1
  s_waitcnt lgkmcnt(2)
  buffer_store_dwordx4 v[112:115], v200, s[24:27], s42 offen sc1
  s_waitcnt lgkmcnt(1)
  buffer_store_dwordx4 v[116:119], v201, s[24:27], s42 offen sc1
  s_waitcnt lgkmcnt(0)
  buffer_store_dwordx2 v[120:121], v202, s[24:27], s42 offen sc1
  s_branch P2_DONE
P2_V:
  s_add_u32 s24, s86, 5308416
  s_addc_u32 s25, s87, 0
  s_mov_b32 s26, 5767168
  s_mov_b32 s27, 0x00020000
  s_barrier
  s_barrier
  ds_read_b128 v[40:43], v212 offset:0
  ds_read_b64_tr_b16 v[48:49], v220 offset:0
  ds_read_b64_tr_b16 v[50:51], v220 offset:1024
  ds_read_b64_tr_b16 v[52:53], v221 offset:0
  ds_read_b64_tr_b16 v[54:55], v221 offset:1024
  ds_read_b64_tr_b16 v[56:57], v222 offset:0
  ds_read_b64_tr_b16 v[58:59], v222 offset:1024
  ds_read_b64_tr_b16 v[60:61], v223 offset:0
  ds_read_b64_tr_b16 v[62:63], v223 offset:1024
  s_waitcnt lgkmcnt(6)
  v_mfma_f32_32x32x16_bf16 v[80:95], v[40:43], v[48:51], 0
  ds_read_b128 v[44:47], v213 offset:0
  ds_read_b64_tr_b16 v[64:65], v220 offset:4096
  ds_read_b64_tr_b16 v[66:67], v220 offset:5120
  s_waitcnt lgkmcnt(7)
  v_mfma_f32_32x32x16_bf16 v[96:111], v[40:43], v[52:55], 0
  ds_read_b64_tr_b16 v[68:69], v221 offset:4096
  ds_read_b64_tr_b16 v[70:71], v221 offset:5120
  s_waitcnt lgkmcnt(7)
  v_mfma_f32_32x32x16_bf16 v[112:127], v[40:43], v[56:59], 0
  ds_read_b64_tr_b16 v[72:73], v222 offset:4096
  ds_read_b64_tr_b16 v[74:75], v222 offset:5120
  s_waitcnt lgkmcnt(7)
  v_mfma_f32_32x32x16_bf16 v[128:143], v[40:43], v[60:63], 0
  ds_read_b64_tr_b16 v[76:77], v223 offset:4096
  ds_read_b64_tr_b16 v[78:79], v223 offset:5120
  s_waitcnt lgkmcnt(6)
  v_mfma_f32_32x32x16_bf16 v[80:95], v[44:47], v[64:67], v[80:95]
  ds_read_b128 v[40:43], v214 offset:0
  ds_read_b64_tr_b16 v[48:49], v220 offset:8192
  ds_read_b64_tr_b16 v[50:51], v220 offset:9216
  s_waitcnt lgkmcnt(7)
  v_mfma_f32_32x32x16_bf16 v[96:111], v[44:47], v[68:71], v[96:111]
  ds_read_b64_tr_b16 v[52:53], v221 offset:8192
  ds_read_b64_tr_b16 v[54:55], v221 offset:9216
  s_waitcnt lgkmcnt(7)
  v_mfma_f32_32x32x16_bf16 v[112:127], v[44:47], v[72:75], v[112:127]
  ds_read_b64_tr_b16 v[56:57], v222 offset:8192
  ds_read_b64_tr_b16 v[58:59], v222 offset:9216
  s_waitcnt lgkmcnt(7)
  v_mfma_f32_32x32x16_bf16 v[128:143], v[44:47], v[76:79], v[128:143]
  ds_read_b64_tr_b16 v[60:61], v223 offset:8192
  ds_read_b64_tr_b16 v[62:63], v223 offset:9216
  s_waitcnt lgkmcnt(6)
  v_mfma_f32_32x32x16_bf16 v[80:95], v[40:43], v[48:51], v[80:95]
  ds_read_b128 v[44:47], v215 offset:0
  ds_read_b64_tr_b16 v[64:65], v220 offset:12288
  ds_read_b64_tr_b16 v[66:67], v220 offset:13312
  s_waitcnt lgkmcnt(7)
  v_mfma_f32_32x32x16_bf16 v[96:111], v[40:43], v[52:55], v[96:111]
  ds_read_b64_tr_b16 v[68:69], v221 offset:12288
  ds_read_b64_tr_b16 v[70:71], v221 offset:13312
  s_waitcnt lgkmcnt(7)
  v_mfma_f32_32x32x16_bf16 v[112:127], v[40:43], v[56:59], v[112:127]
  ds_read_b64_tr_b16 v[72:73], v222 offset:12288
  ds_read_b64_tr_b16 v[74:75], v222 offset:13312
  s_waitcnt lgkmcnt(7)
  v_mfma_f32_32x32x16_bf16 v[128:143], v[40:43], v[60:63], v[128:143]
  ds_read_b64_tr_b16 v[76:77], v223 offset:12288
  ds_read_b64_tr_b16 v[78:79], v223 offset:13312
  s_barrier
  s_waitcnt lgkmcnt(6)
  v_mfma_f32_32x32x16_bf16 v[80:95], v[44:47], v[64:67], v[80:95]
  ds_read_b128 v[40:43], v212 offset:32768
  ds_read_b64_tr_b16 v[48:49], v220 offset:32768
  ds_read_b64_tr_b16 v[50:51], v220 offset:33792
  s_waitcnt lgkmcnt(7)
  v_mfma_f32_32x32x16_bf16 v[96:111], v[44:47], v[68:71], v[96:111]
  ds_read_b64_tr_b16 v[52:53], v221 offset:32768
  ds_read_b64_tr_b16 v[54:55], v221 offset:33792
  s_waitcnt lgkmcnt(7)
  v_mfma_f32_32x32x16_bf16 v[112:127], v[44:47], v[72:75], v[112:127]
  ds_read_b64_tr_b16 v[56:57], v222 offset:32768
  ds_read_b64_tr_b16 v[58:59], v222 offset:33792
  s_waitcnt lgkmcnt(7)
  v_mfma_f32_32x32x16_bf16 v[128:143], v[44:47], v[76:79], v[128:143]
  ds_read_b64_tr_b16 v[60:61], v223 offset:32768
  ds_read_b64_tr_b16 v[62:63], v223 offset:33792
  s_waitcnt lgkmcnt(6)
  v_mfma_f32_32x32x16_bf16 v[80:95], v[40:43], v[48:51], v[80:95]
  ds_read_b128 v[44:47], v213 offset:32768
  ds_read_b64_tr_b16 v[64:65], v220 offset:36864
  ds_read_b64_tr_b16 v[66:67], v220 offset:37888
  s_waitcnt lgkmcnt(7)
  v_mfma_f32_32x32x16_bf16 v[96:111], v[40:43], v[52:55], v[96:111]
  ds_read_b64_tr_b16 v[68:69], v221 offset:36864
  ds_read_b64_tr_b16 v[70:71], v221 offset:37888
  s_waitcnt lgkmcnt(7)
  v_mfma_f32_32x32x16_bf16 v[112:127], v[40:43], v[56:59], v[112:127]
  ds_read_b64_tr_b16 v[72:73], v222 offset:36864
  ds_read_b64_tr_b16 v[74:75], v222 offset:37888
  s_waitcnt lgkmcnt(7)
  v_mfma_f32_32x32x16_bf16 v[128:143], v[40:43], v[60:63], v[128:143]
  ds_read_b64_tr_b16 v[76:77], v223 offset:36864
  ds_read_b64_tr_b16 v[78:79], v223 offset:37888
  s_waitcnt lgkmcnt(6)
  v_mfma_f32_32x32x16_bf16 v[80:95], v[44:47], v[64:67], v[80:95]
  ds_read_b128 v[40:43], v214 offset:32768
  ds_read_b64_tr_b16 v[48:49], v220 offset:40960
  ds_read_b64_tr_b16 v[50:51], v220 offset:41984
  s_waitcnt lgkmcnt(7)
  v_mfma_f32_32x32x16_bf16 v[96:111], v[44:47], v[68:71], v[96:111]
  ds_read_b64_tr_b16 v[52:53], v221 offset:40960
  ds_read_b64_tr_b16 v[54:55], v221 offset:41984
  s_waitcnt lgkmcnt(7)
  v_mfma_f32_32x32x16_bf16 v[112:127], v[44:47], v[72:75], v[112:127]
  ds_read_b64_tr_b16 v[56:57], v222 offset:40960
  ds_read_b64_tr_b16 v[58:59], v222 offset:41984
  s_waitcnt lgkmcnt(7)
  v_mfma_f32_32x32x16_bf16 v[128:143], v[44:47], v[76:79], v[128:143]
  ds_read_b64_tr_b16 v[60:61], v223 offset:40960
  ds_read_b64_tr_b16 v[62:63], v223 offset:41984
  s_waitcnt lgkmcnt(6)
  v_mfma_f32_32x32x16_bf16 v[80:95], v[40:43], v[48:51], v[80:95]
  ds_read_b128 v[44:47], v215 offset:32768
  ds_read_b64_tr_b16 v[64:65], v220 offset:45056
  ds_read_b64_tr_b16 v[66:67], v220 offset:46080
  s_waitcnt lgkmcnt(7)
  v_mfma_f32_32x32x16_bf16 v[96:111], v[40:43], v[52:55], v[96:111]
  ds_read_b64_tr_b16 v[68:69], v221 offset:45056
  ds_read_b64_tr_b16 v[70:71], v221 offset:46080
  s_waitcnt lgkmcnt(7)
  v_mfma_f32_32x32x16_bf16 v[112:127], v[40:43], v[56:59], v[112:127]
  ds_read_b64_tr_b16 v[72:73], v222 offset:45056
  ds_read_b64_tr_b16 v[74:75], v222 offset:46080
  s_waitcnt lgkmcnt(7)
  v_mfma_f32_32x32x16_bf16 v[128:143], v[40:43], v[60:63], v[128:143]
  ds_read_b64_tr_b16 v[76:77], v223 offset:45056
  ds_read_b64_tr_b16 v[78:79], v223 offset:46080
  s_barrier
  s_waitcnt lgkmcnt(6)
  v_mfma_f32_32x32x16_bf16 v[80:95], v[44:47], v[64:67], v[80:95]
  ds_read_b128 v[40:43], v216 offset:0
  ds_read_b64_tr_b16 v[48:49], v224 offset:0
  ds_read_b64_tr_b16 v[50:51], v224 offset:1024
  s_waitcnt lgkmcnt(7)
  v_mfma_f32_32x32x16_bf16 v[96:111], v[44:47], v[68:71], v[96:111]
  ds_read_b64_tr_b16 v[52:53], v225 offset:0
  ds_read_b64_tr_b16 v[54:55], v225 offset:1024
  s_waitcnt lgkmcnt(7)
  v_mfma_f32_32x32x16_bf16 v[112:127], v[44:47], v[72:75], v[112:127]
  ds_read_b64_tr_b16 v[56:57], v226 offset:0
  ds_read_b64_tr_b16 v[58:59], v226 offset:1024
  s_waitcnt lgkmcnt(7)
  v_mfma_f32_32x32x16_bf16 v[128:143], v[44:47], v[76:79], v[128:143]
  ds_read_b64_tr_b16 v[60:61], v227 offset:0
  ds_read_b64_tr_b16 v[62:63], v227 offset:1024
  s_waitcnt lgkmcnt(6)
  v_mfma_f32_32x32x16_bf16 v[80:95], v[40:43], v[48:51], v[80:95]
  ds_read_b128 v[44:47], v217 offset:0
  ds_read_b64_tr_b16 v[64:65], v224 offset:4096
  ds_read_b64_tr_b16 v[66:67], v224 offset:5120
  s_waitcnt lgkmcnt(7)
  v_mfma_f32_32x32x16_bf16 v[96:111], v[40:43], v[52:55], v[96:111]
  ds_read_b64_tr_b16 v[68:69], v225 offset:4096
  ds_read_b64_tr_b16 v[70:71], v225 offset:5120
  s_waitcnt lgkmcnt(7)
  v_mfma_f32_32x32x16_bf16 v[112:127], v[40:43], v[56:59], v[112:127]
  ds_read_b64_tr_b16 v[72:73], v226 offset:4096
  ds_read_b64_tr_b16 v[74:75], v226 offset:5120
  s_waitcnt lgkmcnt(7)
  v_mfma_f32_32x32x16_bf16 v[128:143], v[40:43], v[60:63], v[128:143]
  ds_read_b64_tr_b16 v[76:77], v227 offset:4096
  ds_read_b64_tr_b16 v[78:79], v227 offset:5120
  s_waitcnt lgkmcnt(6)
  v_mfma_f32_32x32x16_bf16 v[80:95], v[44:47], v[64:67], v[80:95]
  ds_read_b128 v[40:43], v218 offset:0
  ds_read_b64_tr_b16 v[48:49], v224 offset:8192
  ds_read_b64_tr_b16 v[50:51], v224 offset:9216
  s_waitcnt lgkmcnt(7)
  v_mfma_f32_32x32x16_bf16 v[96:111], v[44:47], v[68:71], v[96:111]
  ds_read_b64_tr_b16 v[52:53], v225 offset:8192
  ds_read_b64_tr_b16 v[54:55], v225 offset:9216
  s_waitcnt lgkmcnt(7)
  v_mfma_f32_32x32x16_bf16 v[112:127], v[44:47], v[72:75], v[112:127]
  ds_read_b64_tr_b16 v[56:57], v226 offset:8192
  ds_read_b64_tr_b16 v[58:59], v226 offset:9216
  s_waitcnt lgkmcnt(7)
  v_mfma_f32_32x32x16_bf16 v[128:143], v[44:47], v[76:79], v[128:143]
  ds_read_b64_tr_b16 v[60:61], v227 offset:8192
  ds_read_b64_tr_b16 v[62:63], v227 offset:9216
  s_waitcnt lgkmcnt(6)
  v_mfma_f32_32x32x16_bf16 v[80:95], v[40:43], v[48:51], v[80:95]
  ds_read_b128 v[44:47], v219 offset:0
  ds_read_b64_tr_b16 v[64:65], v224 offset:12288
  ds_read_b64_tr_b16 v[66:67], v224 offset:13312
  s_waitcnt lgkmcnt(7)
  v_mfma_f32_32x32x16_bf16 v[96:111], v[40:43], v[52:55], v[96:111]
  ds_read_b64_tr_b16 v[68:69], v225 offset:12288
  ds_read_b64_tr_b16 v[70:71], v225 offset:13312
  s_waitcnt lgkmcnt(7)
  v_mfma_f32_32x32x16_bf16 v[112:127], v[40:43], v[56:59], v[112:127]
  ds_read_b64_tr_b16 v[72:73], v226 offset:12288
  ds_read_b64_tr_b16 v[74:75], v226 offset:13312
  s_waitcnt lgkmcnt(7)
  v_mfma_f32_32x32x16_bf16 v[128:143], v[40:43], v[60:63], v[128:143]
  ds_read_b64_tr_b16 v[76:77], v227 offset:12288
  ds_read_b64_tr_b16 v[78:79], v227 offset:13312
  s_barrier
  s_waitcnt lgkmcnt(6)
  v_mfma_f32_32x32x16_bf16 v[80:95], v[44:47], v[64:67], v[80:95]
  ds_read_b128 v[40:43], v216 offset:32768
  ds_read_b64_tr_b16 v[48:49], v224 offset:32768
  ds_read_b64_tr_b16 v[50:51], v224 offset:33792
  s_waitcnt lgkmcnt(7)
  v_mfma_f32_32x32x16_bf16 v[96:111], v[44:47], v[68:71], v[96:111]
  ds_read_b64_tr_b16 v[52:53], v225 offset:32768
  ds_read_b64_tr_b16 v[54:55], v225 offset:33792
  s_waitcnt lgkmcnt(7)
  v_mfma_f32_32x32x16_bf16 v[112:127], v[44:47], v[72:75], v[112:127]
  ds_read_b64_tr_b16 v[56:57], v226 offset:32768
  ds_read_b64_tr_b16 v[58:59], v226 offset:33792
  s_waitcnt lgkmcnt(7)
  v_mfma_f32_32x32x16_bf16 v[128:143], v[44:47], v[76:79], v[128:143]
  ds_read_b64_tr_b16 v[60:61], v227 offset:32768
  ds_read_b64_tr_b16 v[62:63], v227 offset:33792
  s_waitcnt lgkmcnt(6)
  v_mfma_f32_32x32x16_bf16 v[80:95], v[40:43], v[48:51], v[80:95]
  ds_read_b128 v[44:47], v217 offset:32768
  ds_read_b64_tr_b16 v[64:65], v224 offset:36864
  ds_read_b64_tr_b16 v[66:67], v224 offset:37888
  s_waitcnt lgkmcnt(7)
  v_mfma_f32_32x32x16_bf16 v[96:111], v[40:43], v[52:55], v[96:111]
  ds_read_b64_tr_b16 v[68:69], v225 offset:36864
  ds_read_b64_tr_b16 v[70:71], v225 offset:37888
  s_waitcnt lgkmcnt(7)
  v_mfma_f32_32x32x16_bf16 v[112:127], v[40:43], v[56:59], v[112:127]
  ds_read_b64_tr_b16 v[72:73], v226 offset:36864
  ds_read_b64_tr_b16 v[74:75], v226 offset:37888
  s_waitcnt lgkmcnt(7)
  v_mfma_f32_32x32x16_bf16 v[128:143], v[40:43], v[60:63], v[128:143]
  ds_read_b64_tr_b16 v[76:77], v227 offset:36864
  ds_read_b64_tr_b16 v[78:79], v227 offset:37888
  s_waitcnt lgkmcnt(6)
  v_mfma_f32_32x32x16_bf16 v[80:95], v[44:47], v[64:67], v[80:95]
  ds_read_b128 v[40:43], v218 offset:32768
  ds_read_b64_tr_b16 v[48:49], v224 offset:40960
  ds_read_b64_tr_b16 v[50:51], v224 offset:41984
  s_waitcnt lgkmcnt(7)
  v_mfma_f32_32x32x16_bf16 v[96:111], v[44:47], v[68:71], v[96:111]
  ds_read_b64_tr_b16 v[52:53], v225 offset:40960
  ds_read_b64_tr_b16 v[54:55], v225 offset:41984
  s_waitcnt lgkmcnt(7)
  v_mfma_f32_32x32x16_bf16 v[112:127], v[44:47], v[72:75], v[112:127]
  ds_read_b64_tr_b16 v[56:57], v226 offset:40960
  ds_read_b64_tr_b16 v[58:59], v226 offset:41984
  s_waitcnt lgkmcnt(7)
  v_mfma_f32_32x32x16_bf16 v[128:143], v[44:47], v[76:79], v[128:143]
  ds_read_b64_tr_b16 v[60:61], v227 offset:40960
  ds_read_b64_tr_b16 v[62:63], v227 offset:41984
  s_waitcnt lgkmcnt(6)
  v_mfma_f32_32x32x16_bf16 v[80:95], v[40:43], v[48:51], v[80:95]
  ds_read_b128 v[44:47], v219 offset:32768
  ds_read_b64_tr_b16 v[64:65], v224 offset:45056
  ds_read_b64_tr_b16 v[66:67], v224 offset:46080
  s_waitcnt lgkmcnt(7)
  v_mfma_f32_32x32x16_bf16 v[96:111], v[40:43], v[52:55], v[96:111]
  ds_read_b64_tr_b16 v[68:69], v225 offset:45056
  ds_read_b64_tr_b16 v[70:71], v225 offset:46080
  s_waitcnt lgkmcnt(7)
  v_mfma_f32_32x32x16_bf16 v[112:127], v[40:43], v[56:59], v[112:127]
  ds_read_b64_tr_b16 v[72:73], v226 offset:45056
  ds_read_b64_tr_b16 v[74:75], v226 offset:46080
  s_waitcnt lgkmcnt(7)
  v_mfma_f32_32x32x16_bf16 v[128:143], v[40:43], v[60:63], v[128:143]
  ds_read_b64_tr_b16 v[76:77], v227 offset:45056
  ds_read_b64_tr_b16 v[78:79], v227 offset:46080
  s_barrier
  s_waitcnt lgkmcnt(6)
  v_mfma_f32_32x32x16_bf16 v[80:95], v[44:47], v[64:67], v[80:95]
  ds_read_b128 v[40:43], v212 offset:0
  ds_read_b64_tr_b16 v[48:49], v220 offset:0
  ds_read_b64_tr_b16 v[50:51], v220 offset:1024
  s_waitcnt lgkmcnt(7)
  v_mfma_f32_32x32x16_bf16 v[96:111], v[44:47], v[68:71], v[96:111]
  ds_read_b64_tr_b16 v[52:53], v221 offset:0
  ds_read_b64_tr_b16 v[54:55], v221 offset:1024
  s_waitcnt lgkmcnt(7)
  v_mfma_f32_32x32x16_bf16 v[112:127], v[44:47], v[72:75], v[112:127]
  ds_read_b64_tr_b16 v[56:57], v222 offset:0
  ds_read_b64_tr_b16 v[58:59], v222 offset:1024
  s_waitcnt lgkmcnt(7)
  v_mfma_f32_32x32x16_bf16 v[128:143], v[44:47], v[76:79], v[128:143]
  ds_read_b64_tr_b16 v[60:61], v223 offset:0
  ds_read_b64_tr_b16 v[62:63], v223 offset:1024
  s_waitcnt lgkmcnt(6)
  v_mfma_f32_32x32x16_bf16 v[80:95], v[40:43], v[48:51], v[80:95]
  ds_read_b128 v[44:47], v213 offset:0
  ds_read_b64_tr_b16 v[64:65], v220 offset:4096
  ds_read_b64_tr_b16 v[66:67], v220 offset:5120
  s_waitcnt lgkmcnt(7)
  v_mfma_f32_32x32x16_bf16 v[96:111], v[40:43], v[52:55], v[96:111]
  ds_read_b64_tr_b16 v[68:69], v221 offset:4096
  ds_read_b64_tr_b16 v[70:71], v221 offset:5120
  s_waitcnt lgkmcnt(7)
  v_mfma_f32_32x32x16_bf16 v[112:127], v[40:43], v[56:59], v[112:127]
  ds_read_b64_tr_b16 v[72:73], v222 offset:4096
  ds_read_b64_tr_b16 v[74:75], v222 offset:5120
  s_waitcnt lgkmcnt(7)
  v_mfma_f32_32x32x16_bf16 v[128:143], v[40:43], v[60:63], v[128:143]
  ds_read_b64_tr_b16 v[76:77], v223 offset:4096
  ds_read_b64_tr_b16 v[78:79], v223 offset:5120
  s_waitcnt lgkmcnt(6)
  v_mfma_f32_32x32x16_bf16 v[80:95], v[44:47], v[64:67], v[80:95]
  ds_read_b128 v[40:43], v214 offset:0
  ds_read_b64_tr_b16 v[48:49], v220 offset:8192
  ds_read_b64_tr_b16 v[50:51], v220 offset:9216
  s_waitcnt lgkmcnt(7)
  v_mfma_f32_32x32x16_bf16 v[96:111], v[44:47], v[68:71], v[96:111]
  ds_read_b64_tr_b16 v[52:53], v221 offset:8192
  ds_read_b64_tr_b16 v[54:55], v221 offset:9216
  s_waitcnt lgkmcnt(7)
  v_mfma_f32_32x32x16_bf16 v[112:127], v[44:47], v[72:75], v[112:127]
  ds_read_b64_tr_b16 v[56:57], v222 offset:8192
  ds_read_b64_tr_b16 v[58:59], v222 offset:9216
  s_waitcnt lgkmcnt(7)
  v_mfma_f32_32x32x16_bf16 v[128:143], v[44:47], v[76:79], v[128:143]
  ds_read_b64_tr_b16 v[60:61], v223 offset:8192
  ds_read_b64_tr_b16 v[62:63], v223 offset:9216
  s_waitcnt lgkmcnt(6)
  v_mfma_f32_32x32x16_bf16 v[80:95], v[40:43], v[48:51], v[80:95]
  ds_read_b128 v[44:47], v215 offset:0
  ds_read_b64_tr_b16 v[64:65], v220 offset:12288
  ds_read_b64_tr_b16 v[66:67], v220 offset:13312
  s_waitcnt lgkmcnt(7)
  v_mfma_f32_32x32x16_bf16 v[96:111], v[40:43], v[52:55], v[96:111]
  ds_read_b64_tr_b16 v[68:69], v221 offset:12288
  ds_read_b64_tr_b16 v[70:71], v221 offset:13312
  s_waitcnt lgkmcnt(7)
  v_mfma_f32_32x32x16_bf16 v[112:127], v[40:43], v[56:59], v[112:127]
  ds_read_b64_tr_b16 v[72:73], v222 offset:12288
  ds_read_b64_tr_b16 v[74:75], v222 offset:13312
  s_waitcnt lgkmcnt(7)
  v_mfma_f32_32x32x16_bf16 v[128:143], v[40:43], v[60:63], v[128:143]
  ds_read_b64_tr_b16 v[76:77], v223 offset:12288
  ds_read_b64_tr_b16 v[78:79], v223 offset:13312
  s_barrier
  s_waitcnt lgkmcnt(6)
  v_mfma_f32_32x32x16_bf16 v[80:95], v[44:47], v[64:67], v[80:95]
  ds_read_b128 v[40:43], v212 offset:32768
  ds_read_b64_tr_b16 v[48:49], v220 offset:32768
  ds_read_b64_tr_b16 v[50:51], v220 offset:33792
  s_waitcnt lgkmcnt(7)
  v_mfma_f32_32x32x16_bf16 v[96:111], v[44:47], v[68:71], v[96:111]
  ds_read_b64_tr_b16 v[52:53], v221 offset:32768
  ds_read_b64_tr_b16 v[54:55], v221 offset:33792
  s_waitcnt lgkmcnt(7)
  v_mfma_f32_32x32x16_bf16 v[112:127], v[44:47], v[72:75], v[112:127]
  ds_read_b64_tr_b16 v[56:57], v222 offset:32768
  ds_read_b64_tr_b16 v[58:59], v222 offset:33792
  s_waitcnt lgkmcnt(7)
  v_mfma_f32_32x32x16_bf16 v[128:143], v[44:47], v[76:79], v[128:143]
  ds_read_b64_tr_b16 v[60:61], v223 offset:32768
  ds_read_b64_tr_b16 v[62:63], v223 offset:33792
  s_waitcnt lgkmcnt(6)
  v_mfma_f32_32x32x16_bf16 v[80:95], v[40:43], v[48:51], v[80:95]
  ds_read_b128 v[44:47], v213 offset:32768
  ds_read_b64_tr_b16 v[64:65], v220 offset:36864
  ds_read_b64_tr_b16 v[66:67], v220 offset:37888
  s_waitcnt lgkmcnt(7)
  v_mfma_f32_32x32x16_bf16 v[96:111], v[40:43], v[52:55], v[96:111]
  ds_read_b64_tr_b16 v[68:69], v221 offset:36864
  ds_read_b64_tr_b16 v[70:71], v221 offset:37888
  s_waitcnt lgkmcnt(7)
  v_mfma_f32_32x32x16_bf16 v[112:127], v[40:43], v[56:59], v[112:127]
  ds_read_b64_tr_b16 v[72:73], v222 offset:36864
  ds_read_b64_tr_b16 v[74:75], v222 offset:37888
  s_waitcnt lgkmcnt(7)
  v_mfma_f32_32x32x16_bf16 v[128:143], v[40:43], v[60:63], v[128:143]
  ds_read_b64_tr_b16 v[76:77], v223 offset:36864
  ds_read_b64_tr_b16 v[78:79], v223 offset:37888
  s_waitcnt lgkmcnt(6)
  v_mfma_f32_32x32x16_bf16 v[80:95], v[44:47], v[64:67], v[80:95]
  ds_read_b128 v[40:43], v214 offset:32768
  ds_read_b64_tr_b16 v[48:49], v220 offset:40960
  ds_read_b64_tr_b16 v[50:51], v220 offset:41984
  s_waitcnt lgkmcnt(7)
  v_mfma_f32_32x32x16_bf16 v[96:111], v[44:47], v[68:71], v[96:111]
  ds_read_b64_tr_b16 v[52:53], v221 offset:40960
  ds_read_b64_tr_b16 v[54:55], v221 offset:41984
  s_waitcnt lgkmcnt(7)
  v_mfma_f32_32x32x16_bf16 v[112:127], v[44:47], v[72:75], v[112:127]
  ds_read_b64_tr_b16 v[56:57], v222 offset:40960
  ds_read_b64_tr_b16 v[58:59], v222 offset:41984
  s_waitcnt lgkmcnt(7)
  v_mfma_f32_32x32x16_bf16 v[128:143], v[44:47], v[76:79], v[128:143]
  ds_read_b64_tr_b16 v[60:61], v223 offset:40960
  ds_read_b64_tr_b16 v[62:63], v223 offset:41984
  s_waitcnt lgkmcnt(6)
  v_mfma_f32_32x32x16_bf16 v[80:95], v[40:43], v[48:51], v[80:95]
  ds_read_b128 v[44:47], v215 offset:32768
  ds_read_b64_tr_b16 v[64:65], v220 offset:45056
  ds_read_b64_tr_b16 v[66:67], v220 offset:46080
  s_waitcnt lgkmcnt(7)
  v_mfma_f32_32x32x16_bf16 v[96:111], v[40:43], v[52:55], v[96:111]
  ds_read_b64_tr_b16 v[68:69], v221 offset:45056
  ds_read_b64_tr_b16 v[70:71], v221 offset:46080
  s_waitcnt lgkmcnt(7)
  v_mfma_f32_32x32x16_bf16 v[112:127], v[40:43], v[56:59], v[112:127]
  ds_read_b64_tr_b16 v[72:73], v222 offset:45056
  ds_read_b64_tr_b16 v[74:75], v222 offset:46080
  s_waitcnt lgkmcnt(7)
  v_mfma_f32_32x32x16_bf16 v[128:143], v[40:43], v[60:63], v[128:143]
  ds_read_b64_tr_b16 v[76:77], v223 offset:45056
  ds_read_b64_tr_b16 v[78:79], v223 offset:46080
  s_barrier
  s_waitcnt lgkmcnt(6)
  v_mfma_f32_32x32x16_bf16 v[80:95], v[44:47], v[64:67], v[80:95]
  ds_read_b128 v[40:43], v216 offset:0
  ds_read_b64_tr_b16 v[48:49], v224 offset:0
  ds_read_b64_tr_b16 v[50:51], v224 offset:1024
  s_waitcnt lgkmcnt(7)
  v_mfma_f32_32x32x16_bf16 v[96:111], v[44:47], v[68:71], v[96:111]
  ds_read_b64_tr_b16 v[52:53], v225 offset:0
  ds_read_b64_tr_b16 v[54:55], v225 offset:1024
  s_waitcnt lgkmcnt(7)
  v_mfma_f32_32x32x16_bf16 v[112:127], v[44:47], v[72:75], v[112:127]
  ds_read_b64_tr_b16 v[56:57], v226 offset:0
  ds_read_b64_tr_b16 v[58:59], v226 offset:1024
  s_waitcnt lgkmcnt(7)
  v_mfma_f32_32x32x16_bf16 v[128:143], v[44:47], v[76:79], v[128:143]
  ds_read_b64_tr_b16 v[60:61], v227 offset:0
  ds_read_b64_tr_b16 v[62:63], v227 offset:1024
  s_waitcnt lgkmcnt(6)
  v_mfma_f32_32x32x16_bf16 v[80:95], v[40:43], v[48:51], v[80:95]
  ds_read_b128 v[44:47], v217 offset:0
  ds_read_b64_tr_b16 v[64:65], v224 offset:4096
  ds_read_b64_tr_b16 v[66:67], v224 offset:5120
  s_waitcnt lgkmcnt(7)
  v_mfma_f32_32x32x16_bf16 v[96:111], v[40:43], v[52:55], v[96:111]
  ds_read_b64_tr_b16 v[68:69], v225 offset:4096
  ds_read_b64_tr_b16 v[70:71], v225 offset:5120
  s_waitcnt lgkmcnt(7)
  v_mfma_f32_32x32x16_bf16 v[112:127], v[40:43], v[56:59], v[112:127]
  ds_read_b64_tr_b16 v[72:73], v226 offset:4096
  ds_read_b64_tr_b16 v[74:75], v226 offset:5120
  s_waitcnt lgkmcnt(7)
  v_mfma_f32_32x32x16_bf16 v[128:143], v[40:43], v[60:63], v[128:143]
  ds_read_b64_tr_b16 v[76:77], v227 offset:4096
  ds_read_b64_tr_b16 v[78:79], v227 offset:5120
  s_waitcnt lgkmcnt(6)
  v_mfma_f32_32x32x16_bf16 v[80:95], v[44:47], v[64:67], v[80:95]
  ds_read_b128 v[40:43], v218 offset:0
  ds_read_b64_tr_b16 v[48:49], v224 offset:8192
  ds_read_b64_tr_b16 v[50:51], v224 offset:9216
  s_waitcnt lgkmcnt(7)
  v_mfma_f32_32x32x16_bf16 v[96:111], v[44:47], v[68:71], v[96:111]
  ds_read_b64_tr_b16 v[52:53], v225 offset:8192
  ds_read_b64_tr_b16 v[54:55], v225 offset:9216
  s_waitcnt lgkmcnt(7)
  v_mfma_f32_32x32x16_bf16 v[112:127], v[44:47], v[72:75], v[112:127]
  ds_read_b64_tr_b16 v[56:57], v226 offset:8192
  ds_read_b64_tr_b16 v[58:59], v226 offset:9216
  s_waitcnt lgkmcnt(7)
  v_mfma_f32_32x32x16_bf16 v[128:143], v[44:47], v[76:79], v[128:143]
  ds_read_b64_tr_b16 v[60:61], v227 offset:8192
  ds_read_b64_tr_b16 v[62:63], v227 offset:9216
  s_waitcnt lgkmcnt(6)
  v_mfma_f32_32x32x16_bf16 v[80:95], v[40:43], v[48:51], v[80:95]
  ds_read_b128 v[44:47], v219 offset:0
  ds_read_b64_tr_b16 v[64:65], v224 offset:12288
  ds_read_b64_tr_b16 v[66:67], v224 offset:13312
  s_waitcnt lgkmcnt(7)
  v_mfma_f32_32x32x16_bf16 v[96:111], v[40:43], v[52:55], v[96:111]
  ds_read_b64_tr_b16 v[68:69], v225 offset:12288
  ds_read_b64_tr_b16 v[70:71], v225 offset:13312
  s_waitcnt lgkmcnt(7)
  v_mfma_f32_32x32x16_bf16 v[112:127], v[40:43], v[56:59], v[112:127]
  ds_read_b64_tr_b16 v[72:73], v226 offset:12288
  ds_read_b64_tr_b16 v[74:75], v226 offset:13312
  s_waitcnt lgkmcnt(7)
  v_mfma_f32_32x32x16_bf16 v[128:143], v[40:43], v[60:63], v[128:143]
  ds_read_b64_tr_b16 v[76:77], v227 offset:12288
  ds_read_b64_tr_b16 v[78:79], v227 offset:13312
  s_barrier
  s_waitcnt lgkmcnt(6)
  v_mfma_f32_32x32x16_bf16 v[80:95], v[44:47], v[64:67], v[80:95]
  ds_read_b128 v[40:43], v216 offset:32768
  ds_read_b64_tr_b16 v[48:49], v224 offset:32768
  ds_read_b64_tr_b16 v[50:51], v224 offset:33792
  s_waitcnt lgkmcnt(7)
  v_mfma_f32_32x32x16_bf16 v[96:111], v[44:47], v[68:71], v[96:111]
  ds_read_b64_tr_b16 v[52:53], v225 offset:32768
  ds_read_b64_tr_b16 v[54:55], v225 offset:33792
  s_waitcnt lgkmcnt(7)
  v_mfma_f32_32x32x16_bf16 v[112:127], v[44:47], v[72:75], v[112:127]
  ds_read_b64_tr_b16 v[56:57], v226 offset:32768
  ds_read_b64_tr_b16 v[58:59], v226 offset:33792
  s_waitcnt lgkmcnt(7)
  v_mfma_f32_32x32x16_bf16 v[128:143], v[44:47], v[76:79], v[128:143]
  ds_read_b64_tr_b16 v[60:61], v227 offset:32768
  ds_read_b64_tr_b16 v[62:63], v227 offset:33792
  s_waitcnt lgkmcnt(6)
  v_mfma_f32_32x32x16_bf16 v[80:95], v[40:43], v[48:51], v[80:95]
  ds_read_b128 v[44:47], v217 offset:32768
  ds_read_b64_tr_b16 v[64:65], v224 offset:36864
  ds_read_b64_tr_b16 v[66:67], v224 offset:37888
  s_waitcnt lgkmcnt(7)
  v_mfma_f32_32x32x16_bf16 v[96:111], v[40:43], v[52:55], v[96:111]
  ds_read_b64_tr_b16 v[68:69], v225 offset:36864
  ds_read_b64_tr_b16 v[70:71], v225 offset:37888
  s_waitcnt lgkmcnt(7)
  v_mfma_f32_32x32x16_bf16 v[112:127], v[40:43], v[56:59], v[112:127]
  ds_read_b64_tr_b16 v[72:73], v226 offset:36864
  ds_read_b64_tr_b16 v[74:75], v226 offset:37888
  s_waitcnt lgkmcnt(7)
  v_mfma_f32_32x32x16_bf16 v[128:143], v[40:43], v[60:63], v[128:143]
  ds_read_b64_tr_b16 v[76:77], v227 offset:36864
  ds_read_b64_tr_b16 v[78:79], v227 offset:37888
  s_waitcnt lgkmcnt(6)
  v_mfma_f32_32x32x16_bf16 v[80:95], v[44:47], v[64:67], v[80:95]
  ds_read_b128 v[40:43], v218 offset:32768
  ds_read_b64_tr_b16 v[48:49], v224 offset:40960
  ds_read_b64_tr_b16 v[50:51], v224 offset:41984
  s_waitcnt lgkmcnt(7)
  v_mfma_f32_32x32x16_bf16 v[96:111], v[44:47], v[68:71], v[96:111]
  ds_read_b64_tr_b16 v[52:53], v225 offset:40960
  ds_read_b64_tr_b16 v[54:55], v225 offset:41984
  s_waitcnt lgkmcnt(7)
  v_mfma_f32_32x32x16_bf16 v[112:127], v[44:47], v[72:75], v[112:127]
  ds_read_b64_tr_b16 v[56:57], v226 offset:40960
  ds_read_b64_tr_b16 v[58:59], v226 offset:41984
  s_waitcnt lgkmcnt(7)
  v_mfma_f32_32x32x16_bf16 v[128:143], v[44:47], v[76:79], v[128:143]
  ds_read_b64_tr_b16 v[60:61], v227 offset:40960
  ds_read_b64_tr_b16 v[62:63], v227 offset:41984
  s_waitcnt lgkmcnt(6)
  v_mfma_f32_32x32x16_bf16 v[80:95], v[40:43], v[48:51], v[80:95]
  ds_read_b128 v[44:47], v219 offset:32768
  ds_read_b64_tr_b16 v[64:65], v224 offset:45056
  ds_read_b64_tr_b16 v[66:67], v224 offset:46080
  s_waitcnt lgkmcnt(7)
  v_mfma_f32_32x32x16_bf16 v[96:111], v[40:43], v[52:55], v[96:111]
  ds_read_b64_tr_b16 v[68:69], v225 offset:45056
  ds_read_b64_tr_b16 v[70:71], v225 offset:46080
  s_waitcnt lgkmcnt(7)
  v_mfma_f32_32x32x16_bf16 v[112:127], v[40:43], v[56:59], v[112:127]
  ds_read_b64_tr_b16 v[72:73], v226 offset:45056
  ds_read_b64_tr_b16 v[74:75], v226 offset:46080
  s_waitcnt lgkmcnt(7)
  v_mfma_f32_32x32x16_bf16 v[128:143], v[40:43], v[60:63], v[128:143]
  ds_read_b64_tr_b16 v[76:77], v227 offset:45056
  ds_read_b64_tr_b16 v[78:79], v227 offset:46080
  s_barrier
  s_waitcnt lgkmcnt(6)
  v_mfma_f32_32x32x16_bf16 v[80:95], v[44:47], v[64:67], v[80:95]
  ds_read_b128 v[40:43], v212 offset:0
  ds_read_b64_tr_b16 v[48:49], v220 offset:0
  ds_read_b64_tr_b16 v[50:51], v220 offset:1024
  s_waitcnt lgkmcnt(7)
  v_mfma_f32_32x32x16_bf16 v[96:111], v[44:47], v[68:71], v[96:111]
  ds_read_b64_tr_b16 v[52:53], v221 offset:0
  ds_read_b64_tr_b16 v[54:55], v221 offset:1024
  s_waitcnt lgkmcnt(7)
  v_mfma_f32_32x32x16_bf16 v[112:127], v[44:47], v[72:75], v[112:127]
  ds_read_b64_tr_b16 v[56:57], v222 offset:0
  ds_read_b64_tr_b16 v[58:59], v222 offset:1024
  s_waitcnt lgkmcnt(7)
  v_mfma_f32_32x32x16_bf16 v[128:143], v[44:47], v[76:79], v[128:143]
  ds_read_b64_tr_b16 v[60:61], v223 offset:0
  ds_read_b64_tr_b16 v[62:63], v223 offset:1024
  s_waitcnt lgkmcnt(6)
  v_mfma_f32_32x32x16_bf16 v[80:95], v[40:43], v[48:51], v[80:95]
  ds_read_b128 v[44:47], v213 offset:0
  ds_read_b64_tr_b16 v[64:65], v220 offset:4096
  ds_read_b64_tr_b16 v[66:67], v220 offset:5120
  s_waitcnt lgkmcnt(7)
  v_mfma_f32_32x32x16_bf16 v[96:111], v[40:43], v[52:55], v[96:111]
  ds_read_b64_tr_b16 v[68:69], v221 offset:4096
  ds_read_b64_tr_b16 v[70:71], v221 offset:5120
  s_waitcnt lgkmcnt(7)
  v_mfma_f32_32x32x16_bf16 v[112:127], v[40:43], v[56:59], v[112:127]
  ds_read_b64_tr_b16 v[72:73], v222 offset:4096
  ds_read_b64_tr_b16 v[74:75], v222 offset:5120
  s_waitcnt lgkmcnt(7)
  v_mfma_f32_32x32x16_bf16 v[128:143], v[40:43], v[60:63], v[128:143]
  ds_read_b64_tr_b16 v[76:77], v223 offset:4096
  ds_read_b64_tr_b16 v[78:79], v223 offset:5120
  s_waitcnt lgkmcnt(6)
  v_mfma_f32_32x32x16_bf16 v[80:95], v[44:47], v[64:67], v[80:95]
  ds_read_b128 v[40:43], v214 offset:0
  ds_read_b64_tr_b16 v[48:49], v220 offset:8192
  ds_read_b64_tr_b16 v[50:51], v220 offset:9216
  s_waitcnt lgkmcnt(7)
  v_mfma_f32_32x32x16_bf16 v[96:111], v[44:47], v[68:71], v[96:111]
  ds_read_b64_tr_b16 v[52:53], v221 offset:8192
  ds_read_b64_tr_b16 v[54:55], v221 offset:9216
  s_waitcnt lgkmcnt(7)
  v_mfma_f32_32x32x16_bf16 v[112:127], v[44:47], v[72:75], v[112:127]
  ds_read_b64_tr_b16 v[56:57], v222 offset:8192
  ds_read_b64_tr_b16 v[58:59], v222 offset:9216
  s_waitcnt lgkmcnt(7)
  v_mfma_f32_32x32x16_bf16 v[128:143], v[44:47], v[76:79], v[128:143]
  ds_read_b64_tr_b16 v[60:61], v223 offset:8192
  ds_read_b64_tr_b16 v[62:63], v223 offset:9216
  s_waitcnt lgkmcnt(6)
  v_mfma_f32_32x32x16_bf16 v[80:95], v[40:43], v[48:51], v[80:95]
  ds_read_b128 v[44:47], v215 offset:0
  ds_read_b64_tr_b16 v[64:65], v220 offset:12288
  ds_read_b64_tr_b16 v[66:67], v220 offset:13312
  s_waitcnt lgkmcnt(7)
  v_mfma_f32_32x32x16_bf16 v[96:111], v[40:43], v[52:55], v[96:111]
  ds_read_b64_tr_b16 v[68:69], v221 offset:12288
  ds_read_b64_tr_b16 v[70:71], v221 offset:13312
  s_waitcnt lgkmcnt(7)
  v_mfma_f32_32x32x16_bf16 v[112:127], v[40:43], v[56:59], v[112:127]
  ds_read_b64_tr_b16 v[72:73], v222 offset:12288
  ds_read_b64_tr_b16 v[74:75], v222 offset:13312
  s_waitcnt lgkmcnt(7)
  v_mfma_f32_32x32x16_bf16 v[128:143], v[40:43], v[60:63], v[128:143]
  ds_read_b64_tr_b16 v[76:77], v223 offset:12288
  ds_read_b64_tr_b16 v[78:79], v223 offset:13312
  s_barrier
  s_waitcnt lgkmcnt(6)
  v_mfma_f32_32x32x16_bf16 v[80:95], v[44:47], v[64:67], v[80:95]
  ds_read_b128 v[40:43], v212 offset:32768
  ds_read_b64_tr_b16 v[48:49], v220 offset:32768
  ds_read_b64_tr_b16 v[50:51], v220 offset:33792
  s_waitcnt lgkmcnt(7)
  v_mfma_f32_32x32x16_bf16 v[96:111], v[44:47], v[68:71], v[96:111]
  ds_read_b64_tr_b16 v[52:53], v221 offset:32768
  ds_read_b64_tr_b16 v[54:55], v221 offset:33792
  s_waitcnt lgkmcnt(7)
  v_mfma_f32_32x32x16_bf16 v[112:127], v[44:47], v[72:75], v[112:127]
  ds_read_b64_tr_b16 v[56:57], v222 offset:32768
  ds_read_b64_tr_b16 v[58:59], v222 offset:33792
  s_waitcnt lgkmcnt(7)
  v_mfma_f32_32x32x16_bf16 v[128:143], v[44:47], v[76:79], v[128:143]
  ds_read_b64_tr_b16 v[60:61], v223 offset:32768
  ds_read_b64_tr_b16 v[62:63], v223 offset:33792
  s_waitcnt lgkmcnt(6)
  v_mfma_f32_32x32x16_bf16 v[80:95], v[40:43], v[48:51], v[80:95]
  ds_read_b128 v[44:47], v213 offset:32768
  ds_read_b64_tr_b16 v[64:65], v220 offset:36864
  ds_read_b64_tr_b16 v[66:67], v220 offset:37888
  s_waitcnt lgkmcnt(7)
  v_mfma_f32_32x32x16_bf16 v[96:111], v[40:43], v[52:55], v[96:111]
  ds_read_b64_tr_b16 v[68:69], v221 offset:36864
  ds_read_b64_tr_b16 v[70:71], v221 offset:37888
  s_waitcnt lgkmcnt(7)
  v_mfma_f32_32x32x16_bf16 v[112:127], v[40:43], v[56:59], v[112:127]
  ds_read_b64_tr_b16 v[72:73], v222 offset:36864
  ds_read_b64_tr_b16 v[74:75], v222 offset:37888
  s_waitcnt lgkmcnt(7)
  v_mfma_f32_32x32x16_bf16 v[128:143], v[40:43], v[60:63], v[128:143]
  ds_read_b64_tr_b16 v[76:77], v223 offset:36864
  ds_read_b64_tr_b16 v[78:79], v223 offset:37888
  s_waitcnt lgkmcnt(6)
  v_mfma_f32_32x32x16_bf16 v[80:95], v[44:47], v[64:67], v[80:95]
  ds_read_b128 v[40:43], v214 offset:32768
  ds_read_b64_tr_b16 v[48:49], v220 offset:40960
  ds_read_b64_tr_b16 v[50:51], v220 offset:41984
  s_waitcnt lgkmcnt(7)
  v_mfma_f32_32x32x16_bf16 v[96:111], v[44:47], v[68:71], v[96:111]
  ds_read_b64_tr_b16 v[52:53], v221 offset:40960
  ds_read_b64_tr_b16 v[54:55], v221 offset:41984
  s_waitcnt lgkmcnt(7)
  v_mfma_f32_32x32x16_bf16 v[112:127], v[44:47], v[72:75], v[112:127]
  ds_read_b64_tr_b16 v[56:57], v222 offset:40960
  ds_read_b64_tr_b16 v[58:59], v222 offset:41984
  s_waitcnt lgkmcnt(7)
  v_mfma_f32_32x32x16_bf16 v[128:143], v[44:47], v[76:79], v[128:143]
  ds_read_b64_tr_b16 v[60:61], v223 offset:40960
  ds_read_b64_tr_b16 v[62:63], v223 offset:41984
  s_waitcnt lgkmcnt(6)
  v_mfma_f32_32x32x16_bf16 v[80:95], v[40:43], v[48:51], v[80:95]
  ds_read_b128 v[44:47], v215 offset:32768
  ds_read_b64_tr_b16 v[64:65], v220 offset:45056
  ds_read_b64_tr_b16 v[66:67], v220 offset:46080
  s_waitcnt lgkmcnt(7)
  v_mfma_f32_32x32x16_bf16 v[96:111], v[40:43], v[52:55], v[96:111]
  ds_read_b64_tr_b16 v[68:69], v221 offset:45056
  ds_read_b64_tr_b16 v[70:71], v221 offset:46080
  s_waitcnt lgkmcnt(7)
  v_mfma_f32_32x32x16_bf16 v[112:127], v[40:43], v[56:59], v[112:127]
  ds_read_b64_tr_b16 v[72:73], v222 offset:45056
  ds_read_b64_tr_b16 v[74:75], v222 offset:46080
  s_waitcnt lgkmcnt(7)
  v_mfma_f32_32x32x16_bf16 v[128:143], v[40:43], v[60:63], v[128:143]
  ds_read_b64_tr_b16 v[76:77], v223 offset:45056
  ds_read_b64_tr_b16 v[78:79], v223 offset:46080
  s_waitcnt lgkmcnt(6)
  v_mfma_f32_32x32x16_bf16 v[80:95], v[44:47], v[64:67], v[80:95]
  s_waitcnt lgkmcnt(4)
  v_mfma_f32_32x32x16_bf16 v[96:111], v[44:47], v[68:71], v[96:111]
  s_waitcnt lgkmcnt(2)
  v_mfma_f32_32x32x16_bf16 v[112:127], v[44:47], v[72:75], v[112:127]
  s_waitcnt lgkmcnt(0)
  v_mfma_f32_32x32x16_bf16 v[128:143], v[44:47], v[76:79], v[128:143]
  s_nop 5
  v_cvt_pk_bf16_f32 v28, v80, v81
  v_cvt_pk_bf16_f32 v29, v82, v83
  v_cvt_pk_bf16_f32 v30, v84, v85
  v_cvt_pk_bf16_f32 v31, v86, v87
  buffer_store_dwordx4 v[28:31], v176, s[24:27], s42 offen offset:0 sc1
  v_cvt_pk_bf16_f32 v32, v88, v89
  v_cvt_pk_bf16_f32 v33, v90, v91
  v_cvt_pk_bf16_f32 v34, v92, v93
  v_cvt_pk_bf16_f32 v35, v94, v95
  buffer_store_dwordx4 v[32:35], v176, s[24:27], s42 offen offset:768 sc1
  v_cvt_pk_bf16_f32 v28, v96, v97
  v_cvt_pk_bf16_f32 v29, v98, v99
  v_cvt_pk_bf16_f32 v30, v100, v101
  v_cvt_pk_bf16_f32 v31, v102, v103
  buffer_store_dwordx4 v[28:31], v177, s[24:27], s42 offen offset:0 sc1
  v_cvt_pk_bf16_f32 v32, v104, v105
  v_cvt_pk_bf16_f32 v33, v106, v107
  v_cvt_pk_bf16_f32 v34, v108, v109
  v_cvt_pk_bf16_f32 v35, v110, v111
  buffer_store_dwordx4 v[32:35], v177, s[24:27], s42 offen offset:768 sc1
  v_cvt_pk_bf16_f32 v28, v112, v113
  v_cvt_pk_bf16_f32 v29, v114, v115
  v_cvt_pk_bf16_f32 v30, v116, v117
  v_cvt_pk_bf16_f32 v31, v118, v119
  buffer_store_dwordx4 v[28:31], v178, s[24:27], s42 offen offset:0 sc1
  v_cvt_pk_bf16_f32 v32, v120, v121
  v_cvt_pk_bf16_f32 v33, v122, v123
  v_cvt_pk_bf16_f32 v34, v124, v125
  v_cvt_pk_bf16_f32 v35, v126, v127
  buffer_store_dwordx4 v[32:35], v178, s[24:27], s42 offen offset:768 sc1
  v_cvt_pk_bf16_f32 v28, v128, v129
  v_cvt_pk_bf16_f32 v29, v130, v131
  v_cvt_pk_bf16_f32 v30, v132, v133
  v_cvt_pk_bf16_f32 v31, v134, v135
  buffer_store_dwordx4 v[28:31], v179, s[24:27], s42 offen offset:0 sc1
  v_cvt_pk_bf16_f32 v32, v136, v137
  v_cvt_pk_bf16_f32 v33, v138, v139
  v_cvt_pk_bf16_f32 v34, v140, v141
  v_cvt_pk_bf16_f32 v35, v142, v143
  buffer_store_dwordx4 v[32:35], v179, s[24:27], s42 offen offset:768 sc1
P2_DONE:
  s_barrier
  s_waitcnt vmcnt(0)
  s_lshl_b32 s34, s12, 4
  s_add_u32 s34, s34, s11
  v_mov_b32 v20, 163588
  v_mov_b32 v21, 1
  s_mov_b64 exec, 1
  ds_add_rtn_u32 v22, v20, v21
  s_waitcnt lgkmcnt(0)
  v_readfirstlane_b32 s9, v22
  s_mov_b64 exec, -1
  s_cmp_lg_u32 s9, 3
  s_cbranch_scc1 P2C_NL
  s_add_u32 s56, s86, 29655040
  s_addc_u32 s57, s87, 0
  s_mov_b32 s58, 229376
  s_mov_b32 s59, 0x00020000
  s_lshl_b32 s9, s34, 7
  s_add_u32 s9, s9, 32768
  v_mov_b32 v20, s9
  v_mov_b32 v21, s60
  s_mov_b64 exec, 1
  buffer_store_dword v21, v20, s[56:59], 0 offen sc1
  s_mov_b64 exec, -1
P2C_NL:
  s_branch P3_START
P3_START:
  s_and_b32 s11, s2, 7
  s_lshl_b32 s11, s11, 2
  s_bfe_u32 s12, s2, 0x20003
  s_add_u32 s11, s11, s12
  s_lshr_b32 s12, s2, 5
  s_mul_i32 s9, s11, 180224
  s_lshl_b32 s13, s8, 10
  s_add_u32 s9, s9, s13
  v_lshlrev_b32 v4, 4, v1
  v_add_u32 v105, s9, v4
  v_and_b32 v2, 31, v1
  s_lshl_b32 s9, s12, 3
  s_add_u32 s9, s9, s8
  s_mul_i32 s9, s9, 1280
  s_mul_i32 s10, s11, 81920
  s_add_u32 s9, s9, s10
  v_add_u32 v10, s9, v4
  v_lshlrev_b32 v5, 3, v2
  v_add_u32 v5, s9, v5
  v_lshrrev_b32 v3, 5, v1
  v_lshlrev_b32 v96, 4, v1
  v_lshlrev_b32 v99, 3, v2
  v_add_u32 v99, 1024, v99
  v_mul_u32_u24 v102, 384, v3
  v_lshl_add_u32 v102, v2, 4, v102
  v_add_u32 v102, 1280, v102
  v_lshlrev_b32 v97, 4, v1
  v_add_u32 v97, 45056, v97
  v_lshlrev_b32 v100, 3, v2
  v_add_u32 v100, 46080, v100
  v_mul_u32_u24 v103, 384, v3
  v_lshl_add_u32 v103, v2, 4, v103
  v_add_u32 v103, 46336, v103
  v_lshlrev_b32 v98, 4, v1
  v_add_u32 v98, 90112, v98
  v_lshlrev_b32 v101, 3, v2
  v_add_u32 v101, 91136, v101
  v_mul_u32_u24 v104, 384, v3
  v_lshl_add_u32 v104, v2, 4, v104
  v_add_u32 v104, 91392, v104
  s_lshl_b32 s9, s12, 8
  s_lshl_b32 s10, s8, 5
  s_add_u32 s9, s9, s10
  v_add_u32 v4, s9, v2
  v_mul_u32_u24 v4, 1280, v4
  s_mul_i32 s9, s11, 40
  v_add_u32 v4, s9, v4
  v_lshl_add_u32 v11, v3, 3, v4
  s_mul_i32 s9, s8, 160
  s_mul_i32 s10, s11, 81920
  s_lshl_b32 s15, s12, 9
  s_add_u32 s10, s10, s15
  v_add_u32 v6, 0, v1
  v_add_u32 v6, s9, v6
  v_lshrrev_b32 v7, 5, v6
  v_and_b32 v8, 31, v6
  v_lshlrev_b32 v7, 12, v7
  v_lshl_add_u32 v7, v8, 4, v7
  v_add_u32 v128, s10, v7
  v_add_u32 v6, 64, v1
  v_add_u32 v6, s9, v6
  v_lshrrev_b32 v7, 5, v6
  v_and_b32 v8, 31, v6
  v_lshlrev_b32 v7, 12, v7
  v_lshl_add_u32 v7, v8, 4, v7
  v_add_u32 v129, s10, v7
  v_add_u32 v6, 128, v1
  v_add_u32 v6, s9, v6
  v_lshrrev_b32 v7, 5, v6
  v_and_b32 v8, 31, v6
  v_lshlrev_b32 v7, 12, v7
  v_lshl_add_u32 v7, v8, 4, v7
  v_add_u32 v130, s10, v7
  v_cmp_gt_u32 vcc, 32, v1
  v_mov_b32 v6, 0x7ffffff0
  s_nop 0
  v_cndmask_b32 v130, v6, v130, vcc
  v_mov_b32 v80, 0
  v_mov_b32 v81, 0
  v_mov_b32 v82, 0
  v_mov_b32 v83, 0
  v_mov_b32 v84, 0
  v_mov_b32 v85, 0
  v_mov_b32 v86, 0
  v_mov_b32 v87, 0
  v_mov_b32 v88, 0
  v_mov_b32 v89, 0
  v_mov_b32 v90, 0
  v_mov_b32 v91, 0
  v_mov_b32 v92, 0
  v_mov_b32 v93, 0
  v_mov_b32 v94, 0
  v_mov_b32 v95, 0
  s_add_u32 s16, s86, 5308416
  s_addc_u32 s17, s87, 0
  s_mov_b32 s18, 5767168
  s_mov_b32 s19, 0x00020000
  s_add_u32 s20, s86, 2686976
  s_addc_u32 s21, s87, 0
  s_mov_b32 s22, 2621440
  s_mov_b32 s23, 0x00020000
  s_add_u32 s24, s86, 11075584
  s_addc_u32 s25, s87, 0
  s_mov_b32 s26, 2621440
  s_mov_b32 s27, 0x00020000
  s_cmp_lg_u32 s8, 4
  s_cbranch_scc1 P3_GO
  s_mul_i32 s9, s11, 20
  s_lshr_b32 s10, s9, 7
  s_add_u32 s9, s9, 19
  s_lshr_b32 s9, s9, 7
  v_bfe_u32 v20, v1, 4, 1
  s_sub_u32 s15, s9, s10
  v_mul_u32_u24 v20, s15, v20
  v_add_u32 v20, s10, v20
  v_lshrrev_b32 v21, 5, v1
  v_mul_u32_u24 v21, 5, v21
  v_add3_u32 v20, v20, v21, 5
  v_and_b32 v21, 15, v1
  v_lshl_add_u32 v20, v20, 4, v21
  v_lshlrev_b32 v20, 7, v20
  v_add_u32 v20, 32768, v20
  s_add_u32 s56, s86, 29655040
  s_addc_u32 s57, s87, 0
  s_mov_b32 s58, 229376
  s_mov_b32 s59, 0x00020000
  s_mov_b32 s14, 0
  s_mov_b64 exec, -1
  s_waitcnt vmcnt(0)
  buffer_load_dword v226, v20, s[56:59], 0 offen sc1
P3_KV_P:
  buffer_load_dword v227, v20, s[56:59], 0 offen sc1
  s_waitcnt vmcnt(1)
  v_cmp_ne_u32 vcc, s60, v226
  s_cmp_eq_u64 vcc, 0
  s_cbranch_scc1 P3_KV_R
  buffer_load_dword v226, v20, s[56:59], 0 offen sc1
  s_waitcnt vmcnt(1)
  v_cmp_ne_u32 vcc, s60, v227
  s_cmp_eq_u64 vcc, 0
  s_cbranch_scc1 P3_KV_R
  s_add_u32 s14, s14, 1
  s_cmp_gt_u32 s14, 30000
  s_cbranch_scc0 P3_KV_P
P3_KV_R:
  s_mov_b64 exec, -1
  v_bfe_u32 v20, v1, 1, 1
  v_mul_u32_u24 v20, s15, v20
  v_add_u32 v20, s10, v20
  v_and_b32 v21, 1, v1
  s_lshl_b32 s9, s12, 1
  v_add_u32 v21, s9, v21
  v_lshl_add_u32 v20, v20, 4, v21
  v_lshlrev_b32 v20, 7, v20
  v_add_u32 v20, 32768, v20
  s_mov_b32 s14, 0
  s_mov_b64 exec, 0xf
  s_waitcnt vmcnt(0)
  buffer_load_dword v226, v20, s[56:59], 0 offen sc1
P3_Q_P:
  buffer_load_dword v227, v20, s[56:59], 0 offen sc1
  s_waitcnt vmcnt(1)
  v_cmp_ne_u32 vcc, s60, v226
  s_cmp_eq_u64 vcc, 0
  s_cbranch_scc1 P3_Q_R
  buffer_load_dword v226, v20, s[56:59], 0 offen sc1
  s_waitcnt vmcnt(1)
  v_cmp_ne_u32 vcc, s60, v227
  s_cmp_eq_u64 vcc, 0
  s_cbranch_scc1 P3_Q_R
  s_add_u32 s14, s14, 1
  s_cmp_gt_u32 s14, 30000
  s_cbranch_scc0 P3_Q_P
P3_Q_R:
  s_mov_b64 exec, -1
P3_GO:
  s_barrier
  buffer_load_dwordx4 v[112:115], v10, s[20:23], 0 offen sc1
  buffer_load_dwordx2 v[116:117], v5, s[20:23], 0 offen offset:1024 sc1
  s_cmp_ge_u32 s8, 4
  s_cbranch_scc1 ATT_NP_0
  s_add_u32 m0, s13, 40960
  s_mov_b32 s14, 40960
  buffer_load_dwordx4 v105, s[16:19], s14 offen sc1 lds
ATT_NP_0:
  s_add_u32 m0, s13, 0
  s_mov_b32 s14, 0
  buffer_load_dwordx4 v105, s[16:19], s14 offen sc1 lds
  s_add_u32 m0, s13, 8192
  s_mov_b32 s14, 8192
  buffer_load_dwordx4 v105, s[16:19], s14 offen sc1 lds
  s_add_u32 m0, s13, 16384
  s_mov_b32 s14, 16384
  buffer_load_dwordx4 v105, s[16:19], s14 offen sc1 lds
  s_add_u32 m0, s13, 24576
  s_mov_b32 s14, 24576
  buffer_load_dwordx4 v105, s[16:19], s14 offen sc1 lds
  s_add_u32 m0, s13, 32768
  s_mov_b32 s14, 32768
  buffer_load_dwordx4 v105, s[16:19], s14 offen sc1 lds
  s_waitcnt vmcnt(3)
  v_cmp_gt_u32 vcc, 32, v1
  s_nop 1
  v_cndmask_b32 v116, 0, v116, vcc
  v_cndmask_b32 v117, 0, v117, vcc
  s_barrier
  ds_read_b128 v[12:15], v96 offset:0
  ds_read_b64 v[20:21], v99 offset:0
  ds_read_b128 v[16:19], v96 offset:2816
  ds_read_b64 v[22:23], v99 offset:2816
  ds_read_b128 v[24:27], v102 offset:0
  ds_read_b128 v[28:31], v102 offset:768
  s_waitcnt lgkmcnt(4)
  v_mfma_f32_32x32x16_bf16 v[40:55], v[12:15], v[112:115], 0
  v_mfma_f32_32x32x8bf16_1k v[40:55], v[20:21], v[116:117], v[40:55]
  s_waitcnt lgkmcnt(0)
  v_mfma_f32_32x32x16_bf16 v[56:71], v[16:19], v[112:115], 0
  ds_read_b128 v[12:15], v96 offset:5632
  ds_read_b64 v[20:21], v99 offset:5632
  s_nop 7
  v_exp_f32 v40, v40
  v_exp_f32 v41, v41
  v_exp_f32 v42, v42
  v_cvt_pk_bf16_f32 v72, v40, v41
  v_exp_f32 v43, v43
  ds_read_b128 v[32:35], v102 offset:2816
  ds_read_b128 v[36:39], v102 offset:3584
  v_exp_f32 v44, v44
  v_cvt_pk_bf16_f32 v73, v42, v43
  v_exp_f32 v45, v45
  v_exp_f32 v46, v46
  v_mfma_f32_32x32x8bf16_1k v[56:71], v[22:23], v[116:117], v[56:71]
  v_cvt_pk_bf16_f32 v74, v44, v45
  v_exp_f32 v47, v47
  v_exp_f32 v48, v48
  v_cvt_pk_bf16_f32 v75, v46, v47
  v_exp_f32 v49, v49
  v_exp_f32 v50, v50
  v_mfma_f32_32x32x16_bf16 v[80:95], v[24:27], v[72:75], v[80:95]
  s_cmp_ge_u32 s8, 4
  s_cbranch_scc1 ATT_NP_1
  s_add_u32 m0, s13, 86016
  s_mov_b32 s14, 86016
  buffer_load_dwordx4 v105, s[16:19], s14 offen sc1 lds
ATT_NP_1:
  s_add_u32 m0, s13, 45056
  s_mov_b32 s14, 45056
  buffer_load_dwordx4 v105, s[16:19], s14 offen sc1 lds
  v_cvt_pk_bf16_f32 v76, v48, v49
  v_exp_f32 v51, v51
  v_exp_f32 v52, v52
  v_cvt_pk_bf16_f32 v77, v50, v51
  v_exp_f32 v53, v53
  v_exp_f32 v54, v54
  v_exp_f32 v55, v55
  v_cvt_pk_bf16_f32 v78, v52, v53
  v_cvt_pk_bf16_f32 v79, v54, v55
  s_waitcnt lgkmcnt(0)
  v_mfma_f32_32x32x16_bf16 v[40:55], v[12:15], v[112:115], 0
  ds_read_b128 v[16:19], v96 offset:8448
  ds_read_b64 v[22:23], v99 offset:8448
  v_exp_f32 v56, v56
  v_exp_f32 v57, v57
  v_exp_f32 v58, v58
  v_cvt_pk_bf16_f32 v72, v56, v57
  v_exp_f32 v59, v59
  v_mfma_f32_32x32x16_bf16 v[80:95], v[28:31], v[76:79], v[80:95]
  ds_read_b128 v[24:27], v102 offset:5632
  ds_read_b128 v[28:31], v102 offset:6400
  v_exp_f32 v60, v60
  v_cvt_pk_bf16_f32 v73, v58, v59
  v_exp_f32 v61, v61
  v_exp_f32 v62, v62
  v_mfma_f32_32x32x8bf16_1k v[40:55], v[20:21], v[116:117], v[40:55]
  v_cvt_pk_bf16_f32 v74, v60, v61
  v_exp_f32 v63, v63
  v_exp_f32 v64, v64
  v_cvt_pk_bf16_f32 v75, v62, v63
  v_exp_f32 v65, v65
  v_exp_f32 v66, v66
  v_mfma_f32_32x32x16_bf16 v[80:95], v[32:35], v[72:75], v[80:95]
  v_cvt_pk_bf16_f32 v76, v64, v65
  v_exp_f32 v67, v67
  v_exp_f32 v68, v68
  v_cvt_pk_bf16_f32 v77, v66, v67
  v_exp_f32 v69, v69
  v_exp_f32 v70, v70
  v_exp_f32 v71, v71
  v_cvt_pk_bf16_f32 v78, v68, v69
  v_cvt_pk_bf16_f32 v79, v70, v71
  s_waitcnt lgkmcnt(0)
  v_mfma_f32_32x32x16_bf16 v[56:71], v[16:19], v[112:115], 0
  ds_read_b128 v[12:15], v96 offset:11264
  ds_read_b64 v[20:21], v99 offset:11264
  v_exp_f32 v40, v40
  v_exp_f32 v41, v41
  v_exp_f32 v42, v42
  v_cvt_pk_bf16_f32 v72, v40, v41
  v_exp_f32 v43, v43
  v_mfma_f32_32x32x16_bf16 v[80:95], v[36:39], v[76:79], v[80:95]
  ds_read_b128 v[32:35], v102 offset:8448
  ds_read_b128 v[36:39], v102 offset:9216
  v_exp_f32 v44, v44
  v_cvt_pk_bf16_f32 v73, v42, v43
  v_exp_f32 v45, v45
  v_exp_f32 v46, v46
  v_mfma_f32_32x32x8bf16_1k v[56:71], v[22:23], v[116:117], v[56:71]
  v_cvt_pk_bf16_f32 v74, v44, v45
  v_exp_f32 v47, v47
  v_exp_f32 v48, v48
  v_cvt_pk_bf16_f32 v75, v46, v47
  v_exp_f32 v49, v49
  v_exp_f32 v50, v50
  v_mfma_f32_32x32x16_bf16 v[80:95], v[24:27], v[72:75], v[80:95]
  s_add_u32 m0, s13, 53248
  s_mov_b32 s14, 53248
  buffer_load_dwordx4 v105, s[16:19], s14 offen sc1 lds
  v_cvt_pk_bf16_f32 v76, v48, v49
  v_exp_f32 v51, v51
  v_exp_f32 v52, v52
  v_cvt_pk_bf16_f32 v77, v50, v51
  v_exp_f32 v53, v53
  v_exp_f32 v54, v54
  v_exp_f32 v55, v55
  v_cvt_pk_bf16_f32 v78, v52, v53
  v_cvt_pk_bf16_f32 v79, v54, v55
  s_waitcnt vmcnt(2)
  s_barrier
  s_waitcnt lgkmcnt(0)
  v_mfma_f32_32x32x16_bf16 v[40:55], v[12:15], v[112:115], 0
  ds_read_b128 v[16:19], v96 offset:14080
  ds_read_b64 v[22:23], v99 offset:14080
  v_exp_f32 v56, v56
  v_exp_f32 v57, v57
  v_exp_f32 v58, v58
  v_cvt_pk_bf16_f32 v72, v56, v57
  v_exp_f32 v59, v59
  v_mfma_f32_32x32x16_bf16 v[80:95], v[28:31], v[76:79], v[80:95]
  ds_read_b128 v[24:27], v102 offset:11264
  ds_read_b128 v[28:31], v102 offset:12032
  v_exp_f32 v60, v60
  v_cvt_pk_bf16_f32 v73, v58, v59
  v_exp_f32 v61, v61
  v_exp_f32 v62, v62
  v_mfma_f32_32x32x8bf16_1k v[40:55], v[20:21], v[116:117], v[40:55]
  v_cvt_pk_bf16_f32 v74, v60, v61
  v_exp_f32 v63, v63
  v_exp_f32 v64, v64
  v_cvt_pk_bf16_f32 v75, v62, v63
  v_exp_f32 v65, v65
  v_exp_f32 v66, v66
  v_mfma_f32_32x32x16_bf16 v[80:95], v[32:35], v[72:75], v[80:95]
  v_cvt_pk_bf16_f32 v76, v64, v65
  v_exp_f32 v67, v67
  v_exp_f32 v68, v68
  v_cvt_pk_bf16_f32 v77, v66, v67
  v_exp_f32 v69, v69
  v_exp_f32 v70, v70
  v_exp_f32 v71, v71
  v_cvt_pk_bf16_f32 v78, v68, v69
  v_cvt_pk_bf16_f32 v79, v70, v71
  s_waitcnt lgkmcnt(0)
  v_mfma_f32_32x32x16_bf16 v[56:71], v[16:19], v[112:115], 0
  ds_read_b128 v[12:15], v96 offset:16896
  ds_read_b64 v[20:21], v99 offset:16896
  v_exp_f32 v40, v40
  v_exp_f32 v41, v41
  v_exp_f32 v42, v42
  v_cvt_pk_bf16_f32 v72, v40, v41
  v_exp_f32 v43, v43
  v_mfma_f32_32x32x16_bf16 v[80:95], v[36:39], v[76:79], v[80:95]
  ds_read_b128 v[32:35], v102 offset:14080
  ds_read_b128 v[36:39], v102 offset:14848
  v_exp_f32 v44, v44
  v_cvt_pk_bf16_f32 v73, v42, v43
  v_exp_f32 v45, v45
  v_exp_f32 v46, v46
  v_mfma_f32_32x32x8bf16_1k v[56:71], v[22:23], v[116:117], v[56:71]
  v_cvt_pk_bf16_f32 v74, v44, v45
  v_exp_f32 v47, v47
  v_exp_f32 v48, v48
  v_cvt_pk_bf16_f32 v75, v46, v47
  v_exp_f32 v49, v49
  v_exp_f32 v50, v50
  v_mfma_f32_32x32x16_bf16 v[80:95], v[24:27], v[72:75], v[80:95]
  s_add_u32 m0, s13, 61440
  s_mov_b32 s14, 61440
  buffer_load_dwordx4 v105, s[16:19], s14 offen sc1 lds
  v_cvt_pk_bf16_f32 v76, v48, v49
  v_exp_f32 v51, v51
  v_exp_f32 v52, v52
  v_cvt_pk_bf16_f32 v77, v50, v51
  v_exp_f32 v53, v53
  v_exp_f32 v54, v54
  v_exp_f32 v55, v55
  v_cvt_pk_bf16_f32 v78, v52, v53
  v_cvt_pk_bf16_f32 v79, v54, v55
  s_waitcnt lgkmcnt(0)
  v_mfma_f32_32x32x16_bf16 v[40:55], v[12:15], v[112:115], 0
  ds_read_b128 v[16:19], v96 offset:19712
  ds_read_b64 v[22:23], v99 offset:19712
  v_exp_f32 v56, v56
  v_exp_f32 v57, v57
  v_exp_f32 v58, v58
  v_cvt_pk_bf16_f32 v72, v56, v57
  v_exp_f32 v59, v59
  v_mfma_f32_32x32x16_bf16 v[80:95], v[28:31], v[76:79], v[80:95]
  ds_read_b128 v[24:27], v102 offset:16896
  ds_read_b128 v[28:31], v102 offset:17664
  v_exp_f32 v60, v60
  v_cvt_pk_bf16_f32 v73, v58, v59
  v_exp_f32 v61, v61
  v_exp_f32 v62, v62
  v_mfma_f32_32x32x8bf16_1k v[40:55], v[20:21], v[116:117], v[40:55]
  v_cvt_pk_bf16_f32 v74, v60, v61
  v_exp_f32 v63, v63
  v_exp_f32 v64, v64
  v_cvt_pk_bf16_f32 v75, v62, v63
  v_exp_f32 v65, v65
  v_exp_f32 v66, v66
  v_mfma_f32_32x32x16_bf16 v[80:95], v[32:35], v[72:75], v[80:95]
  s_cmp_lt_u32 s8, 4
  s_cbranch_scc1 P3_Ja
  s_cmp_ge_u32 s2, 240
  s_cselect_b32 s55, 0, 3932160
  s_add_u32 s44, s86, 25395200
  s_addc_u32 s45, s87, 0
  s_mov_b32 s46, s55
  s_mov_b32 s47, 0x00020000
  buffer_store_dwordx4 v[136:139], v199, s[44:47], 0 offen sc1
  buffer_store_dwordx4 v[140:143], v200, s[44:47], 0 offen sc1
  buffer_store_dwordx4 v[144:147], v201, s[44:47], 0 offen sc1
  buffer_store_dwordx4 v[148:151], v202, s[44:47], 0 offen sc1
P3_Ja:
  v_cvt_pk_bf16_f32 v76, v64, v65
  v_exp_f32 v67, v67
  v_exp_f32 v68, v68
  v_cvt_pk_bf16_f32 v77, v66, v67
  v_exp_f32 v69, v69
  v_exp_f32 v70, v70
  v_exp_f32 v71, v71
  v_cvt_pk_bf16_f32 v78, v68, v69
  v_cvt_pk_bf16_f32 v79, v70, v71
  s_waitcnt lgkmcnt(0)
  v_mfma_f32_32x32x16_bf16 v[56:71], v[16:19], v[112:115], 0
  ds_read_b128 v[12:15], v96 offset:22528
  ds_read_b64 v[20:21], v99 offset:22528
  v_exp_f32 v40, v40
  v_exp_f32 v41, v41
  v_exp_f32 v42, v42
  v_cvt_pk_bf16_f32 v72, v40, v41
  v_exp_f32 v43, v43
  v_mfma_f32_32x32x16_bf16 v[80:95], v[36:39], v[76:79], v[80:95]
  ds_read_b128 v[32:35], v102 offset:19712
  ds_read_b128 v[36:39], v102 offset:20480
  v_exp_f32 v44, v44
  v_cvt_pk_bf16_f32 v73, v42, v43
  v_exp_f32 v45, v45
  v_exp_f32 v46, v46
  v_mfma_f32_32x32x8bf16_1k v[56:71], v[22:23], v[116:117], v[56:71]
  v_cvt_pk_bf16_f32 v74, v44, v45
  v_exp_f32 v47, v47
  v_exp_f32 v48, v48
  v_cvt_pk_bf16_f32 v75, v46, v47
  v_exp_f32 v49, v49
  v_exp_f32 v50, v50
  v_mfma_f32_32x32x16_bf16 v[80:95], v[24:27], v[72:75], v[80:95]
  s_add_u32 m0, s13, 69632
  s_mov_b32 s14, 69632
  buffer_load_dwordx4 v105, s[16:19], s14 offen sc1 lds
  s_cmp_lt_u32 s8, 4
  s_cbranch_scc1 P3_Jb
  s_cmp_ge_u32 s2, 240
  s_cselect_b32 s55, 0, 24576
  s_add_u32 s44, s86, 16384
  s_addc_u32 s45, s87, 0
  s_mov_b32 s46, s55
  s_mov_b32 s47, 0x00020000
  buffer_atomic_add_f32 v160, v203, s[44:47], 0 offen
  buffer_atomic_add_f32 v168, v203, s[44:47], 0 offen offset:768
  s_add_u32 s48, s86, 22609920
  s_addc_u32 s49, s87, 0
  s_mov_b32 s50, 819200
  s_mov_b32 s51, 0x00020000
  buffer_store_dwordx4 v[184:187], v204, s[48:51], 0 offen sc1
P3_Jb:
  v_cvt_pk_bf16_f32 v76, v48, v49
  v_exp_f32 v51, v51
  v_exp_f32 v52, v52
  v_cvt_pk_bf16_f32 v77, v50, v51
  v_exp_f32 v53, v53
  v_exp_f32 v54, v54
  v_exp_f32 v55, v55
  v_cvt_pk_bf16_f32 v78, v52, v53
  v_cvt_pk_bf16_f32 v79, v54, v55
  s_waitcnt lgkmcnt(0)
  v_mfma_f32_32x32x16_bf16 v[40:55], v[12:15], v[112:115], 0
  ds_read_b128 v[16:19], v96 offset:25344
  ds_read_b64 v[22:23], v99 offset:25344
  v_exp_f32 v56, v56
  v_exp_f32 v57, v57
  v_exp_f32 v58, v58
  v_cvt_pk_bf16_f32 v72, v56, v57
  v_exp_f32 v59, v59
  v_mfma_f32_32x32x16_bf16 v[80:95], v[28:31], v[76:79], v[80:95]
  ds_read_b128 v[24:27], v102 offset:22528
  ds_read_b128 v[28:31], v102 offset:23296
  v_exp_f32 v60, v60
  v_cvt_pk_bf16_f32 v73, v58, v59
  v_exp_f32 v61, v61
  v_exp_f32 v62, v62
  v_mfma_f32_32x32x8bf16_1k v[40:55], v[20:21], v[116:117], v[40:55]
  v_cvt_pk_bf16_f32 v74, v60, v61
  v_exp_f32 v63, v63
  v_exp_f32 v64, v64
  v_cvt_pk_bf16_f32 v75, v62, v63
  v_exp_f32 v65, v65
  v_exp_f32 v66, v66
  v_mfma_f32_32x32x16_bf16 v[80:95], v[32:35], v[72:75], v[80:95]
  v_cvt_pk_bf16_f32 v76, v64, v65
  v_exp_f32 v67, v67
  v_exp_f32 v68, v68
  v_cvt_pk_bf16_f32 v77, v66, v67
  v_exp_f32 v69, v69
  v_exp_f32 v70, v70
  v_exp_f32 v71, v71
  v_cvt_pk_bf16_f32 v78, v68, v69
  v_cvt_pk_bf16_f32 v79, v70, v71
  s_waitcnt lgkmcnt(0)
  v_mfma_f32_32x32x16_bf16 v[56:71], v[16:19], v[112:115], 0
  ds_read_b128 v[12:15], v96 offset:28160
  ds_read_b64 v[20:21], v99 offset:28160
  v_exp_f32 v40, v40
  v_exp_f32 v41, v41
  v_exp_f32 v42, v42
  v_cvt_pk_bf16_f32 v72, v40, v41
  v_exp_f32 v43, v43
  v_mfma_f32_32x32x16_bf16 v[80:95], v[36:39], v[76:79], v[80:95]
  ds_read_b128 v[32:35], v102 offset:25344
  ds_read_b128 v[36:39], v102 offset:26112
  v_exp_f32 v44, v44
  v_cvt_pk_bf16_f32 v73, v42, v43
  v_exp_f32 v45, v45
  v_exp_f32 v46, v46
  v_mfma_f32_32x32x8bf16_1k v[56:71], v[22:23], v[116:117], v[56:71]
  v_cvt_pk_bf16_f32 v74, v44, v45
  v_exp_f32 v47, v47
  v_exp_f32 v48, v48
  v_cvt_pk_bf16_f32 v75, v46, v47
  v_exp_f32 v49, v49
  v_exp_f32 v50, v50
  v_mfma_f32_32x32x16_bf16 v[80:95], v[24:27], v[72:75], v[80:95]
  s_add_u32 m0, s13, 77824
  s_mov_b32 s14, 77824
  buffer_load_dwordx4 v105, s[16:19], s14 offen sc1 lds
  v_cvt_pk_bf16_f32 v76, v48, v49
  v_exp_f32 v51, v51
  v_exp_f32 v52, v52
  v_cvt_pk_bf16_f32 v77, v50, v51
  v_exp_f32 v53, v53
  v_exp_f32 v54, v54
  v_exp_f32 v55, v55
  v_cvt_pk_bf16_f32 v78, v52, v53
  v_cvt_pk_bf16_f32 v79, v54, v55
  s_waitcnt lgkmcnt(0)
  v_mfma_f32_32x32x16_bf16 v[40:55], v[12:15], v[112:115], 0
  ds_read_b128 v[16:19], v96 offset:30976
  ds_read_b64 v[22:23], v99 offset:30976
  v_exp_f32 v56, v56
  v_exp_f32 v57, v57
  v_exp_f32 v58, v58
  v_cvt_pk_bf16_f32 v72, v56, v57
  v_exp_f32 v59, v59
  v_mfma_f32_32x32x16_bf16 v[80:95], v[28:31], v[76:79], v[80:95]
  ds_read_b128 v[24:27], v102 offset:28160
  ds_read_b128 v[28:31], v102 offset:28928
  v_exp_f32 v60, v60
  v_cvt_pk_bf16_f32 v73, v58, v59
  v_exp_f32 v61, v61
  v_exp_f32 v62, v62
  v_mfma_f32_32x32x8bf16_1k v[40:55], v[20:21], v[116:117], v[40:55]
  v_cvt_pk_bf16_f32 v74, v60, v61
  v_exp_f32 v63, v63
  v_exp_f32 v64, v64
  v_cvt_pk_bf16_f32 v75, v62, v63
  v_exp_f32 v65, v65
  v_exp_f32 v66, v66
  v_mfma_f32_32x32x16_bf16 v[80:95], v[32:35], v[72:75], v[80:95]
  v_cvt_pk_bf16_f32 v76, v64, v65
  v_exp_f32 v67, v67
  v_exp_f32 v68, v68
  v_cvt_pk_bf16_f32 v77, v66, v67
  v_exp_f32 v69, v69
  v_exp_f32 v70, v70
  v_exp_f32 v71, v71
  v_cvt_pk_bf16_f32 v78, v68, v69
  v_cvt_pk_bf16_f32 v79, v70, v71
  s_waitcnt lgkmcnt(0)
  v_mfma_f32_32x32x16_bf16 v[56:71], v[16:19], v[112:115], 0
  ds_read_b128 v[12:15], v96 offset:33792
  ds_read_b64 v[20:21], v99 offset:33792
  v_exp_f32 v40, v40
  v_exp_f32 v41, v41
  v_exp_f32 v42, v42
  v_cvt_pk_bf16_f32 v72, v40, v41
  v_exp_f32 v43, v43
  v_mfma_f32_32x32x16_bf16 v[80:95], v[36:39], v[76:79], v[80:95]
  ds_read_b128 v[32:35], v102 offset:30976
  ds_read_b128 v[36:39], v102 offset:31744
  v_exp_f32 v44, v44
  v_cvt_pk_bf16_f32 v73, v42, v43
  v_exp_f32 v45, v45
  v_exp_f32 v46, v46
  v_mfma_f32_32x32x8bf16_1k v[56:71], v[22:23], v[116:117], v[56:71]
  v_cvt_pk_bf16_f32 v74, v44, v45
  v_exp_f32 v47, v47
  v_exp_f32 v48, v48
  v_cvt_pk_bf16_f32 v75, v46, v47
  v_exp_f32 v49, v49
  v_exp_f32 v50, v50
  v_mfma_f32_32x32x16_bf16 v[80:95], v[24:27], v[72:75], v[80:95]
  v_cvt_pk_bf16_f32 v76, v48, v49
  v_exp_f32 v51, v51
  v_exp_f32 v52, v52
  v_cvt_pk_bf16_f32 v77, v50, v51
  v_exp_f32 v53, v53
  v_exp_f32 v54, v54
  v_exp_f32 v55, v55
  v_cvt_pk_bf16_f32 v78, v52, v53
  v_cvt_pk_bf16_f32 v79, v54, v55
  s_waitcnt lgkmcnt(0)
  v_mfma_f32_32x32x16_bf16 v[40:55], v[12:15], v[112:115], 0
  ds_read_b128 v[16:19], v96 offset:36608
  ds_read_b64 v[22:23], v99 offset:36608
  v_exp_f32 v56, v56
  v_exp_f32 v57, v57
  v_exp_f32 v58, v58
  v_cvt_pk_bf16_f32 v72, v56, v57
  v_exp_f32 v59, v59
  v_mfma_f32_32x32x16_bf16 v[80:95], v[28:31], v[76:79], v[80:95]
  ds_read_b128 v[24:27], v102 offset:33792
  ds_read_b128 v[28:31], v102 offset:34560
  v_exp_f32 v60, v60
  v_cvt_pk_bf16_f32 v73, v58, v59
  v_exp_f32 v61, v61
  v_exp_f32 v62, v62
  v_mfma_f32_32x32x8bf16_1k v[40:55], v[20:21], v[116:117], v[40:55]
  v_cvt_pk_bf16_f32 v74, v60, v61
  v_exp_f32 v63, v63
  v_exp_f32 v64, v64
  v_cvt_pk_bf16_f32 v75, v62, v63
  v_exp_f32 v65, v65
  v_exp_f32 v66, v66
  v_mfma_f32_32x32x16_bf16 v[80:95], v[32:35], v[72:75], v[80:95]
  v_cvt_pk_bf16_f32 v76, v64, v65
  v_exp_f32 v67, v67
  v_exp_f32 v68, v68
  v_cvt_pk_bf16_f32 v77, v66, v67
  v_exp_f32 v69, v69
  v_exp_f32 v70, v70
  v_exp_f32 v71, v71
  v_cvt_pk_bf16_f32 v78, v68, v69
  v_cvt_pk_bf16_f32 v79, v70, v71
  s_waitcnt lgkmcnt(0)
  v_mfma_f32_32x32x16_bf16 v[56:71], v[16:19], v[112:115], 0
  ds_read_b128 v[12:15], v96 offset:39424
  ds_read_b64 v[20:21], v99 offset:39424
  v_exp_f32 v40, v40
  v_exp_f32 v41, v41
  v_exp_f32 v42, v42
  v_cvt_pk_bf16_f32 v72, v40, v41
  v_exp_f32 v43, v43
  v_mfma_f32_32x32x16_bf16 v[80:95], v[36:39], v[76:79], v[80:95]
  ds_read_b128 v[32:35], v102 offset:36608
  ds_read_b128 v[36:39], v102 offset:37376
  v_exp_f32 v44, v44
  v_cvt_pk_bf16_f32 v73, v42, v43
  v_exp_f32 v45, v45
  v_exp_f32 v46, v46
  v_mfma_f32_32x32x8bf16_1k v[56:71], v[22:23], v[116:117], v[56:71]
  v_cvt_pk_bf16_f32 v74, v44, v45
  v_exp_f32 v47, v47
  v_exp_f32 v48, v48
  v_cvt_pk_bf16_f32 v75, v46, v47
  v_exp_f32 v49, v49
  v_exp_f32 v50, v50
  v_mfma_f32_32x32x16_bf16 v[80:95], v[24:27], v[72:75], v[80:95]
  v_cvt_pk_bf16_f32 v76, v48, v49
  v_exp_f32 v51, v51
  v_exp_f32 v52, v52
  v_cvt_pk_bf16_f32 v77, v50, v51
  v_exp_f32 v53, v53
  v_exp_f32 v54, v54
  v_exp_f32 v55, v55
  v_cvt_pk_bf16_f32 v78, v52, v53
  v_cvt_pk_bf16_f32 v79, v54, v55
  s_waitcnt lgkmcnt(0)
  v_mfma_f32_32x32x16_bf16 v[40:55], v[12:15], v[112:115], 0
  ds_read_b128 v[16:19], v96 offset:42240
  ds_read_b64 v[22:23], v99 offset:42240
  v_exp_f32 v56, v56
  v_exp_f32 v57, v57
  v_exp_f32 v58, v58
  v_cvt_pk_bf16_f32 v72, v56, v57
  v_exp_f32 v59, v59
  v_mfma_f32_32x32x16_bf16 v[80:95], v[28:31], v[76:79], v[80:95]
  ds_read_b128 v[24:27], v102 offset:39424
  ds_read_b128 v[28:31], v102 offset:40192
  v_exp_f32 v60, v60
  v_cvt_pk_bf16_f32 v73, v58, v59
  v_exp_f32 v61, v61
  v_exp_f32 v62, v62
  v_mfma_f32_32x32x8bf16_1k v[40:55], v[20:21], v[116:117], v[40:55]
  v_cvt_pk_bf16_f32 v74, v60, v61
  v_exp_f32 v63, v63
  v_exp_f32 v64, v64
  v_cvt_pk_bf16_f32 v75, v62, v63
  v_exp_f32 v65, v65
  v_exp_f32 v66, v66
  v_mfma_f32_32x32x16_bf16 v[80:95], v[32:35], v[72:75], v[80:95]
  v_cvt_pk_bf16_f32 v76, v64, v65
  v_exp_f32 v67, v67
  v_exp_f32 v68, v68
  v_cvt_pk_bf16_f32 v77, v66, v67
  v_exp_f32 v69, v69
  v_exp_f32 v70, v70
  v_exp_f32 v71, v71
  v_cvt_pk_bf16_f32 v78, v68, v69
  v_cvt_pk_bf16_f32 v79, v70, v71
  s_waitcnt vmcnt(0)
  s_barrier
  s_waitcnt lgkmcnt(0)
  v_mfma_f32_32x32x16_bf16 v[56:71], v[16:19], v[112:115], 0
  ds_read_b128 v[12:15], v97 offset:0
  ds_read_b64 v[20:21], v100 offset:0
  v_exp_f32 v40, v40
  v_exp_f32 v41, v41
  v_exp_f32 v42, v42
  v_cvt_pk_bf16_f32 v72, v40, v41
  v_exp_f32 v43, v43
  v_mfma_f32_32x32x16_bf16 v[80:95], v[36:39], v[76:79], v[80:95]
  ds_read_b128 v[32:35], v102 offset:42240
  ds_read_b128 v[36:39], v102 offset:43008
  v_exp_f32 v44, v44
  v_cvt_pk_bf16_f32 v73, v42, v43
  v_exp_f32 v45, v45
  v_exp_f32 v46, v46
  v_mfma_f32_32x32x8bf16_1k v[56:71], v[22:23], v[116:117], v[56:71]
  v_cvt_pk_bf16_f32 v74, v44, v45
  v_exp_f32 v47, v47
  v_exp_f32 v48, v48
  v_cvt_pk_bf16_f32 v75, v46, v47
  v_exp_f32 v49, v49
  v_exp_f32 v50, v50
  v_mfma_f32_32x32x16_bf16 v[80:95], v[24:27], v[72:75], v[80:95]
  s_cmp_ge_u32 s8, 4
  s_cbranch_scc1 ATT_NP_2
  s_add_u32 m0, s13, 131072
  s_mov_b32 s14, 131072
  buffer_load_dwordx4 v105, s[16:19], s14 offen sc1 lds
ATT_NP_2:
  s_add_u32 m0, s13, 90112
  s_mov_b32 s14, 90112
  buffer_load_dwordx4 v105, s[16:19], s14 offen sc1 lds
  v_cvt_pk_bf16_f32 v76, v48, v49
  v_exp_f32 v51, v51
  v_exp_f32 v52, v52
  v_cvt_pk_bf16_f32 v77, v50, v51
  v_exp_f32 v53, v53
  v_exp_f32 v54, v54
  v_exp_f32 v55, v55
  v_cvt_pk_bf16_f32 v78, v52, v53
  v_cvt_pk_bf16_f32 v79, v54, v55
  s_waitcnt lgkmcnt(0)
  v_mfma_f32_32x32x16_bf16 v[40:55], v[12:15], v[112:115], 0
  ds_read_b128 v[16:19], v97 offset:2816
  ds_read_b64 v[22:23], v100 offset:2816
  v_exp_f32 v56, v56
  v_exp_f32 v57, v57
  v_exp_f32 v58, v58
  v_cvt_pk_bf16_f32 v72, v56, v57
  v_exp_f32 v59, v59
  v_mfma_f32_32x32x16_bf16 v[80:95], v[28:31], v[76:79], v[80:95]
  ds_read_b128 v[24:27], v103 offset:0
  ds_read_b128 v[28:31], v103 offset:768
  v_exp_f32 v60, v60
  v_cvt_pk_bf16_f32 v73, v58, v59
  v_exp_f32 v61, v61
  v_exp_f32 v62, v62
  v_mfma_f32_32x32x8bf16_1k v[40:55], v[20:21], v[116:117], v[40:55]
  v_cvt_pk_bf16_f32 v74, v60, v61
  v_exp_f32 v63, v63
  v_exp_f32 v64, v64
  v_cvt_pk_bf16_f32 v75, v62, v63
  v_exp_f32 v65, v65
  v_exp_f32 v66, v66
  v_mfma_f32_32x32x16_bf16 v[80:95], v[32:35], v[72:75], v[80:95]
  s_add_u32 m0, s13, 98304
  s_mov_b32 s14, 98304
  buffer_load_dwordx4 v105, s[16:19], s14 offen sc1 lds
  s_lshl_b32 s9, s2, 9
  v_add_u32 v118, s9, v0
  v_lshlrev_b32 v119, 4, v118
  s_mov_b32 s36, s76
  s_mov_b32 s37, s77
  s_mov_b32 s38, 1966080
  s_mov_b32 s39, 0x00020000
  buffer_load_dwordx4 v[120:123], v119, s[36:39], 0 offen nt
  s_cmp_lg_u32 s8, 4
  s_cbranch_scc1 P3_NOTF
  s_add_u32 s56, s86, 29655040
  s_addc_u32 s57, s87, 0
  s_mov_b32 s58, 229376
  s_mov_b32 s59, 0x00020000
  s_lshl_b32 s9, s2, 7
  s_add_u32 s9, s9, 65536
  v_mov_b32 v188, s9
  v_mov_b32 v189, s60
  s_mov_b64 exec, 1
  buffer_store_dword v189, v188, s[56:59], 0 offen sc1
  s_mov_b64 exec, -1
P3_NOTF:
  v_cvt_pk_bf16_f32 v76, v64, v65
  v_exp_f32 v67, v67
  v_exp_f32 v68, v68
  v_cvt_pk_bf16_f32 v77, v66, v67
  v_exp_f32 v69, v69
  v_exp_f32 v70, v70
  v_exp_f32 v71, v71
  v_cvt_pk_bf16_f32 v78, v68, v69
  v_cvt_pk_bf16_f32 v79, v70, v71
  s_waitcnt lgkmcnt(0)
  v_mfma_f32_32x32x16_bf16 v[56:71], v[16:19], v[112:115], 0
  ds_read_b128 v[12:15], v97 offset:5632
  ds_read_b64 v[20:21], v100 offset:5632
  v_exp_f32 v40, v40
  v_exp_f32 v41, v41
  v_exp_f32 v42, v42
  v_cvt_pk_bf16_f32 v72, v40, v41
  v_exp_f32 v43, v43
  v_mfma_f32_32x32x16_bf16 v[80:95], v[36:39], v[76:79], v[80:95]
  ds_read_b128 v[32:35], v103 offset:2816
  ds_read_b128 v[36:39], v103 offset:3584
  v_exp_f32 v44, v44
  v_cvt_pk_bf16_f32 v73, v42, v43
  v_exp_f32 v45, v45
  v_exp_f32 v46, v46
  v_mfma_f32_32x32x8bf16_1k v[56:71], v[22:23], v[116:117], v[56:71]
  v_cvt_pk_bf16_f32 v74, v44, v45
  v_exp_f32 v47, v47
  v_exp_f32 v48, v48
  v_cvt_pk_bf16_f32 v75, v46, v47
  v_exp_f32 v49, v49
  v_exp_f32 v50, v50
  v_mfma_f32_32x32x16_bf16 v[80:95], v[24:27], v[72:75], v[80:95]
  s_add_u32 m0, s13, 106496
  s_mov_b32 s14, 106496
  buffer_load_dwordx4 v105, s[16:19], s14 offen sc1 lds
  v_cvt_pk_bf16_f32 v76, v48, v49
  v_exp_f32 v51, v51
  v_exp_f32 v52, v52
  v_cvt_pk_bf16_f32 v77, v50, v51
  v_exp_f32 v53, v53
  v_exp_f32 v54, v54
  v_exp_f32 v55, v55
  v_cvt_pk_bf16_f32 v78, v52, v53
  v_cvt_pk_bf16_f32 v79, v54, v55
  s_waitcnt lgkmcnt(0)
  v_mfma_f32_32x32x16_bf16 v[40:55], v[12:15], v[112:115], 0
  ds_read_b128 v[16:19], v97 offset:8448
  ds_read_b64 v[22:23], v100 offset:8448
  v_exp_f32 v56, v56
  v_exp_f32 v57, v57
  v_exp_f32 v58, v58
  v_cvt_pk_bf16_f32 v72, v56, v57
  v_exp_f32 v59, v59
  v_mfma_f32_32x32x16_bf16 v[80:95], v[28:31], v[76:79], v[80:95]
  ds_read_b128 v[24:27], v103 offset:5632
  ds_read_b128 v[28:31], v103 offset:6400
  v_exp_f32 v60, v60
  v_cvt_pk_bf16_f32 v73, v58, v59
  v_exp_f32 v61, v61
  v_exp_f32 v62, v62
  v_mfma_f32_32x32x8bf16_1k v[40:55], v[20:21], v[116:117], v[40:55]
  v_cvt_pk_bf16_f32 v74, v60, v61
  v_exp_f32 v63, v63
  v_exp_f32 v64, v64
  v_cvt_pk_bf16_f32 v75, v62, v63
  v_exp_f32 v65, v65
  v_exp_f32 v66, v66
  v_mfma_f32_32x32x16_bf16 v[80:95], v[32:35], v[72:75], v[80:95]
  s_add_u32 m0, s13, 114688
  s_mov_b32 s14, 114688
  buffer_load_dwordx4 v105, s[16:19], s14 offen sc1 lds
  v_cvt_pk_bf16_f32 v76, v64, v65
  v_exp_f32 v67, v67
  v_exp_f32 v68, v68
  v_cvt_pk_bf16_f32 v77, v66, v67
  v_exp_f32 v69, v69
  v_exp_f32 v70, v70
  v_exp_f32 v71, v71
  v_cvt_pk_bf16_f32 v78, v68, v69
  v_cvt_pk_bf16_f32 v79, v70, v71
  s_waitcnt lgkmcnt(0)
  v_mfma_f32_32x32x16_bf16 v[56:71], v[16:19], v[112:115], 0
  ds_read_b128 v[12:15], v97 offset:11264
  ds_read_b64 v[20:21], v100 offset:11264
  v_exp_f32 v40, v40
  v_exp_f32 v41, v41
  v_exp_f32 v42, v42
  v_cvt_pk_bf16_f32 v72, v40, v41
  v_exp_f32 v43, v43
  v_mfma_f32_32x32x16_bf16 v[80:95], v[36:39], v[76:79], v[80:95]
  ds_read_b128 v[32:35], v103 offset:8448
  ds_read_b128 v[36:39], v103 offset:9216
  v_exp_f32 v44, v44
  v_cvt_pk_bf16_f32 v73, v42, v43
  v_exp_f32 v45, v45
  v_exp_f32 v46, v46
  v_mfma_f32_32x32x8bf16_1k v[56:71], v[22:23], v[116:117], v[56:71]
  v_cvt_pk_bf16_f32 v74, v44, v45
  v_exp_f32 v47, v47
  v_exp_f32 v48, v48
  v_cvt_pk_bf16_f32 v75, v46, v47
  v_exp_f32 v49, v49
  v_exp_f32 v50, v50
  v_mfma_f32_32x32x16_bf16 v[80:95], v[24:27], v[72:75], v[80:95]
  s_add_u32 m0, s13, 122880
  s_mov_b32 s14, 122880
  buffer_load_dwordx4 v105, s[16:19], s14 offen sc1 lds
  v_cvt_pk_bf16_f32 v76, v48, v49
  v_exp_f32 v51, v51
  v_exp_f32 v52, v52
  v_cvt_pk_bf16_f32 v77, v50, v51
  v_exp_f32 v53, v53
  v_exp_f32 v54, v54
  v_exp_f32 v55, v55
  v_cvt_pk_bf16_f32 v78, v52, v53
  v_cvt_pk_bf16_f32 v79, v54, v55
  s_waitcnt lgkmcnt(0)
  v_mfma_f32_32x32x16_bf16 v[40:55], v[12:15], v[112:115], 0
  ds_read_b128 v[16:19], v97 offset:14080
  ds_read_b64 v[22:23], v100 offset:14080
  v_exp_f32 v56, v56
  v_exp_f32 v57, v57
  v_exp_f32 v58, v58
  v_cvt_pk_bf16_f32 v72, v56, v57
  v_exp_f32 v59, v59
  v_mfma_f32_32x32x16_bf16 v[80:95], v[28:31], v[76:79], v[80:95]
  ds_read_b128 v[24:27], v103 offset:11264
  ds_read_b128 v[28:31], v103 offset:12032
  v_exp_f32 v60, v60
  v_cvt_pk_bf16_f32 v73, v58, v59
  v_exp_f32 v61, v61
  v_exp_f32 v62, v62
  v_mfma_f32_32x32x8bf16_1k v[40:55], v[20:21], v[116:117], v[40:55]
  v_cvt_pk_bf16_f32 v74, v60, v61
  v_exp_f32 v63, v63
  v_exp_f32 v64, v64
  v_cvt_pk_bf16_f32 v75, v62, v63
  v_exp_f32 v65, v65
  v_exp_f32 v66, v66
  v_mfma_f32_32x32x16_bf16 v[80:95], v[32:35], v[72:75], v[80:95]
  v_cvt_pk_bf16_f32 v76, v64, v65
  v_exp_f32 v67, v67
  v_exp_f32 v68, v68
  v_cvt_pk_bf16_f32 v77, v66, v67
  v_exp_f32 v69, v69
  v_exp_f32 v70, v70
  v_exp_f32 v71, v71
  v_cvt_pk_bf16_f32 v78, v68, v69
  v_cvt_pk_bf16_f32 v79, v70, v71
  s_waitcnt lgkmcnt(0)
  v_mfma_f32_32x32x16_bf16 v[56:71], v[16:19], v[112:115], 0
  ds_read_b128 v[12:15], v97 offset:16896
  ds_read_b64 v[20:21], v100 offset:16896
  v_exp_f32 v40, v40
  v_exp_f32 v41, v41
  v_exp_f32 v42, v42
  v_cvt_pk_bf16_f32 v72, v40, v41
  v_exp_f32 v43, v43
  v_mfma_f32_32x32x16_bf16 v[80:95], v[36:39], v[76:79], v[80:95]
  ds_read_b128 v[32:35], v103 offset:14080
  ds_read_b128 v[36:39], v103 offset:14848
  v_exp_f32 v44, v44
  v_cvt_pk_bf16_f32 v73, v42, v43
  v_exp_f32 v45, v45
  v_exp_f32 v46, v46
  v_mfma_f32_32x32x8bf16_1k v[56:71], v[22:23], v[116:117], v[56:71]
  v_cvt_pk_bf16_f32 v74, v44, v45
  v_exp_f32 v47, v47
  v_exp_f32 v48, v48
  v_cvt_pk_bf16_f32 v75, v46, v47
  v_exp_f32 v49, v49
  v_exp_f32 v50, v50
  v_mfma_f32_32x32x16_bf16 v[80:95], v[24:27], v[72:75], v[80:95]
  s_mov_b32 s9, 53687092
  v_mul_hi_u32 v124, s9, v118
  v_mul_u32_u24 v125, 80, v124
  v_sub_u32 v125, v118, v125
  s_mov_b32 s9, 429496730
  v_mul_hi_u32 v126, s9, v125
  v_mul_u32_u24 v127, 10, v126
  v_sub_u32 v125, v125, v127
  v_and_b32 v127, 0xfffffff3, v124
  v_bfe_u32 v119, v124, 2, 1
  v_lshl_or_b32 v127, v119, 3, v127
  v_bfe_u32 v119, v124, 3, 1
  v_lshl_or_b32 v127, v119, 2, v127
  s_mov_b32 s9, 245760
  v_mul_lo_u32 v126, s9, v126
  v_mul_u32_u24 v127, 160, v127
  v_lshlrev_b32 v125, 4, v125
  v_add3_u32 v119, v126, v125, v127
  s_mov_b32 s9, 122880
  v_cmp_gt_u32 vcc, s9, v118
  v_mov_b32 v124, 0x7ffffff0
  s_nop 0
  v_cndmask_b32 v119, v124, v119, vcc
  s_add_u32 s36, s86, 23429120
  s_addc_u32 s37, s87, 0
  s_mov_b32 s38, 1966080
  s_mov_b32 s39, 0x00020000
  v_cvt_pk_bf16_f32 v76, v48, v49
  v_exp_f32 v51, v51
  v_exp_f32 v52, v52
  v_cvt_pk_bf16_f32 v77, v50, v51
  v_exp_f32 v53, v53
  v_exp_f32 v54, v54
  v_exp_f32 v55, v55
  v_cvt_pk_bf16_f32 v78, v52, v53
  v_cvt_pk_bf16_f32 v79, v54, v55
  s_waitcnt lgkmcnt(0)
  v_mfma_f32_32x32x16_bf16 v[40:55], v[12:15], v[112:115], 0
  ds_read_b128 v[16:19], v97 offset:19712
  ds_read_b64 v[22:23], v100 offset:19712
  v_exp_f32 v56, v56
  v_exp_f32 v57, v57
  v_exp_f32 v58, v58
  v_cvt_pk_bf16_f32 v72, v56, v57
  v_exp_f32 v59, v59
  v_mfma_f32_32x32x16_bf16 v[80:95], v[28:31], v[76:79], v[80:95]
  ds_read_b128 v[24:27], v103 offset:16896
  ds_read_b128 v[28:31], v103 offset:17664
  v_exp_f32 v60, v60
  v_cvt_pk_bf16_f32 v73, v58, v59
  v_exp_f32 v61, v61
  v_exp_f32 v62, v62
  v_mfma_f32_32x32x8bf16_1k v[40:55], v[20:21], v[116:117], v[40:55]
  v_cvt_pk_bf16_f32 v74, v60, v61
  v_exp_f32 v63, v63
  v_exp_f32 v64, v64
  v_cvt_pk_bf16_f32 v75, v62, v63
  v_exp_f32 v65, v65
  v_exp_f32 v66, v66
  v_mfma_f32_32x32x16_bf16 v[80:95], v[32:35], v[72:75], v[80:95]
  v_cvt_pk_bf16_f32 v76, v64, v65
  v_exp_f32 v67, v67
  v_exp_f32 v68, v68
  v_cvt_pk_bf16_f32 v77, v66, v67
  v_exp_f32 v69, v69
  v_exp_f32 v70, v70
  v_exp_f32 v71, v71
  v_cvt_pk_bf16_f32 v78, v68, v69
  v_cvt_pk_bf16_f32 v79, v70, v71
  s_waitcnt lgkmcnt(0)
  v_mfma_f32_32x32x16_bf16 v[56:71], v[16:19], v[112:115], 0
  ds_read_b128 v[12:15], v97 offset:22528
  ds_read_b64 v[20:21], v100 offset:22528
  v_exp_f32 v40, v40
  v_exp_f32 v41, v41
  v_exp_f32 v42, v42
  v_cvt_pk_bf16_f32 v72, v40, v41
  v_exp_f32 v43, v43
  v_mfma_f32_32x32x16_bf16 v[80:95], v[36:39], v[76:79], v[80:95]
  ds_read_b128 v[32:35], v103 offset:19712
  ds_read_b128 v[36:39], v103 offset:20480
  v_exp_f32 v44, v44
  v_cvt_pk_bf16_f32 v73, v42, v43
  v_exp_f32 v45, v45
  v_exp_f32 v46, v46
  v_mfma_f32_32x32x8bf16_1k v[56:71], v[22:23], v[116:117], v[56:71]
  v_cvt_pk_bf16_f32 v74, v44, v45
  v_exp_f32 v47, v47
  v_exp_f32 v48, v48
  v_cvt_pk_bf16_f32 v75, v46, v47
  v_exp_f32 v49, v49
  v_exp_f32 v50, v50
  v_mfma_f32_32x32x16_bf16 v[80:95], v[24:27], v[72:75], v[80:95]
  v_cvt_pk_bf16_f32 v76, v48, v49
  v_exp_f32 v51, v51
  v_exp_f32 v52, v52
  v_cvt_pk_bf16_f32 v77, v50, v51
  v_exp_f32 v53, v53
  v_exp_f32 v54, v54
  v_exp_f32 v55, v55
  v_cvt_pk_bf16_f32 v78, v52, v53
  v_cvt_pk_bf16_f32 v79, v54, v55
  s_waitcnt lgkmcnt(0)
  v_mfma_f32_32x32x16_bf16 v[40:55], v[12:15], v[112:115], 0
  ds_read_b128 v[16:19], v97 offset:25344
  ds_read_b64 v[22:23], v100 offset:25344
  v_exp_f32 v56, v56
  v_exp_f32 v57, v57
  v_exp_f32 v58, v58
  v_cvt_pk_bf16_f32 v72, v56, v57
  v_exp_f32 v59, v59
  v_mfma_f32_32x32x16_bf16 v[80:95], v[28:31], v[76:79], v[80:95]
  ds_read_b128 v[24:27], v103 offset:22528
  ds_read_b128 v[28:31], v103 offset:23296
  v_exp_f32 v60, v60
  v_cvt_pk_bf16_f32 v73, v58, v59
  v_exp_f32 v61, v61
  v_exp_f32 v62, v62
  v_mfma_f32_32x32x8bf16_1k v[40:55], v[20:21], v[116:117], v[40:55]
  v_cvt_pk_bf16_f32 v74, v60, v61
  v_exp_f32 v63, v63
  v_exp_f32 v64, v64
  v_cvt_pk_bf16_f32 v75, v62, v63
  v_exp_f32 v65, v65
  v_exp_f32 v66, v66
  v_mfma_f32_32x32x16_bf16 v[80:95], v[32:35], v[72:75], v[80:95]
  v_cvt_pk_bf16_f32 v76, v64, v65
  v_exp_f32 v67, v67
  v_exp_f32 v68, v68
  v_cvt_pk_bf16_f32 v77, v66, v67
  v_exp_f32 v69, v69
  v_exp_f32 v70, v70
  v_exp_f32 v71, v71
  v_cvt_pk_bf16_f32 v78, v68, v69
  v_cvt_pk_bf16_f32 v79, v70, v71
  s_waitcnt lgkmcnt(0)
  v_mfma_f32_32x32x16_bf16 v[56:71], v[16:19], v[112:115], 0
  ds_read_b128 v[12:15], v97 offset:28160
  ds_read_b64 v[20:21], v100 offset:28160
  v_exp_f32 v40, v40
  v_exp_f32 v41, v41
  v_exp_f32 v42, v42
  v_cvt_pk_bf16_f32 v72, v40, v41
  v_exp_f32 v43, v43
  v_mfma_f32_32x32x16_bf16 v[80:95], v[36:39], v[76:79], v[80:95]
  ds_read_b128 v[32:35], v103 offset:25344
  ds_read_b128 v[36:39], v103 offset:26112
  v_exp_f32 v44, v44
  v_cvt_pk_bf16_f32 v73, v42, v43
  v_exp_f32 v45, v45
  v_exp_f32 v46, v46
  v_mfma_f32_32x32x8bf16_1k v[56:71], v[22:23], v[116:117], v[56:71]
  v_cvt_pk_bf16_f32 v74, v44, v45
  v_exp_f32 v47, v47
  v_exp_f32 v48, v48
  v_cvt_pk_bf16_f32 v75, v46, v47
  v_exp_f32 v49, v49
  v_exp_f32 v50, v50
  v_mfma_f32_32x32x16_bf16 v[80:95], v[24:27], v[72:75], v[80:95]
  v_cvt_pk_bf16_f32 v76, v48, v49
  v_exp_f32 v51, v51
  v_exp_f32 v52, v52
  v_cvt_pk_bf16_f32 v77, v50, v51
  v_exp_f32 v53, v53
  v_exp_f32 v54, v54
  v_exp_f32 v55, v55
  v_cvt_pk_bf16_f32 v78, v52, v53
  v_cvt_pk_bf16_f32 v79, v54, v55
  s_waitcnt lgkmcnt(0)
  v_mfma_f32_32x32x16_bf16 v[40:55], v[12:15], v[112:115], 0
  ds_read_b128 v[16:19], v97 offset:30976
  ds_read_b64 v[22:23], v100 offset:30976
  v_exp_f32 v56, v56
  v_exp_f32 v57, v57
  v_exp_f32 v58, v58
  v_cvt_pk_bf16_f32 v72, v56, v57
  v_exp_f32 v59, v59
  v_mfma_f32_32x32x16_bf16 v[80:95], v[28:31], v[76:79], v[80:95]
  ds_read_b128 v[24:27], v103 offset:28160
  ds_read_b128 v[28:31], v103 offset:28928
  v_exp_f32 v60, v60
  v_cvt_pk_bf16_f32 v73, v58, v59
  v_exp_f32 v61, v61
  v_exp_f32 v62, v62
  v_mfma_f32_32x32x8bf16_1k v[40:55], v[20:21], v[116:117], v[40:55]
  v_cvt_pk_bf16_f32 v74, v60, v61
  v_exp_f32 v63, v63
  v_exp_f32 v64, v64
  v_cvt_pk_bf16_f32 v75, v62, v63
  v_exp_f32 v65, v65
  v_exp_f32 v66, v66
  v_mfma_f32_32x32x16_bf16 v[80:95], v[32:35], v[72:75], v[80:95]
  v_cvt_pk_bf16_f32 v76, v64, v65
  v_exp_f32 v67, v67
  v_exp_f32 v68, v68
  v_cvt_pk_bf16_f32 v77, v66, v67
  v_exp_f32 v69, v69
  v_exp_f32 v70, v70
  v_exp_f32 v71, v71
  v_cvt_pk_bf16_f32 v78, v68, v69
  v_cvt_pk_bf16_f32 v79, v70, v71
  s_waitcnt lgkmcnt(0)
  v_mfma_f32_32x32x16_bf16 v[56:71], v[16:19], v[112:115], 0
  ds_read_b128 v[12:15], v97 offset:33792
  ds_read_b64 v[20:21], v100 offset:33792
  v_exp_f32 v40, v40
  v_exp_f32 v41, v41
  v_exp_f32 v42, v42
  v_cvt_pk_bf16_f32 v72, v40, v41
  v_exp_f32 v43, v43
  v_mfma_f32_32x32x16_bf16 v[80:95], v[36:39], v[76:79], v[80:95]
  ds_read_b128 v[32:35], v103 offset:30976
  ds_read_b128 v[36:39], v103 offset:31744
  v_exp_f32 v44, v44
  v_cvt_pk_bf16_f32 v73, v42, v43
  v_exp_f32 v45, v45
  v_exp_f32 v46, v46
  v_mfma_f32_32x32x8bf16_1k v[56:71], v[22:23], v[116:117], v[56:71]
  v_cvt_pk_bf16_f32 v74, v44, v45
  v_exp_f32 v47, v47
  v_exp_f32 v48, v48
  v_cvt_pk_bf16_f32 v75, v46, v47
  v_exp_f32 v49, v49
  v_exp_f32 v50, v50
  v_mfma_f32_32x32x16_bf16 v[80:95], v[24:27], v[72:75], v[80:95]
  v_cvt_pk_bf16_f32 v76, v48, v49
  v_exp_f32 v51, v51
  v_exp_f32 v52, v52
  v_cvt_pk_bf16_f32 v77, v50, v51
  v_exp_f32 v53, v53
  v_exp_f32 v54, v54
  v_exp_f32 v55, v55
  v_cvt_pk_bf16_f32 v78, v52, v53
  v_cvt_pk_bf16_f32 v79, v54, v55
  s_waitcnt lgkmcnt(0)
  v_mfma_f32_32x32x16_bf16 v[40:55], v[12:15], v[112:115], 0
  ds_read_b128 v[16:19], v97 offset:36608
  ds_read_b64 v[22:23], v100 offset:36608
  v_exp_f32 v56, v56
  v_exp_f32 v57, v57
  v_exp_f32 v58, v58
  v_cvt_pk_bf16_f32 v72, v56, v57
  v_exp_f32 v59, v59
  v_mfma_f32_32x32x16_bf16 v[80:95], v[28:31], v[76:79], v[80:95]
  ds_read_b128 v[24:27], v103 offset:33792
  ds_read_b128 v[28:31], v103 offset:34560
  v_exp_f32 v60, v60
  v_cvt_pk_bf16_f32 v73, v58, v59
  v_exp_f32 v61, v61
  v_exp_f32 v62, v62
  v_mfma_f32_32x32x8bf16_1k v[40:55], v[20:21], v[116:117], v[40:55]
  v_cvt_pk_bf16_f32 v74, v60, v61
  v_exp_f32 v63, v63
  v_exp_f32 v64, v64
  v_cvt_pk_bf16_f32 v75, v62, v63
  v_exp_f32 v65, v65
  v_exp_f32 v66, v66
  v_mfma_f32_32x32x16_bf16 v[80:95], v[32:35], v[72:75], v[80:95]
  v_cvt_pk_bf16_f32 v76, v64, v65
  v_exp_f32 v67, v67
  v_exp_f32 v68, v68
  v_cvt_pk_bf16_f32 v77, v66, v67
  v_exp_f32 v69, v69
  v_exp_f32 v70, v70
  v_exp_f32 v71, v71
  v_cvt_pk_bf16_f32 v78, v68, v69
  v_cvt_pk_bf16_f32 v79, v70, v71
  s_waitcnt lgkmcnt(0)
  v_mfma_f32_32x32x16_bf16 v[56:71], v[16:19], v[112:115], 0
  ds_read_b128 v[12:15], v97 offset:39424
  ds_read_b64 v[20:21], v100 offset:39424
  v_exp_f32 v40, v40
  v_exp_f32 v41, v41
  v_exp_f32 v42, v42
  v_cvt_pk_bf16_f32 v72, v40, v41
  v_exp_f32 v43, v43
  v_mfma_f32_32x32x16_bf16 v[80:95], v[36:39], v[76:79], v[80:95]
  ds_read_b128 v[32:35], v103 offset:36608
  ds_read_b128 v[36:39], v103 offset:37376
  v_exp_f32 v44, v44
  v_cvt_pk_bf16_f32 v73, v42, v43
  v_exp_f32 v45, v45
  v_exp_f32 v46, v46
  v_mfma_f32_32x32x8bf16_1k v[56:71], v[22:23], v[116:117], v[56:71]
  v_cvt_pk_bf16_f32 v74, v44, v45
  v_exp_f32 v47, v47
  v_exp_f32 v48, v48
  v_cvt_pk_bf16_f32 v75, v46, v47
  v_exp_f32 v49, v49
  v_exp_f32 v50, v50
  v_mfma_f32_32x32x16_bf16 v[80:95], v[24:27], v[72:75], v[80:95]
  v_cvt_pk_bf16_f32 v76, v48, v49
  v_exp_f32 v51, v51
  v_exp_f32 v52, v52
  v_cvt_pk_bf16_f32 v77, v50, v51
  v_exp_f32 v53, v53
  v_exp_f32 v54, v54
  v_exp_f32 v55, v55
  v_cvt_pk_bf16_f32 v78, v52, v53
  v_cvt_pk_bf16_f32 v79, v54, v55
  s_waitcnt lgkmcnt(0)
  v_mfma_f32_32x32x16_bf16 v[40:55], v[12:15], v[112:115], 0
  ds_read_b128 v[16:19], v97 offset:42240
  ds_read_b64 v[22:23], v100 offset:42240
  v_exp_f32 v56, v56
  v_exp_f32 v57, v57
  v_exp_f32 v58, v58
  v_cvt_pk_bf16_f32 v72, v56, v57
  v_exp_f32 v59, v59
  v_mfma_f32_32x32x16_bf16 v[80:95], v[28:31], v[76:79], v[80:95]
  ds_read_b128 v[24:27], v103 offset:39424
  ds_read_b128 v[28:31], v103 offset:40192
  v_exp_f32 v60, v60
  v_cvt_pk_bf16_f32 v73, v58, v59
  v_exp_f32 v61, v61
  v_exp_f32 v62, v62
  v_mfma_f32_32x32x8bf16_1k v[40:55], v[20:21], v[116:117], v[40:55]
  v_cvt_pk_bf16_f32 v74, v60, v61
  v_exp_f32 v63, v63
  v_exp_f32 v64, v64
  v_cvt_pk_bf16_f32 v75, v62, v63
  v_exp_f32 v65, v65
  v_exp_f32 v66, v66
  v_mfma_f32_32x32x16_bf16 v[80:95], v[32:35], v[72:75], v[80:95]
  v_cvt_pk_bf16_f32 v76, v64, v65
  v_exp_f32 v67, v67
  v_exp_f32 v68, v68
  v_cvt_pk_bf16_f32 v77, v66, v67
  v_exp_f32 v69, v69
  v_exp_f32 v70, v70
  v_exp_f32 v71, v71
  v_cvt_pk_bf16_f32 v78, v68, v69
  v_cvt_pk_bf16_f32 v79, v70, v71
  s_waitcnt vmcnt(0)
  s_barrier
  s_waitcnt lgkmcnt(0)
  v_mfma_f32_32x32x16_bf16 v[56:71], v[16:19], v[112:115], 0
  ds_read_b128 v[12:15], v98 offset:0
  ds_read_b64 v[20:21], v101 offset:0
  v_exp_f32 v40, v40
  v_exp_f32 v41, v41
  v_exp_f32 v42, v42
  v_cvt_pk_bf16_f32 v72, v40, v41
  v_exp_f32 v43, v43
  v_mfma_f32_32x32x16_bf16 v[80:95], v[36:39], v[76:79], v[80:95]
  ds_read_b128 v[32:35], v103 offset:42240
  ds_read_b128 v[36:39], v103 offset:43008
  v_exp_f32 v44, v44
  v_cvt_pk_bf16_f32 v73, v42, v43
  v_exp_f32 v45, v45
  v_exp_f32 v46, v46
  v_mfma_f32_32x32x8bf16_1k v[56:71], v[22:23], v[116:117], v[56:71]
  v_cvt_pk_bf16_f32 v74, v44, v45
  v_exp_f32 v47, v47
  v_exp_f32 v48, v48
  v_cvt_pk_bf16_f32 v75, v46, v47
  v_exp_f32 v49, v49
  v_exp_f32 v50, v50
  v_mfma_f32_32x32x16_bf16 v[80:95], v[24:27], v[72:75], v[80:95]
  s_cmp_ge_u32 s8, 4
  s_cbranch_scc1 ATT_NP_3
  s_add_u32 m0, s13, 40960
  s_mov_b32 s14, 176128
  buffer_load_dwordx4 v105, s[16:19], s14 offen sc1 lds
ATT_NP_3:
  s_add_u32 m0, s13, 0
  s_mov_b32 s14, 135168
  buffer_load_dwordx4 v105, s[16:19], s14 offen sc1 lds
  v_cvt_pk_bf16_f32 v76, v48, v49
  v_exp_f32 v51, v51
  v_exp_f32 v52, v52
  v_cvt_pk_bf16_f32 v77, v50, v51
  v_exp_f32 v53, v53
  v_exp_f32 v54, v54
  v_exp_f32 v55, v55
  v_cvt_pk_bf16_f32 v78, v52, v53
  v_cvt_pk_bf16_f32 v79, v54, v55
  s_waitcnt lgkmcnt(0)
  v_mfma_f32_32x32x16_bf16 v[40:55], v[12:15], v[112:115], 0
  ds_read_b128 v[16:19], v98 offset:2816
  ds_read_b64 v[22:23], v101 offset:2816
  v_exp_f32 v56, v56
  v_exp_f32 v57, v57
  v_exp_f32 v58, v58
  v_cvt_pk_bf16_f32 v72, v56, v57
  v_exp_f32 v59, v59
  v_mfma_f32_32x32x16_bf16 v[80:95], v[28:31], v[76:79], v[80:95]
  ds_read_b128 v[24:27], v104 offset:0
  ds_read_b128 v[28:31], v104 offset:768
  v_exp_f32 v60, v60
  v_cvt_pk_bf16_f32 v73, v58, v59
  v_exp_f32 v61, v61
  v_exp_f32 v62, v62
  v_mfma_f32_32x32x8bf16_1k v[40:55], v[20:21], v[116:117], v[40:55]
  v_cvt_pk_bf16_f32 v74, v60, v61
  v_exp_f32 v63, v63
  v_exp_f32 v64, v64
  v_cvt_pk_bf16_f32 v75, v62, v63
  v_exp_f32 v65, v65
  v_exp_f32 v66, v66
  v_mfma_f32_32x32x16_bf16 v[80:95], v[32:35], v[72:75], v[80:95]
  buffer_store_dwordx4 v[120:123], v119, s[36:39], 0 offen sc1
  v_cvt_pk_bf16_f32 v76, v64, v65
  v_exp_f32 v67, v67
  v_exp_f32 v68, v68
  v_cvt_pk_bf16_f32 v77, v66, v67
  v_exp_f32 v69, v69
  v_exp_f32 v70, v70
  v_exp_f32 v71, v71
  v_cvt_pk_bf16_f32 v78, v68, v69
  v_cvt_pk_bf16_f32 v79, v70, v71
  s_waitcnt lgkmcnt(0)
  v_mfma_f32_32x32x16_bf16 v[56:71], v[16:19], v[112:115], 0
  ds_read_b128 v[12:15], v98 offset:5632
  ds_read_b64 v[20:21], v101 offset:5632
  v_exp_f32 v40, v40
  v_exp_f32 v41, v41
  v_exp_f32 v42, v42
  v_cvt_pk_bf16_f32 v72, v40, v41
  v_exp_f32 v43, v43
  v_mfma_f32_32x32x16_bf16 v[80:95], v[36:39], v[76:79], v[80:95]
  ds_read_b128 v[32:35], v104 offset:2816
  ds_read_b128 v[36:39], v104 offset:3584
  v_exp_f32 v44, v44
  v_cvt_pk_bf16_f32 v73, v42, v43
  v_exp_f32 v45, v45
  v_exp_f32 v46, v46
  v_mfma_f32_32x32x8bf16_1k v[56:71], v[22:23], v[116:117], v[56:71]
  v_cvt_pk_bf16_f32 v74, v44, v45
  v_exp_f32 v47, v47
  v_exp_f32 v48, v48
  v_cvt_pk_bf16_f32 v75, v46, v47
  v_exp_f32 v49, v49
  v_exp_f32 v50, v50
  v_mfma_f32_32x32x16_bf16 v[80:95], v[24:27], v[72:75], v[80:95]
  s_add_u32 m0, s13, 8192
  s_mov_b32 s14, 143360
  buffer_load_dwordx4 v105, s[16:19], s14 offen sc1 lds
  v_cvt_pk_bf16_f32 v76, v48, v49
  v_exp_f32 v51, v51
  v_exp_f32 v52, v52
  v_cvt_pk_bf16_f32 v77, v50, v51
  v_exp_f32 v53, v53
  v_exp_f32 v54, v54
  v_exp_f32 v55, v55
  v_cvt_pk_bf16_f32 v78, v52, v53
  v_cvt_pk_bf16_f32 v79, v54, v55
  s_waitcnt lgkmcnt(0)
  v_mfma_f32_32x32x16_bf16 v[40:55], v[12:15], v[112:115], 0
  ds_read_b128 v[16:19], v98 offset:8448
  ds_read_b64 v[22:23], v101 offset:8448
  v_exp_f32 v56, v56
  v_exp_f32 v57, v57
  v_exp_f32 v58, v58
  v_cvt_pk_bf16_f32 v72, v56, v57
  v_exp_f32 v59, v59
  v_mfma_f32_32x32x16_bf16 v[80:95], v[28:31], v[76:79], v[80:95]
  ds_read_b128 v[24:27], v104 offset:5632
  ds_read_b128 v[28:31], v104 offset:6400
  v_exp_f32 v60, v60
  v_cvt_pk_bf16_f32 v73, v58, v59
  v_exp_f32 v61, v61
  v_exp_f32 v62, v62
  v_mfma_f32_32x32x8bf16_1k v[40:55], v[20:21], v[116:117], v[40:55]
  v_cvt_pk_bf16_f32 v74, v60, v61
  v_exp_f32 v63, v63
  v_exp_f32 v64, v64
  v_cvt_pk_bf16_f32 v75, v62, v63
  v_exp_f32 v65, v65
  v_exp_f32 v66, v66
  v_mfma_f32_32x32x16_bf16 v[80:95], v[32:35], v[72:75], v[80:95]
  v_cvt_pk_bf16_f32 v76, v64, v65
  v_exp_f32 v67, v67
  v_exp_f32 v68, v68
  v_cvt_pk_bf16_f32 v77, v66, v67
  v_exp_f32 v69, v69
  v_exp_f32 v70, v70
  v_exp_f32 v71, v71
  v_cvt_pk_bf16_f32 v78, v68, v69
  v_cvt_pk_bf16_f32 v79, v70, v71
  s_waitcnt lgkmcnt(0)
  v_mfma_f32_32x32x16_bf16 v[56:71], v[16:19], v[112:115], 0
  ds_read_b128 v[12:15], v98 offset:11264
  ds_read_b64 v[20:21], v101 offset:11264
  v_exp_f32 v40, v40
  v_exp_f32 v41, v41
  v_exp_f32 v42, v42
  v_cvt_pk_bf16_f32 v72, v40, v41
  v_exp_f32 v43, v43
  v_mfma_f32_32x32x16_bf16 v[80:95], v[36:39], v[76:79], v[80:95]
  ds_read_b128 v[32:35], v104 offset:8448
  ds_read_b128 v[36:39], v104 offset:9216
  v_exp_f32 v44, v44
  v_cvt_pk_bf16_f32 v73, v42, v43
  v_exp_f32 v45, v45
  v_exp_f32 v46, v46
  v_mfma_f32_32x32x8bf16_1k v[56:71], v[22:23], v[116:117], v[56:71]
  v_cvt_pk_bf16_f32 v74, v44, v45
  v_exp_f32 v47, v47
  v_exp_f32 v48, v48
  v_cvt_pk_bf16_f32 v75, v46, v47
  v_exp_f32 v49, v49
  v_exp_f32 v50, v50
  v_mfma_f32_32x32x16_bf16 v[80:95], v[24:27], v[72:75], v[80:95]
  s_add_u32 m0, s13, 16384
  s_mov_b32 s14, 151552
  buffer_load_dwordx4 v105, s[16:19], s14 offen sc1 lds
  v_cvt_pk_bf16_f32 v76, v48, v49
  v_exp_f32 v51, v51
  v_exp_f32 v52, v52
  v_cvt_pk_bf16_f32 v77, v50, v51
  v_exp_f32 v53, v53
  v_exp_f32 v54, v54
  v_exp_f32 v55, v55
  v_cvt_pk_bf16_f32 v78, v52, v53
  v_cvt_pk_bf16_f32 v79, v54, v55
  s_waitcnt lgkmcnt(0)
  v_mfma_f32_32x32x16_bf16 v[40:55], v[12:15], v[112:115], 0
  ds_read_b128 v[16:19], v98 offset:14080
  ds_read_b64 v[22:23], v101 offset:14080
  v_exp_f32 v56, v56
  v_exp_f32 v57, v57
  v_exp_f32 v58, v58
  v_cvt_pk_bf16_f32 v72, v56, v57
  v_exp_f32 v59, v59
  v_mfma_f32_32x32x16_bf16 v[80:95], v[28:31], v[76:79], v[80:95]
  ds_read_b128 v[24:27], v104 offset:11264
  ds_read_b128 v[28:31], v104 offset:12032
  v_exp_f32 v60, v60
  v_cvt_pk_bf16_f32 v73, v58, v59
  v_exp_f32 v61, v61
  v_exp_f32 v62, v62
  v_mfma_f32_32x32x8bf16_1k v[40:55], v[20:21], v[116:117], v[40:55]
  v_cvt_pk_bf16_f32 v74, v60, v61
  v_exp_f32 v63, v63
  v_exp_f32 v64, v64
  v_cvt_pk_bf16_f32 v75, v62, v63
  v_exp_f32 v65, v65
  v_exp_f32 v66, v66
  v_mfma_f32_32x32x16_bf16 v[80:95], v[32:35], v[72:75], v[80:95]
  v_cvt_pk_bf16_f32 v76, v64, v65
  v_exp_f32 v67, v67
  v_exp_f32 v68, v68
  v_cvt_pk_bf16_f32 v77, v66, v67
  v_exp_f32 v69, v69
  v_exp_f32 v70, v70
  v_exp_f32 v71, v71
  v_cvt_pk_bf16_f32 v78, v68, v69
  v_cvt_pk_bf16_f32 v79, v70, v71
  s_waitcnt lgkmcnt(0)
  v_mfma_f32_32x32x16_bf16 v[56:71], v[16:19], v[112:115], 0
  ds_read_b128 v[12:15], v98 offset:16896
  ds_read_b64 v[20:21], v101 offset:16896
  v_exp_f32 v40, v40
  v_exp_f32 v41, v41
  v_exp_f32 v42, v42
  v_cvt_pk_bf16_f32 v72, v40, v41
  v_exp_f32 v43, v43
  v_mfma_f32_32x32x16_bf16 v[80:95], v[36:39], v[76:79], v[80:95]
  ds_read_b128 v[32:35], v104 offset:14080
  ds_read_b128 v[36:39], v104 offset:14848
  v_exp_f32 v44, v44
  v_cvt_pk_bf16_f32 v73, v42, v43
  v_exp_f32 v45, v45
  v_exp_f32 v46, v46
  v_mfma_f32_32x32x8bf16_1k v[56:71], v[22:23], v[116:117], v[56:71]
  v_cvt_pk_bf16_f32 v74, v44, v45
  v_exp_f32 v47, v47
  v_exp_f32 v48, v48
  v_cvt_pk_bf16_f32 v75, v46, v47
  v_exp_f32 v49, v49
  v_exp_f32 v50, v50
  v_mfma_f32_32x32x16_bf16 v[80:95], v[24:27], v[72:75], v[80:95]
  s_add_u32 m0, s13, 24576
  s_mov_b32 s14, 159744
  buffer_load_dwordx4 v105, s[16:19], s14 offen sc1 lds
  v_cvt_pk_bf16_f32 v76, v48, v49
  v_exp_f32 v51, v51
  v_exp_f32 v52, v52
  v_cvt_pk_bf16_f32 v77, v50, v51
  v_exp_f32 v53, v53
  v_exp_f32 v54, v54
  v_exp_f32 v55, v55
  v_cvt_pk_bf16_f32 v78, v52, v53
  v_cvt_pk_bf16_f32 v79, v54, v55
  s_waitcnt lgkmcnt(0)
  v_mfma_f32_32x32x16_bf16 v[40:55], v[12:15], v[112:115], 0
  ds_read_b128 v[16:19], v98 offset:19712
  ds_read_b64 v[22:23], v101 offset:19712
  v_exp_f32 v56, v56
  v_exp_f32 v57, v57
  v_exp_f32 v58, v58
  v_cvt_pk_bf16_f32 v72, v56, v57
  v_exp_f32 v59, v59
  v_mfma_f32_32x32x16_bf16 v[80:95], v[28:31], v[76:79], v[80:95]
  ds_read_b128 v[24:27], v104 offset:16896
  ds_read_b128 v[28:31], v104 offset:17664
  v_exp_f32 v60, v60
  v_cvt_pk_bf16_f32 v73, v58, v59
  v_exp_f32 v61, v61
  v_exp_f32 v62, v62
  v_mfma_f32_32x32x8bf16_1k v[40:55], v[20:21], v[116:117], v[40:55]
  v_cvt_pk_bf16_f32 v74, v60, v61
  v_exp_f32 v63, v63
  v_exp_f32 v64, v64
  v_cvt_pk_bf16_f32 v75, v62, v63
  v_exp_f32 v65, v65
  v_exp_f32 v66, v66
  v_mfma_f32_32x32x16_bf16 v[80:95], v[32:35], v[72:75], v[80:95]
  v_cvt_pk_bf16_f32 v76, v64, v65
  v_exp_f32 v67, v67
  v_exp_f32 v68, v68
  v_cvt_pk_bf16_f32 v77, v66, v67
  v_exp_f32 v69, v69
  v_exp_f32 v70, v70
  v_exp_f32 v71, v71
  v_cvt_pk_bf16_f32 v78, v68, v69
  v_cvt_pk_bf16_f32 v79, v70, v71
  s_waitcnt lgkmcnt(0)
  v_mfma_f32_32x32x16_bf16 v[56:71], v[16:19], v[112:115], 0
  ds_read_b128 v[12:15], v98 offset:22528
  ds_read_b64 v[20:21], v101 offset:22528
  v_exp_f32 v40, v40
  v_exp_f32 v41, v41
  v_exp_f32 v42, v42
  v_cvt_pk_bf16_f32 v72, v40, v41
  v_exp_f32 v43, v43
  v_mfma_f32_32x32x16_bf16 v[80:95], v[36:39], v[76:79], v[80:95]
  ds_read_b128 v[32:35], v104 offset:19712
  ds_read_b128 v[36:39], v104 offset:20480
  v_exp_f32 v44, v44
  v_cvt_pk_bf16_f32 v73, v42, v43
  v_exp_f32 v45, v45
  v_exp_f32 v46, v46
  v_mfma_f32_32x32x8bf16_1k v[56:71], v[22:23], v[116:117], v[56:71]
  v_cvt_pk_bf16_f32 v74, v44, v45
  v_exp_f32 v47, v47
  v_exp_f32 v48, v48
  v_cvt_pk_bf16_f32 v75, v46, v47
  v_exp_f32 v49, v49
  v_exp_f32 v50, v50
  v_mfma_f32_32x32x16_bf16 v[80:95], v[24:27], v[72:75], v[80:95]
  s_add_u32 m0, s13, 32768
  s_mov_b32 s14, 167936
  buffer_load_dwordx4 v105, s[16:19], s14 offen sc1 lds
  v_cvt_pk_bf16_f32 v76, v48, v49
  v_exp_f32 v51, v51
  v_exp_f32 v52, v52
  v_cvt_pk_bf16_f32 v77, v50, v51
  v_exp_f32 v53, v53
  v_exp_f32 v54, v54
  v_exp_f32 v55, v55
  v_cvt_pk_bf16_f32 v78, v52, v53
  v_cvt_pk_bf16_f32 v79, v54, v55
  s_waitcnt lgkmcnt(0)
  v_mfma_f32_32x32x16_bf16 v[40:55], v[12:15], v[112:115], 0
  ds_read_b128 v[16:19], v98 offset:25344
  ds_read_b64 v[22:23], v101 offset:25344
  v_exp_f32 v56, v56
  v_exp_f32 v57, v57
  v_exp_f32 v58, v58
  v_cvt_pk_bf16_f32 v72, v56, v57
  v_exp_f32 v59, v59
  v_mfma_f32_32x32x16_bf16 v[80:95], v[28:31], v[76:79], v[80:95]
  ds_read_b128 v[24:27], v104 offset:22528
  ds_read_b128 v[28:31], v104 offset:23296
  v_exp_f32 v60, v60
  v_cvt_pk_bf16_f32 v73, v58, v59
  v_exp_f32 v61, v61
  v_exp_f32 v62, v62
  v_mfma_f32_32x32x8bf16_1k v[40:55], v[20:21], v[116:117], v[40:55]
  v_cvt_pk_bf16_f32 v74, v60, v61
  v_exp_f32 v63, v63
  v_exp_f32 v64, v64
  v_cvt_pk_bf16_f32 v75, v62, v63
  v_exp_f32 v65, v65
  v_exp_f32 v66, v66
  v_mfma_f32_32x32x16_bf16 v[80:95], v[32:35], v[72:75], v[80:95]
  v_cvt_pk_bf16_f32 v76, v64, v65
  v_exp_f32 v67, v67
  v_exp_f32 v68, v68
  v_cvt_pk_bf16_f32 v77, v66, v67
  v_exp_f32 v69, v69
  v_exp_f32 v70, v70
  v_exp_f32 v71, v71
  v_cvt_pk_bf16_f32 v78, v68, v69
  v_cvt_pk_bf16_f32 v79, v70, v71
  s_waitcnt lgkmcnt(0)
  v_mfma_f32_32x32x16_bf16 v[56:71], v[16:19], v[112:115], 0
  ds_read_b128 v[12:15], v98 offset:28160
  ds_read_b64 v[20:21], v101 offset:28160
  v_exp_f32 v40, v40
  v_exp_f32 v41, v41
  v_exp_f32 v42, v42
  v_cvt_pk_bf16_f32 v72, v40, v41
  v_exp_f32 v43, v43
  v_mfma_f32_32x32x16_bf16 v[80:95], v[36:39], v[76:79], v[80:95]
  ds_read_b128 v[32:35], v104 offset:25344
  ds_read_b128 v[36:39], v104 offset:26112
  v_exp_f32 v44, v44
  v_cvt_pk_bf16_f32 v73, v42, v43
  v_exp_f32 v45, v45
  v_exp_f32 v46, v46
  v_mfma_f32_32x32x8bf16_1k v[56:71], v[22:23], v[116:117], v[56:71]
  v_cvt_pk_bf16_f32 v74, v44, v45
  v_exp_f32 v47, v47
  v_exp_f32 v48, v48
  v_cvt_pk_bf16_f32 v75, v46, v47
  v_exp_f32 v49, v49
  v_exp_f32 v50, v50
  v_mfma_f32_32x32x16_bf16 v[80:95], v[24:27], v[72:75], v[80:95]
  v_cvt_pk_bf16_f32 v76, v48, v49
  v_exp_f32 v51, v51
  v_exp_f32 v52, v52
  v_cvt_pk_bf16_f32 v77, v50, v51
  v_exp_f32 v53, v53
  v_exp_f32 v54, v54
  v_exp_f32 v55, v55
  v_cvt_pk_bf16_f32 v78, v52, v53
  v_cvt_pk_bf16_f32 v79, v54, v55
  s_waitcnt lgkmcnt(0)
  v_mfma_f32_32x32x16_bf16 v[40:55], v[12:15], v[112:115], 0
  ds_read_b128 v[16:19], v98 offset:30976
  ds_read_b64 v[22:23], v101 offset:30976
  v_exp_f32 v56, v56
  v_exp_f32 v57, v57
  v_exp_f32 v58, v58
  v_cvt_pk_bf16_f32 v72, v56, v57
  v_exp_f32 v59, v59
  v_mfma_f32_32x32x16_bf16 v[80:95], v[28:31], v[76:79], v[80:95]
  ds_read_b128 v[24:27], v104 offset:28160
  ds_read_b128 v[28:31], v104 offset:28928
  v_exp_f32 v60, v60
  v_cvt_pk_bf16_f32 v73, v58, v59
  v_exp_f32 v61, v61
  v_exp_f32 v62, v62
  v_mfma_f32_32x32x8bf16_1k v[40:55], v[20:21], v[116:117], v[40:55]
  v_cvt_pk_bf16_f32 v74, v60, v61
  v_exp_f32 v63, v63
  v_exp_f32 v64, v64
  v_cvt_pk_bf16_f32 v75, v62, v63
  v_exp_f32 v65, v65
  v_exp_f32 v66, v66
  v_mfma_f32_32x32x16_bf16 v[80:95], v[32:35], v[72:75], v[80:95]
  v_cvt_pk_bf16_f32 v76, v64, v65
  v_exp_f32 v67, v67
  v_exp_f32 v68, v68
  v_cvt_pk_bf16_f32 v77, v66, v67
  v_exp_f32 v69, v69
  v_exp_f32 v70, v70
  v_exp_f32 v71, v71
  v_cvt_pk_bf16_f32 v78, v68, v69
  v_cvt_pk_bf16_f32 v79, v70, v71
  s_waitcnt lgkmcnt(0)
  v_mfma_f32_32x32x16_bf16 v[56:71], v[16:19], v[112:115], 0
  ds_read_b128 v[12:15], v98 offset:33792
  ds_read_b64 v[20:21], v101 offset:33792
  v_exp_f32 v40, v40
  v_exp_f32 v41, v41
  v_exp_f32 v42, v42
  v_cvt_pk_bf16_f32 v72, v40, v41
  v_exp_f32 v43, v43
  v_mfma_f32_32x32x16_bf16 v[80:95], v[36:39], v[76:79], v[80:95]
  ds_read_b128 v[32:35], v104 offset:30976
  ds_read_b128 v[36:39], v104 offset:31744
  v_exp_f32 v44, v44
  v_cvt_pk_bf16_f32 v73, v42, v43
  v_exp_f32 v45, v45
  v_exp_f32 v46, v46
  v_mfma_f32_32x32x8bf16_1k v[56:71], v[22:23], v[116:117], v[56:71]
  v_cvt_pk_bf16_f32 v74, v44, v45
  v_exp_f32 v47, v47
  v_exp_f32 v48, v48
  v_cvt_pk_bf16_f32 v75, v46, v47
  v_exp_f32 v49, v49
  v_exp_f32 v50, v50
  v_mfma_f32_32x32x16_bf16 v[80:95], v[24:27], v[72:75], v[80:95]
  v_cvt_pk_bf16_f32 v76, v48, v49
  v_exp_f32 v51, v51
  v_exp_f32 v52, v52
  v_cvt_pk_bf16_f32 v77, v50, v51
  v_exp_f32 v53, v53
  v_exp_f32 v54, v54
  v_exp_f32 v55, v55
  v_cvt_pk_bf16_f32 v78, v52, v53
  v_cvt_pk_bf16_f32 v79, v54, v55
  s_waitcnt lgkmcnt(0)
  v_mfma_f32_32x32x16_bf16 v[40:55], v[12:15], v[112:115], 0
  ds_read_b128 v[16:19], v98 offset:36608
  ds_read_b64 v[22:23], v101 offset:36608
  v_exp_f32 v56, v56
  v_exp_f32 v57, v57
  v_exp_f32 v58, v58
  v_cvt_pk_bf16_f32 v72, v56, v57
  v_exp_f32 v59, v59
  v_mfma_f32_32x32x16_bf16 v[80:95], v[28:31], v[76:79], v[80:95]
  ds_read_b128 v[24:27], v104 offset:33792
  ds_read_b128 v[28:31], v104 offset:34560
  v_exp_f32 v60, v60
  v_cvt_pk_bf16_f32 v73, v58, v59
  v_exp_f32 v61, v61
  v_exp_f32 v62, v62
  v_mfma_f32_32x32x8bf16_1k v[40:55], v[20:21], v[116:117], v[40:55]
  v_cvt_pk_bf16_f32 v74, v60, v61
  v_exp_f32 v63, v63
  v_exp_f32 v64, v64
  v_cvt_pk_bf16_f32 v75, v62, v63
  v_exp_f32 v65, v65
  v_exp_f32 v66, v66
  v_mfma_f32_32x32x16_bf16 v[80:95], v[32:35], v[72:75], v[80:95]
  v_cvt_pk_bf16_f32 v76, v64, v65
  v_exp_f32 v67, v67
  v_exp_f32 v68, v68
  v_cvt_pk_bf16_f32 v77, v66, v67
  v_exp_f32 v69, v69
  v_exp_f32 v70, v70
  v_exp_f32 v71, v71
  v_cvt_pk_bf16_f32 v78, v68, v69
  v_cvt_pk_bf16_f32 v79, v70, v71
  s_waitcnt lgkmcnt(0)
  v_mfma_f32_32x32x16_bf16 v[56:71], v[16:19], v[112:115], 0
  ds_read_b128 v[12:15], v98 offset:39424
  ds_read_b64 v[20:21], v101 offset:39424
  v_exp_f32 v40, v40
  v_exp_f32 v41, v41
  v_exp_f32 v42, v42
  v_cvt_pk_bf16_f32 v72, v40, v41
  v_exp_f32 v43, v43
  v_mfma_f32_32x32x16_bf16 v[80:95], v[36:39], v[76:79], v[80:95]
  ds_read_b128 v[32:35], v104 offset:36608
  ds_read_b128 v[36:39], v104 offset:37376
  v_exp_f32 v44, v44
  v_cvt_pk_bf16_f32 v73, v42, v43
  v_exp_f32 v45, v45
  v_exp_f32 v46, v46
  v_mfma_f32_32x32x8bf16_1k v[56:71], v[22:23], v[116:117], v[56:71]
  v_cvt_pk_bf16_f32 v74, v44, v45
  v_exp_f32 v47, v47
  v_exp_f32 v48, v48
  v_cvt_pk_bf16_f32 v75, v46, v47
  v_exp_f32 v49, v49
  v_exp_f32 v50, v50
  v_mfma_f32_32x32x16_bf16 v[80:95], v[24:27], v[72:75], v[80:95]
  v_cvt_pk_bf16_f32 v76, v48, v49
  v_exp_f32 v51, v51
  v_exp_f32 v52, v52
  v_cvt_pk_bf16_f32 v77, v50, v51
  v_exp_f32 v53, v53
  v_exp_f32 v54, v54
  v_exp_f32 v55, v55
  v_cvt_pk_bf16_f32 v78, v52, v53
  v_cvt_pk_bf16_f32 v79, v54, v55
  s_waitcnt lgkmcnt(0)
  v_mfma_f32_32x32x16_bf16 v[40:55], v[12:15], v[112:115], 0
  ds_read_b128 v[16:19], v98 offset:42240
  ds_read_b64 v[22:23], v101 offset:42240
  v_exp_f32 v56, v56
  v_exp_f32 v57, v57
  v_exp_f32 v58, v58
  v_cvt_pk_bf16_f32 v72, v56, v57
  v_exp_f32 v59, v59
  v_mfma_f32_32x32x16_bf16 v[80:95], v[28:31], v[76:79], v[80:95]
  ds_read_b128 v[24:27], v104 offset:39424
  ds_read_b128 v[28:31], v104 offset:40192
  v_exp_f32 v60, v60
  v_cvt_pk_bf16_f32 v73, v58, v59
  v_exp_f32 v61, v61
  v_exp_f32 v62, v62
  v_mfma_f32_32x32x8bf16_1k v[40:55], v[20:21], v[116:117], v[40:55]
  v_cvt_pk_bf16_f32 v74, v60, v61
  v_exp_f32 v63, v63
  v_exp_f32 v64, v64
  v_cvt_pk_bf16_f32 v75, v62, v63
  v_exp_f32 v65, v65
  v_exp_f32 v66, v66
  v_mfma_f32_32x32x16_bf16 v[80:95], v[32:35], v[72:75], v[80:95]
  v_cvt_pk_bf16_f32 v76, v64, v65
  v_exp_f32 v67, v67
  v_exp_f32 v68, v68
  v_cvt_pk_bf16_f32 v77, v66, v67
  v_exp_f32 v69, v69
  v_exp_f32 v70, v70
  v_exp_f32 v71, v71
  v_cvt_pk_bf16_f32 v78, v68, v69
  v_cvt_pk_bf16_f32 v79, v70, v71
  s_waitcnt vmcnt(0)
  s_barrier
  s_waitcnt lgkmcnt(0)
  v_mfma_f32_32x32x16_bf16 v[56:71], v[16:19], v[112:115], 0
  ds_read_b128 v[12:15], v96 offset:0
  ds_read_b64 v[20:21], v99 offset:0
  v_exp_f32 v40, v40
  v_exp_f32 v41, v41
  v_exp_f32 v42, v42
  v_cvt_pk_bf16_f32 v72, v40, v41
  v_exp_f32 v43, v43
  v_mfma_f32_32x32x16_bf16 v[80:95], v[36:39], v[76:79], v[80:95]
  ds_read_b128 v[32:35], v104 offset:42240
  ds_read_b128 v[36:39], v104 offset:43008
  v_exp_f32 v44, v44
  v_cvt_pk_bf16_f32 v73, v42, v43
  v_exp_f32 v45, v45
  v_exp_f32 v46, v46
  v_mfma_f32_32x32x8bf16_1k v[56:71], v[22:23], v[116:117], v[56:71]
  v_cvt_pk_bf16_f32 v74, v44, v45
  v_exp_f32 v47, v47
  v_exp_f32 v48, v48
  v_cvt_pk_bf16_f32 v75, v46, v47
  v_exp_f32 v49, v49
  v_exp_f32 v50, v50
  v_mfma_f32_32x32x16_bf16 v[80:95], v[24:27], v[72:75], v[80:95]
  v_cvt_pk_bf16_f32 v76, v48, v49
  v_exp_f32 v51, v51
  v_exp_f32 v52, v52
  v_cvt_pk_bf16_f32 v77, v50, v51
  v_exp_f32 v53, v53
  v_exp_f32 v54, v54
  v_exp_f32 v55, v55
  v_cvt_pk_bf16_f32 v78, v52, v53
  v_cvt_pk_bf16_f32 v79, v54, v55
  s_waitcnt lgkmcnt(0)
  v_mfma_f32_32x32x16_bf16 v[40:55], v[12:15], v[112:115], 0
  ds_read_b128 v[16:19], v96 offset:2816
  ds_read_b64 v[22:23], v99 offset:2816
  v_exp_f32 v56, v56
  v_exp_f32 v57, v57
  v_exp_f32 v58, v58
  v_cvt_pk_bf16_f32 v72, v56, v57
  v_exp_f32 v59, v59
  v_mfma_f32_32x32x16_bf16 v[80:95], v[28:31], v[76:79], v[80:95]
  ds_read_b128 v[24:27], v102 offset:0
  ds_read_b128 v[28:31], v102 offset:768
  v_exp_f32 v60, v60
  v_cvt_pk_bf16_f32 v73, v58, v59
  v_exp_f32 v61, v61
  v_exp_f32 v62, v62
  v_mfma_f32_32x32x8bf16_1k v[40:55], v[20:21], v[116:117], v[40:55]
  v_cvt_pk_bf16_f32 v74, v60, v61
  v_exp_f32 v63, v63
  v_exp_f32 v64, v64
  v_cvt_pk_bf16_f32 v75, v62, v63
  v_exp_f32 v65, v65
  v_exp_f32 v66, v66
  v_mfma_f32_32x32x16_bf16 v[80:95], v[32:35], v[72:75], v[80:95]
  v_cvt_pk_bf16_f32 v76, v64, v65
  v_exp_f32 v67, v67
  v_exp_f32 v68, v68
  v_cvt_pk_bf16_f32 v77, v66, v67
  v_exp_f32 v69, v69
  v_exp_f32 v70, v70
  v_exp_f32 v71, v71
  v_cvt_pk_bf16_f32 v78, v68, v69
  v_cvt_pk_bf16_f32 v79, v70, v71
  s_waitcnt lgkmcnt(0)
  v_mfma_f32_32x32x16_bf16 v[56:71], v[16:19], v[112:115], 0
  ds_read_b128 v[12:15], v96 offset:5632
  ds_read_b64 v[20:21], v99 offset:5632
  v_exp_f32 v40, v40
  v_exp_f32 v41, v41
  v_exp_f32 v42, v42
  v_cvt_pk_bf16_f32 v72, v40, v41
  v_exp_f32 v43, v43
  v_mfma_f32_32x32x16_bf16 v[80:95], v[36:39], v[76:79], v[80:95]
  ds_read_b128 v[32:35], v102 offset:2816
  ds_read_b128 v[36:39], v102 offset:3584
  v_exp_f32 v44, v44
  v_cvt_pk_bf16_f32 v73, v42, v43
  v_exp_f32 v45, v45
  v_exp_f32 v46, v46
  v_mfma_f32_32x32x8bf16_1k v[56:71], v[22:23], v[116:117], v[56:71]
  v_cvt_pk_bf16_f32 v74, v44, v45
  v_exp_f32 v47, v47
  v_exp_f32 v48, v48
  v_cvt_pk_bf16_f32 v75, v46, v47
  v_exp_f32 v49, v49
  v_exp_f32 v50, v50
  v_mfma_f32_32x32x16_bf16 v[80:95], v[24:27], v[72:75], v[80:95]
  v_cvt_pk_bf16_f32 v76, v48, v49
  v_exp_f32 v51, v51
  v_exp_f32 v52, v52
  v_cvt_pk_bf16_f32 v77, v50, v51
  v_exp_f32 v53, v53
  v_exp_f32 v54, v54
  v_exp_f32 v55, v55
  v_cvt_pk_bf16_f32 v78, v52, v53
  v_cvt_pk_bf16_f32 v79, v54, v55
  s_waitcnt lgkmcnt(0)
  v_mfma_f32_32x32x16_bf16 v[40:55], v[12:15], v[112:115], 0
  ds_read_b128 v[16:19], v96 offset:8448
  ds_read_b64 v[22:23], v99 offset:8448
  v_exp_f32 v56, v56
  v_exp_f32 v57, v57
  v_exp_f32 v58, v58
  v_cvt_pk_bf16_f32 v72, v56, v57
  v_exp_f32 v59, v59
  v_mfma_f32_32x32x16_bf16 v[80:95], v[28:31], v[76:79], v[80:95]
  ds_read_b128 v[24:27], v102 offset:5632
  ds_read_b128 v[28:31], v102 offset:6400
  v_exp_f32 v60, v60
  v_cvt_pk_bf16_f32 v73, v58, v59
  v_exp_f32 v61, v61
  v_exp_f32 v62, v62
  v_mfma_f32_32x32x8bf16_1k v[40:55], v[20:21], v[116:117], v[40:55]
  v_cvt_pk_bf16_f32 v74, v60, v61
  v_exp_f32 v63, v63
  v_exp_f32 v64, v64
  v_cvt_pk_bf16_f32 v75, v62, v63
  v_exp_f32 v65, v65
  v_exp_f32 v66, v66
  v_mfma_f32_32x32x16_bf16 v[80:95], v[32:35], v[72:75], v[80:95]
  s_add_u32 s40, s86, 22609920
  s_addc_u32 s41, s87, 0
  s_mov_b32 s42, 819200
  s_mov_b32 s43, 0x00020000
  s_mov_b32 s9, 0
  s_lshr_b32 s10, s2, 3
  s_mul_i32 s10, s10, 200
  s_add_u32 s9, s9, s10
  v_add_u32 v118, s9, v0
  v_lshlrev_b32 v118, 7, v118
  v_cmp_gt_u32 vcc, 200, v0
  v_mov_b32 v124, 0x7ffffff0
  s_nop 0
  v_cndmask_b32 v118, v124, v118, vcc
  buffer_load_dword v231, v118, s[40:43], 0 offen
  v_cvt_pk_bf16_f32 v76, v64, v65
  v_exp_f32 v67, v67
  v_exp_f32 v68, v68
  v_cvt_pk_bf16_f32 v77, v66, v67
  v_exp_f32 v69, v69
  v_exp_f32 v70, v70
  v_exp_f32 v71, v71
  v_cvt_pk_bf16_f32 v78, v68, v69
  v_cvt_pk_bf16_f32 v79, v70, v71
  s_waitcnt lgkmcnt(0)
  v_mfma_f32_32x32x16_bf16 v[56:71], v[16:19], v[112:115], 0
  ds_read_b128 v[12:15], v96 offset:11264
  ds_read_b64 v[20:21], v99 offset:11264
  v_exp_f32 v40, v40
  v_exp_f32 v41, v41
  v_exp_f32 v42, v42
  v_cvt_pk_bf16_f32 v72, v40, v41
  v_exp_f32 v43, v43
  v_mfma_f32_32x32x16_bf16 v[80:95], v[36:39], v[76:79], v[80:95]
  ds_read_b128 v[32:35], v102 offset:8448
  ds_read_b128 v[36:39], v102 offset:9216
  v_exp_f32 v44, v44
  v_cvt_pk_bf16_f32 v73, v42, v43
  v_exp_f32 v45, v45
  v_exp_f32 v46, v46
  v_mfma_f32_32x32x8bf16_1k v[56:71], v[22:23], v[116:117], v[56:71]
  v_cvt_pk_bf16_f32 v74, v44, v45
  v_exp_f32 v47, v47
  v_exp_f32 v48, v48
  v_cvt_pk_bf16_f32 v75, v46, v47
  v_exp_f32 v49, v49
  v_exp_f32 v50, v50
  v_mfma_f32_32x32x16_bf16 v[80:95], v[24:27], v[72:75], v[80:95]
  v_cvt_pk_bf16_f32 v76, v48, v49
  v_exp_f32 v51, v51
  v_exp_f32 v52, v52
  v_cvt_pk_bf16_f32 v77, v50, v51
  v_exp_f32 v53, v53
  v_exp_f32 v54, v54
  v_exp_f32 v55, v55
  v_cvt_pk_bf16_f32 v78, v52, v53
  v_cvt_pk_bf16_f32 v79, v54, v55
  s_waitcnt lgkmcnt(0)
  v_mfma_f32_32x32x16_bf16 v[40:55], v[12:15], v[112:115], 0
  ds_read_b128 v[16:19], v96 offset:14080
  ds_read_b64 v[22:23], v99 offset:14080
  v_exp_f32 v56, v56
  v_exp_f32 v57, v57
  v_exp_f32 v58, v58
  v_cvt_pk_bf16_f32 v72, v56, v57
  v_exp_f32 v59, v59
  v_mfma_f32_32x32x16_bf16 v[80:95], v[28:31], v[76:79], v[80:95]
  ds_read_b128 v[24:27], v102 offset:11264
  ds_read_b128 v[28:31], v102 offset:12032
  v_exp_f32 v60, v60
  v_cvt_pk_bf16_f32 v73, v58, v59
  v_exp_f32 v61, v61
  v_exp_f32 v62, v62
  v_mfma_f32_32x32x8bf16_1k v[40:55], v[20:21], v[116:117], v[40:55]
  v_cvt_pk_bf16_f32 v74, v60, v61
  v_exp_f32 v63, v63
  v_exp_f32 v64, v64
  v_cvt_pk_bf16_f32 v75, v62, v63
  v_exp_f32 v65, v65
  v_exp_f32 v66, v66
  v_mfma_f32_32x32x16_bf16 v[80:95], v[32:35], v[72:75], v[80:95]
  v_cvt_pk_bf16_f32 v76, v64, v65
  v_exp_f32 v67, v67
  v_exp_f32 v68, v68
  v_cvt_pk_bf16_f32 v77, v66, v67
  v_exp_f32 v69, v69
  v_exp_f32 v70, v70
  v_exp_f32 v71, v71
  v_cvt_pk_bf16_f32 v78, v68, v69
  v_cvt_pk_bf16_f32 v79, v70, v71
  s_waitcnt lgkmcnt(0)
  v_mfma_f32_32x32x16_bf16 v[56:71], v[16:19], v[112:115], 0
  ds_read_b128 v[12:15], v96 offset:16896
  ds_read_b64 v[20:21], v99 offset:16896
  v_exp_f32 v40, v40
  v_exp_f32 v41, v41
  v_exp_f32 v42, v42
  v_cvt_pk_bf16_f32 v72, v40, v41
  v_exp_f32 v43, v43
  v_mfma_f32_32x32x16_bf16 v[80:95], v[36:39], v[76:79], v[80:95]
  ds_read_b128 v[32:35], v102 offset:14080
  ds_read_b128 v[36:39], v102 offset:14848
  v_exp_f32 v44, v44
  v_cvt_pk_bf16_f32 v73, v42, v43
  v_exp_f32 v45, v45
  v_exp_f32 v46, v46
  v_mfma_f32_32x32x8bf16_1k v[56:71], v[22:23], v[116:117], v[56:71]
  v_cvt_pk_bf16_f32 v74, v44, v45
  v_exp_f32 v47, v47
  v_exp_f32 v48, v48
  v_cvt_pk_bf16_f32 v75, v46, v47
  v_exp_f32 v49, v49
  v_exp_f32 v50, v50
  v_mfma_f32_32x32x16_bf16 v[80:95], v[24:27], v[72:75], v[80:95]
  v_cvt_pk_bf16_f32 v76, v48, v49
  v_exp_f32 v51, v51
  v_exp_f32 v52, v52
  v_cvt_pk_bf16_f32 v77, v50, v51
  v_exp_f32 v53, v53
  v_exp_f32 v54, v54
  v_exp_f32 v55, v55
  v_cvt_pk_bf16_f32 v78, v52, v53
  v_cvt_pk_bf16_f32 v79, v54, v55
  s_waitcnt lgkmcnt(0)
  v_mfma_f32_32x32x16_bf16 v[40:55], v[12:15], v[112:115], 0
  ds_read_b128 v[16:19], v96 offset:19712
  ds_read_b64 v[22:23], v99 offset:19712
  v_exp_f32 v56, v56
  v_exp_f32 v57, v57
  v_exp_f32 v58, v58
  v_cvt_pk_bf16_f32 v72, v56, v57
  v_exp_f32 v59, v59
  v_mfma_f32_32x32x16_bf16 v[80:95], v[28:31], v[76:79], v[80:95]
  ds_read_b128 v[24:27], v102 offset:16896
  ds_read_b128 v[28:31], v102 offset:17664
  v_exp_f32 v60, v60
  v_cvt_pk_bf16_f32 v73, v58, v59
  v_exp_f32 v61, v61
  v_exp_f32 v62, v62
  v_mfma_f32_32x32x8bf16_1k v[40:55], v[20:21], v[116:117], v[40:55]
  v_cvt_pk_bf16_f32 v74, v60, v61
  v_exp_f32 v63, v63
  v_exp_f32 v64, v64
  v_cvt_pk_bf16_f32 v75, v62, v63
  v_exp_f32 v65, v65
  v_exp_f32 v66, v66
  v_mfma_f32_32x32x16_bf16 v[80:95], v[32:35], v[72:75], v[80:95]
  s_add_u32 s40, s86, 25395200
  s_addc_u32 s41, s87, 0
  s_mov_b32 s42, 3932160
  s_mov_b32 s43, 0x00020000
  s_bfe_u32 s9, s2, 0x20001
  s_mul_i32 s9, s9, 7680
  s_lshr_b32 s10, s2, 3
  s_mul_i32 s10, s10, 240
  s_add_u32 s9, s9, s10
  v_add_u32 v118, s9, v0
  v_lshlrev_b32 v118, 7, v118
  v_cmp_gt_u32 vcc, 240, v0
  v_mov_b32 v124, 0x7ffffff0
  s_nop 0
  v_cndmask_b32 v118, v124, v118, vcc
  buffer_load_dword v230, v118, s[40:43], 0 offen
  v_cvt_pk_bf16_f32 v76, v64, v65
  v_exp_f32 v67, v67
  v_exp_f32 v68, v68
  v_cvt_pk_bf16_f32 v77, v66, v67
  v_exp_f32 v69, v69
  v_exp_f32 v70, v70
  v_exp_f32 v71, v71
  v_cvt_pk_bf16_f32 v78, v68, v69
  v_cvt_pk_bf16_f32 v79, v70, v71
  s_waitcnt lgkmcnt(0)
  v_mfma_f32_32x32x16_bf16 v[56:71], v[16:19], v[112:115], 0
  ds_read_b128 v[12:15], v96 offset:22528
  ds_read_b64 v[20:21], v99 offset:22528
  v_exp_f32 v40, v40
  v_exp_f32 v41, v41
  v_exp_f32 v42, v42
  v_cvt_pk_bf16_f32 v72, v40, v41
  v_exp_f32 v43, v43
  v_mfma_f32_32x32x16_bf16 v[80:95], v[36:39], v[76:79], v[80:95]
  ds_read_b128 v[32:35], v102 offset:19712
  ds_read_b128 v[36:39], v102 offset:20480
  v_exp_f32 v44, v44
  v_cvt_pk_bf16_f32 v73, v42, v43
  v_exp_f32 v45, v45
  v_exp_f32 v46, v46
  v_mfma_f32_32x32x8bf16_1k v[56:71], v[22:23], v[116:117], v[56:71]
  v_cvt_pk_bf16_f32 v74, v44, v45
  v_exp_f32 v47, v47
  v_exp_f32 v48, v48
  v_cvt_pk_bf16_f32 v75, v46, v47
  v_exp_f32 v49, v49
  v_exp_f32 v50, v50
  v_mfma_f32_32x32x16_bf16 v[80:95], v[24:27], v[72:75], v[80:95]
  v_cvt_pk_bf16_f32 v76, v48, v49
  v_exp_f32 v51, v51
  v_exp_f32 v52, v52
  v_cvt_pk_bf16_f32 v77, v50, v51
  v_exp_f32 v53, v53
  v_exp_f32 v54, v54
  v_exp_f32 v55, v55
  v_cvt_pk_bf16_f32 v78, v52, v53
  v_cvt_pk_bf16_f32 v79, v54, v55
  s_waitcnt lgkmcnt(0)
  v_mfma_f32_32x32x16_bf16 v[40:55], v[12:15], v[112:115], 0
  ds_read_b128 v[16:19], v96 offset:25344
  ds_read_b64 v[22:23], v99 offset:25344
  v_exp_f32 v56, v56
  v_exp_f32 v57, v57
  v_exp_f32 v58, v58
  v_cvt_pk_bf16_f32 v72, v56, v57
  v_exp_f32 v59, v59
  v_mfma_f32_32x32x16_bf16 v[80:95], v[28:31], v[76:79], v[80:95]
  ds_read_b128 v[24:27], v102 offset:22528
  ds_read_b128 v[28:31], v102 offset:23296
  v_exp_f32 v60, v60
  v_cvt_pk_bf16_f32 v73, v58, v59
  v_exp_f32 v61, v61
  v_exp_f32 v62, v62
  v_mfma_f32_32x32x8bf16_1k v[40:55], v[20:21], v[116:117], v[40:55]
  v_cvt_pk_bf16_f32 v74, v60, v61
  v_exp_f32 v63, v63
  v_exp_f32 v64, v64
  v_cvt_pk_bf16_f32 v75, v62, v63
  v_exp_f32 v65, v65
  v_exp_f32 v66, v66
  v_mfma_f32_32x32x16_bf16 v[80:95], v[32:35], v[72:75], v[80:95]
  s_cmp_lg_u32 s8, 1
  s_cbranch_scc1 P3_Wta
  s_add_u32 s56, s86, 29655040
  s_addc_u32 s57, s87, 0
  s_mov_b32 s58, 229376
  s_mov_b32 s59, 0x00020000
  v_and_b32 v132, 63, v0
  v_lshlrev_b32 v132, 7, v132
  v_add_u32 v132, 65536, v132
  v_add_u32 v133, 8192, v132
  v_add_u32 v134, 16384, v132
  v_add_u32 v135, 24576, v132
  buffer_load_dword v136, v132, s[56:59], 0 offen sc1
  buffer_load_dword v137, v133, s[56:59], 0 offen sc1
  buffer_load_dword v138, v134, s[56:59], 0 offen sc1
  buffer_load_dword v139, v135, s[56:59], 0 offen sc1
P3_Wta:
  v_cvt_pk_bf16_f32 v76, v64, v65
  v_exp_f32 v67, v67
  v_exp_f32 v68, v68
  v_cvt_pk_bf16_f32 v77, v66, v67
  v_exp_f32 v69, v69
  v_exp_f32 v70, v70
  v_exp_f32 v71, v71
  v_cvt_pk_bf16_f32 v78, v68, v69
  v_cvt_pk_bf16_f32 v79, v70, v71
  s_waitcnt lgkmcnt(0)
  v_mfma_f32_32x32x16_bf16 v[56:71], v[16:19], v[112:115], 0
  ds_read_b128 v[12:15], v96 offset:28160
  ds_read_b64 v[20:21], v99 offset:28160
  v_exp_f32 v40, v40
  v_exp_f32 v41, v41
  v_exp_f32 v42, v42
  v_cvt_pk_bf16_f32 v72, v40, v41
  v_exp_f32 v43, v43
  v_mfma_f32_32x32x16_bf16 v[80:95], v[36:39], v[76:79], v[80:95]
  ds_read_b128 v[32:35], v102 offset:25344
  ds_read_b128 v[36:39], v102 offset:26112
  v_exp_f32 v44, v44
  v_cvt_pk_bf16_f32 v73, v42, v43
  v_exp_f32 v45, v45
  v_exp_f32 v46, v46
  v_mfma_f32_32x32x8bf16_1k v[56:71], v[22:23], v[116:117], v[56:71]
  v_cvt_pk_bf16_f32 v74, v44, v45
  v_exp_f32 v47, v47
  v_exp_f32 v48, v48
  v_cvt_pk_bf16_f32 v75, v46, v47
  v_exp_f32 v49, v49
  v_exp_f32 v50, v50
  v_mfma_f32_32x32x16_bf16 v[80:95], v[24:27], v[72:75], v[80:95]
  v_cvt_pk_bf16_f32 v76, v48, v49
  v_exp_f32 v51, v51
  v_exp_f32 v52, v52
  v_cvt_pk_bf16_f32 v77, v50, v51
  v_exp_f32 v53, v53
  v_exp_f32 v54, v54
  v_exp_f32 v55, v55
  v_cvt_pk_bf16_f32 v78, v52, v53
  v_cvt_pk_bf16_f32 v79, v54, v55
  s_waitcnt lgkmcnt(0)
  v_mfma_f32_32x32x16_bf16 v[40:55], v[12:15], v[112:115], 0
  ds_read_b128 v[16:19], v96 offset:30976
  ds_read_b64 v[22:23], v99 offset:30976
  v_exp_f32 v56, v56
  v_exp_f32 v57, v57
  v_exp_f32 v58, v58
  v_cvt_pk_bf16_f32 v72, v56, v57
  v_exp_f32 v59, v59
  v_mfma_f32_32x32x16_bf16 v[80:95], v[28:31], v[76:79], v[80:95]
  ds_read_b128 v[24:27], v102 offset:28160
  ds_read_b128 v[28:31], v102 offset:28928
  v_exp_f32 v60, v60
  v_cvt_pk_bf16_f32 v73, v58, v59
  v_exp_f32 v61, v61
  v_exp_f32 v62, v62
  v_mfma_f32_32x32x8bf16_1k v[40:55], v[20:21], v[116:117], v[40:55]
  v_cvt_pk_bf16_f32 v74, v60, v61
  v_exp_f32 v63, v63
  v_exp_f32 v64, v64
  v_cvt_pk_bf16_f32 v75, v62, v63
  v_exp_f32 v65, v65
  v_exp_f32 v66, v66
  v_mfma_f32_32x32x16_bf16 v[80:95], v[32:35], v[72:75], v[80:95]
  v_cvt_pk_bf16_f32 v76, v64, v65
  v_exp_f32 v67, v67
  v_exp_f32 v68, v68
  v_cvt_pk_bf16_f32 v77, v66, v67
  v_exp_f32 v69, v69
  v_exp_f32 v70, v70
  v_exp_f32 v71, v71
  v_cvt_pk_bf16_f32 v78, v68, v69
  v_cvt_pk_bf16_f32 v79, v70, v71
  s_waitcnt lgkmcnt(0)
  v_mfma_f32_32x32x16_bf16 v[56:71], v[16:19], v[112:115], 0
  ds_read_b128 v[12:15], v96 offset:33792
  ds_read_b64 v[20:21], v99 offset:33792
  v_exp_f32 v40, v40
  v_exp_f32 v41, v41
  v_exp_f32 v42, v42
  v_cvt_pk_bf16_f32 v72, v40, v41
  v_exp_f32 v43, v43
  v_mfma_f32_32x32x16_bf16 v[80:95], v[36:39], v[76:79], v[80:95]
  ds_read_b128 v[32:35], v102 offset:30976
  ds_read_b128 v[36:39], v102 offset:31744
  v_exp_f32 v44, v44
  v_cvt_pk_bf16_f32 v73, v42, v43
  v_exp_f32 v45, v45
  v_exp_f32 v46, v46
  v_mfma_f32_32x32x8bf16_1k v[56:71], v[22:23], v[116:117], v[56:71]
  v_cvt_pk_bf16_f32 v74, v44, v45
  v_exp_f32 v47, v47
  v_exp_f32 v48, v48
  v_cvt_pk_bf16_f32 v75, v46, v47
  v_exp_f32 v49, v49
  v_exp_f32 v50, v50
  v_mfma_f32_32x32x16_bf16 v[80:95], v[24:27], v[72:75], v[80:95]
  v_cvt_pk_bf16_f32 v76, v48, v49
  v_exp_f32 v51, v51
  v_exp_f32 v52, v52
  v_cvt_pk_bf16_f32 v77, v50, v51
  v_exp_f32 v53, v53
  v_exp_f32 v54, v54
  v_exp_f32 v55, v55
  v_cvt_pk_bf16_f32 v78, v52, v53
  v_cvt_pk_bf16_f32 v79, v54, v55
  s_waitcnt lgkmcnt(0)
  v_mfma_f32_32x32x16_bf16 v[40:55], v[12:15], v[112:115], 0
  ds_read_b128 v[16:19], v96 offset:36608
  ds_read_b64 v[22:23], v99 offset:36608
  v_exp_f32 v56, v56
  v_exp_f32 v57, v57
  v_exp_f32 v58, v58
  v_cvt_pk_bf16_f32 v72, v56, v57
  v_exp_f32 v59, v59
  v_mfma_f32_32x32x16_bf16 v[80:95], v[28:31], v[76:79], v[80:95]
  ds_read_b128 v[24:27], v102 offset:33792
  ds_read_b128 v[28:31], v102 offset:34560
  v_exp_f32 v60, v60
  v_cvt_pk_bf16_f32 v73, v58, v59
  v_exp_f32 v61, v61
  v_exp_f32 v62, v62
  v_mfma_f32_32x32x8bf16_1k v[40:55], v[20:21], v[116:117], v[40:55]
  v_cvt_pk_bf16_f32 v74, v60, v61
  v_exp_f32 v63, v63
  v_exp_f32 v64, v64
  v_cvt_pk_bf16_f32 v75, v62, v63
  v_exp_f32 v65, v65
  v_exp_f32 v66, v66
  v_mfma_f32_32x32x16_bf16 v[80:95], v[32:35], v[72:75], v[80:95]
  v_cvt_pk_bf16_f32 v76, v64, v65
  v_exp_f32 v67, v67
  v_exp_f32 v68, v68
  v_cvt_pk_bf16_f32 v77, v66, v67
  v_exp_f32 v69, v69
  v_exp_f32 v70, v70
  v_exp_f32 v71, v71
  v_cvt_pk_bf16_f32 v78, v68, v69
  v_cvt_pk_bf16_f32 v79, v70, v71
  s_waitcnt lgkmcnt(0)
  v_mfma_f32_32x32x16_bf16 v[56:71], v[16:19], v[112:115], 0
  ds_read_b128 v[12:15], v96 offset:39424
  ds_read_b64 v[20:21], v99 offset:39424
  v_exp_f32 v40, v40
  v_exp_f32 v41, v41
  v_exp_f32 v42, v42
  v_cvt_pk_bf16_f32 v72, v40, v41
  v_exp_f32 v43, v43
  v_mfma_f32_32x32x16_bf16 v[80:95], v[36:39], v[76:79], v[80:95]
  ds_read_b128 v[32:35], v102 offset:36608
  ds_read_b128 v[36:39], v102 offset:37376
  v_exp_f32 v44, v44
  v_cvt_pk_bf16_f32 v73, v42, v43
  v_exp_f32 v45, v45
  v_exp_f32 v46, v46
  v_mfma_f32_32x32x8bf16_1k v[56:71], v[22:23], v[116:117], v[56:71]
  v_cvt_pk_bf16_f32 v74, v44, v45
  v_exp_f32 v47, v47
  v_exp_f32 v48, v48
  v_cvt_pk_bf16_f32 v75, v46, v47
  v_exp_f32 v49, v49
  v_exp_f32 v50, v50
  v_mfma_f32_32x32x16_bf16 v[80:95], v[24:27], v[72:75], v[80:95]
  v_cvt_pk_bf16_f32 v76, v48, v49
  v_exp_f32 v51, v51
  v_exp_f32 v52, v52
  v_cvt_pk_bf16_f32 v77, v50, v51
  v_exp_f32 v53, v53
  v_exp_f32 v54, v54
  v_exp_f32 v55, v55
  v_cvt_pk_bf16_f32 v78, v52, v53
  v_cvt_pk_bf16_f32 v79, v54, v55
  s_waitcnt lgkmcnt(0)
  v_mfma_f32_32x32x16_bf16 v[40:55], v[12:15], v[112:115], 0
  ds_read_b128 v[16:19], v96 offset:42240
  ds_read_b64 v[22:23], v99 offset:42240
  v_exp_f32 v56, v56
  v_exp_f32 v57, v57
  v_exp_f32 v58, v58
  v_cvt_pk_bf16_f32 v72, v56, v57
  v_exp_f32 v59, v59
  v_mfma_f32_32x32x16_bf16 v[80:95], v[28:31], v[76:79], v[80:95]
  ds_read_b128 v[24:27], v102 offset:39424
  ds_read_b128 v[28:31], v102 offset:40192
  v_exp_f32 v60, v60
  v_cvt_pk_bf16_f32 v73, v58, v59
  v_exp_f32 v61, v61
  v_exp_f32 v62, v62
  v_mfma_f32_32x32x8bf16_1k v[40:55], v[20:21], v[116:117], v[40:55]
  v_cvt_pk_bf16_f32 v74, v60, v61
  v_exp_f32 v63, v63
  v_exp_f32 v64, v64
  v_cvt_pk_bf16_f32 v75, v62, v63
  v_exp_f32 v65, v65
  v_exp_f32 v66, v66
  v_mfma_f32_32x32x16_bf16 v[80:95], v[32:35], v[72:75], v[80:95]
  s_cmp_lg_u32 s8, 1
  s_cbranch_scc1 P3_Wtb
  s_waitcnt vmcnt(0)
  v_cmp_ne_u32 vcc, s60, v136
  v_cmp_ne_u32 s[62:63], s60, v137
  s_or_b64 vcc, vcc, s[62:63]
  v_cmp_ne_u32 s[62:63], s60, v138
  s_or_b64 vcc, vcc, s[62:63]
  v_cmp_ne_u32 s[62:63], s60, v139
  s_or_b64 vcc, vcc, s[62:63]
  s_cmp_eq_u64 vcc, 0
  s_cbranch_scc1 P3_TALL_OK
  s_add_u32 s56, s86, 29655040
  s_addc_u32 s57, s87, 0
  s_mov_b32 s58, 229376
  s_mov_b32 s59, 0x00020000
  v_and_b32 v132, 63, v0
  v_lshlrev_b32 v132, 7, v132
  v_add_u32 v132, 65536, v132
  v_add_u32 v133, 8192, v132
  v_add_u32 v134, 16384, v132
  v_add_u32 v135, 24576, v132
  s_mov_b32 s14, 0
P3_TALL_P:
  buffer_load_dword v136, v132, s[56:59], 0 offen sc1
  buffer_load_dword v137, v133, s[56:59], 0 offen sc1
  buffer_load_dword v138, v134, s[56:59], 0 offen sc1
  buffer_load_dword v139, v135, s[56:59], 0 offen sc1
  s_waitcnt vmcnt(0)
  v_cmp_ne_u32 vcc, s60, v136
  v_cmp_ne_u32 s[62:63], s60, v137
  s_or_b64 vcc, vcc, s[62:63]
  v_cmp_ne_u32 s[62:63], s60, v138
  s_or_b64 vcc, vcc, s[62:63]
  v_cmp_ne_u32 s[62:63], s60, v139
  s_or_b64 vcc, vcc, s[62:63]
  s_cmp_eq_u64 vcc, 0
  s_cbranch_scc1 P3_TALL_R
  s_add_u32 s14, s14, 1
  s_cmp_gt_u32 s14, 30000
  s_cbranch_scc1 P3_TALL_R
  s_sleep 2
  s_branch P3_TALL_P
P3_TALL_R:
P3_TALL_OK:
P3_Wtb:
  v_cvt_pk_bf16_f32 v76, v64, v65
  v_exp_f32 v67, v67
  v_exp_f32 v68, v68
  v_cvt_pk_bf16_f32 v77, v66, v67
  v_exp_f32 v69, v69
  v_exp_f32 v70, v70
  v_exp_f32 v71, v71
  v_cvt_pk_bf16_f32 v78, v68, v69
  v_cvt_pk_bf16_f32 v79, v70, v71
  s_waitcnt lgkmcnt(0)
  v_mfma_f32_32x32x16_bf16 v[56:71], v[16:19], v[112:115], 0
  v_exp_f32 v40, v40
  v_exp_f32 v41, v41
  v_exp_f32 v42, v42
  v_cvt_pk_bf16_f32 v72, v40, v41
  v_exp_f32 v43, v43
  v_mfma_f32_32x32x16_bf16 v[80:95], v[36:39], v[76:79], v[80:95]
  ds_read_b128 v[32:35], v102 offset:42240
  ds_read_b128 v[36:39], v102 offset:43008
  v_exp_f32 v44, v44
  v_cvt_pk_bf16_f32 v73, v42, v43
  v_exp_f32 v45, v45
  v_exp_f32 v46, v46
  v_mfma_f32_32x32x8bf16_1k v[56:71], v[22:23], v[116:117], v[56:71]
  v_cvt_pk_bf16_f32 v74, v44, v45
  v_exp_f32 v47, v47
  v_exp_f32 v48, v48
  v_cvt_pk_bf16_f32 v75, v46, v47
  v_exp_f32 v49, v49
  v_exp_f32 v50, v50
  v_mfma_f32_32x32x16_bf16 v[80:95], v[24:27], v[72:75], v[80:95]
  v_cvt_pk_bf16_f32 v76, v48, v49
  v_exp_f32 v51, v51
  v_exp_f32 v52, v52
  v_cvt_pk_bf16_f32 v77, v50, v51
  v_exp_f32 v53, v53
  v_exp_f32 v54, v54
  v_exp_f32 v55, v55
  v_cvt_pk_bf16_f32 v78, v52, v53
  v_cvt_pk_bf16_f32 v79, v54, v55
  s_waitcnt lgkmcnt(0)
  v_exp_f32 v56, v56
  v_exp_f32 v57, v57
  v_exp_f32 v58, v58
  v_cvt_pk_bf16_f32 v72, v56, v57
  v_exp_f32 v59, v59
  v_mfma_f32_32x32x16_bf16 v[80:95], v[28:31], v[76:79], v[80:95]
  v_exp_f32 v60, v60
  v_cvt_pk_bf16_f32 v73, v58, v59
  v_exp_f32 v61, v61
  v_exp_f32 v62, v62
  v_cvt_pk_bf16_f32 v74, v60, v61
  v_exp_f32 v63, v63
  v_exp_f32 v64, v64
  v_cvt_pk_bf16_f32 v75, v62, v63
  v_exp_f32 v65, v65
  v_exp_f32 v66, v66
  v_mfma_f32_32x32x16_bf16 v[80:95], v[32:35], v[72:75], v[80:95]
  v_cvt_pk_bf16_f32 v76, v64, v65
  v_exp_f32 v67, v67
  v_exp_f32 v68, v68
  v_cvt_pk_bf16_f32 v77, v66, v67
  v_exp_f32 v69, v69
  v_exp_f32 v70, v70
  v_exp_f32 v71, v71
  v_cvt_pk_bf16_f32 v78, v68, v69
  v_cvt_pk_bf16_f32 v79, v70, v71
  s_nop 1
  v_mfma_f32_32x32x16_bf16 v[80:95], v[36:39], v[76:79], v[80:95]
  s_nop 11
  v_mov_b32 v2, v88
  v_mov_b32 v3, v88
  s_nop 1
  v_permlane32_swap_b32 v2, v3
  s_mov_b32 s9, 0x21800000
  s_mov_b32 s10, 0x5d800000
  v_cmp_le_f32 vcc, s9, v3
  v_cmp_ge_f32 s[28:29], s10, v3
  s_and_b64 s[28:29], s[28:29], vcc
  s_movk_i32 s9, 0x207
  v_cmp_class_f32 vcc, v80, s9
  s_andn2_b64 s[28:29], s[28:29], vcc
  v_cmp_class_f32 vcc, v81, s9
  s_andn2_b64 s[28:29], s[28:29], vcc
  v_cmp_class_f32 vcc, v82, s9
  s_andn2_b64 s[28:29], s[28:29], vcc
  v_cmp_class_f32 vcc, v83, s9
  s_andn2_b64 s[28:29], s[28:29], vcc
  v_cmp_class_f32 vcc, v84, s9
  s_andn2_b64 s[28:29], s[28:29], vcc
  v_cmp_class_f32 vcc, v85, s9
  s_andn2_b64 s[28:29], s[28:29], vcc
  v_cmp_class_f32 vcc, v86, s9
  s_andn2_b64 s[28:29], s[28:29], vcc
  v_cmp_class_f32 vcc, v87, s9
  s_andn2_b64 s[28:29], s[28:29], vcc
  s_mov_b32 s34, -1
  s_mov_b32 s35, 0
  v_cmp_class_f32 vcc, v88, s9
  s_and_b64 vcc, vcc, s[34:35]
  s_andn2_b64 s[28:29], s[28:29], vcc
  v_cmp_class_f32 vcc, v89, s9
  s_and_b64 vcc, vcc, s[34:35]
  s_andn2_b64 s[28:29], s[28:29], vcc
  v_cmp_class_f32 vcc, v90, s9
  s_and_b64 vcc, vcc, s[34:35]
  s_andn2_b64 s[28:29], s[28:29], vcc
  v_cmp_class_f32 vcc, v91, s9
  s_and_b64 vcc, vcc, s[34:35]
  s_andn2_b64 s[28:29], s[28:29], vcc
  s_cmp_eq_u64 s[28:29], -1
  s_cbranch_scc1 ATT_OK
  v_mov_b32 v2, 1
  v_mov_b32 v5, 163596
  ds_write_b32 v5, v2
ATT_OK:
  s_waitcnt lgkmcnt(0)
  s_barrier
  v_mov_b32 v5, 163596
  ds_read_b32 v2, v5
  s_waitcnt lgkmcnt(0)
  v_readfirstlane_b32 s9, v2
  s_cmp_lg_u32 s9, 0
  s_cbranch_scc1 ATT_SLOW
  v_rcp_f32 v3, v3
  s_nop 0
  v_mul_f32 v80, v80, v3
  v_mul_f32 v81, v81, v3
  v_mul_f32 v82, v82, v3
  v_mul_f32 v83, v83, v3
  v_mul_f32 v84, v84, v3
  v_mul_f32 v85, v85, v3
  v_mul_f32 v86, v86, v3
  v_mul_f32 v87, v87, v3
  v_mul_f32 v88, v88, v3
  v_mul_f32 v89, v89, v3
  v_mul_f32 v90, v90, v3
  v_mul_f32 v91, v91, v3
  v_cvt_pk_bf16_f32 v72, v80, v81
  v_cvt_pk_bf16_f32 v73, v82, v83
  v_cvt_pk_bf16_f32 v74, v84, v85
  v_cvt_pk_bf16_f32 v75, v86, v87
  v_cvt_pk_bf16_f32 v76, v88, v89
  v_cvt_pk_bf16_f32 v77, v90, v91
  v_and_b32 v4, 31, v1
  s_lshl_b32 s9, s8, 5
  v_add_u32 v4, s9, v4
  v_lshlrev_b32 v4, 1, v4
  v_lshrrev_b32 v5, 5, v1
  v_lshl_add_u32 v4, v5, 11, v4
  ds_write_b16 v4, v72 offset:0
  ds_write_b16_d16_hi v4, v72 offset:512
  ds_write_b16 v4, v73 offset:1024
  ds_write_b16_d16_hi v4, v73 offset:1536
  ds_write_b16 v4, v74 offset:4096
  ds_write_b16_d16_hi v4, v74 offset:4608
  ds_write_b16 v4, v75 offset:5120
  ds_write_b16_d16_hi v4, v75 offset:5632
  s_mov_b32 exec_hi, 0
  ds_write_b16 v4, v76 offset:8192
  ds_write_b16_d16_hi v4, v76 offset:8704
  ds_write_b16 v4, v77 offset:9216
  ds_write_b16_d16_hi v4, v77 offset:9728
  s_mov_b64 exec, -1
  s_waitcnt lgkmcnt(0)
  s_branch P4_STAGED
ATT_SLOW:
  s_waitcnt vmcnt(0)
  v_mov_b32 v80, 0
  v_mov_b32 v81, 0
  v_mov_b32 v82, 0
  v_mov_b32 v83, 0
  v_mov_b32 v84, 0
  v_mov_b32 v85, 0
  v_mov_b32 v86, 0
  v_mov_b32 v87, 0
  v_mov_b32 v88, 0
  v_mov_b32 v89, 0
  v_mov_b32 v90, 0
  v_mov_b32 v91, 0
  v_mov_b32 v92, 0
  v_mov_b32 v93, 0
  v_mov_b32 v94, 0
  v_mov_b32 v95, 0
  v_mov_b32 v2, 0xff7fffff
  s_mov_b32 s15, 0
ATT_SLOW_STAGE:
  s_barrier
  s_mul_i32 s10, s15, 45056
  s_add_u32 m0, s13, 0
  s_add_u32 s14, s10, 0
  buffer_load_dwordx4 v105, s[16:19], s14 offen sc1 lds
  s_add_u32 m0, s13, 8192
  s_add_u32 s14, s10, 8192
  buffer_load_dwordx4 v105, s[16:19], s14 offen sc1 lds
  s_add_u32 m0, s13, 16384
  s_add_u32 s14, s10, 16384
  buffer_load_dwordx4 v105, s[16:19], s14 offen sc1 lds
  s_add_u32 m0, s13, 24576
  s_add_u32 s14, s10, 24576
  buffer_load_dwordx4 v105, s[16:19], s14 offen sc1 lds
  s_add_u32 m0, s13, 32768
  s_add_u32 s14, s10, 32768
  buffer_load_dwordx4 v105, s[16:19], s14 offen sc1 lds
  s_cmp_ge_u32 s8, 4
  s_cbranch_scc1 ATT_SLOW_NP
  s_add_u32 m0, s13, 40960
  s_add_u32 s14, s10, 40960
  buffer_load_dwordx4 v105, s[16:19], s14 offen sc1 lds
ATT_SLOW_NP:
  s_waitcnt vmcnt(0)
  s_barrier
  v_mov_b32 v5, v96
  v_mov_b32 v6, v99
  v_mov_b32 v7, v102
  s_mov_b32 s9, 0
ATT_SLOW_TILE:
  ds_read_b128 v[12:15], v5
  ds_read_b64 v[20:21], v6
  ds_read_b128 v[24:27], v7
  ds_read_b128 v[28:31], v7 offset:768
  s_waitcnt lgkmcnt(0)
  v_mfma_f32_32x32x16_bf16 v[40:55], v[12:15], v[112:115], 0
  v_mfma_f32_32x32x8bf16_1k v[40:55], v[20:21], v[116:117], v[40:55]
  v_add_u32 v5, 2816, v5
  v_add_u32 v6, 2816, v6
  v_add_u32 v7, 2816, v7
  s_nop 8
  v_max_f32 v108, v40, v41
  v_max_f32 v108, v108, v42
  v_max_f32 v108, v108, v43
  v_max_f32 v108, v108, v44
  v_max_f32 v108, v108, v45
  v_max_f32 v108, v108, v46
  v_max_f32 v108, v108, v47
  v_max_f32 v108, v108, v48
  v_max_f32 v108, v108, v49
  v_max_f32 v108, v108, v50
  v_max_f32 v108, v108, v51
  v_max_f32 v108, v108, v52
  v_max_f32 v108, v108, v53
  v_max_f32 v108, v108, v54
  v_max_f32 v108, v108, v55
  v_mov_b32 v109, v108
  s_nop 1
  v_permlane32_swap_b32 v108, v109
  v_max_f32 v108, v108, v109
  v_max_f32 v108, v108, v2
  v_sub_f32 v109, v2, v108
  v_exp_f32 v109, v109
  v_mov_b32 v2, v108
  v_sub_f32 v40, v40, v108
  v_sub_f32 v41, v41, v108
  v_sub_f32 v42, v42, v108
  v_sub_f32 v43, v43, v108
  v_sub_f32 v44, v44, v108
  v_sub_f32 v45, v45, v108
  v_sub_f32 v46, v46, v108
  v_sub_f32 v47, v47, v108
  v_sub_f32 v48, v48, v108
  v_sub_f32 v49, v49, v108
  v_sub_f32 v50, v50, v108
  v_sub_f32 v51, v51, v108
  v_sub_f32 v52, v52, v108
  v_sub_f32 v53, v53, v108
  v_sub_f32 v54, v54, v108
  v_sub_f32 v55, v55, v108
  v_exp_f32 v40, v40
  v_exp_f32 v41, v41
  v_exp_f32 v42, v42
  v_exp_f32 v43, v43
  v_exp_f32 v44, v44
  v_exp_f32 v45, v45
  v_exp_f32 v46, v46
  v_exp_f32 v47, v47
  v_exp_f32 v48, v48
  v_exp_f32 v49, v49
  v_exp_f32 v50, v50
  v_exp_f32 v51, v51
  v_exp_f32 v52, v52
  v_exp_f32 v53, v53
  v_exp_f32 v54, v54
  v_exp_f32 v55, v55
  v_mul_f32 v80, v80, v109
  v_mul_f32 v81, v81, v109
  v_mul_f32 v82, v82, v109
  v_mul_f32 v83, v83, v109
  v_mul_f32 v84, v84, v109
  v_mul_f32 v85, v85, v109
  v_mul_f32 v86, v86, v109
  v_mul_f32 v87, v87, v109
  v_mul_f32 v88, v88, v109
  v_mul_f32 v89, v89, v109
  v_mul_f32 v90, v90, v109
  v_mul_f32 v91, v91, v109
  v_mul_f32 v92, v92, v109
  v_mul_f32 v93, v93, v109
  v_mul_f32 v94, v94, v109
  v_mul_f32 v95, v95, v109
  v_cvt_pk_bf16_f32 v72, v40, v41
  v_cvt_pk_bf16_f32 v73, v42, v43
  v_cvt_pk_bf16_f32 v74, v44, v45
  v_cvt_pk_bf16_f32 v75, v46, v47
  v_cvt_pk_bf16_f32 v76, v48, v49
  v_cvt_pk_bf16_f32 v77, v50, v51
  v_cvt_pk_bf16_f32 v78, v52, v53
  v_cvt_pk_bf16_f32 v79, v54, v55
  v_mfma_f32_32x32x16_bf16 v[80:95], v[24:27], v[72:75], v[80:95]
  s_nop 0
  v_mfma_f32_32x32x16_bf16 v[80:95], v[28:31], v[76:79], v[80:95]
  s_add_u32 s9, s9, 1
  s_cmp_lt_u32 s9, 16
  s_cbranch_scc1 ATT_SLOW_TILE
  s_add_u32 s15, s15, 1
  s_cmp_lt_u32 s15, 4
  s_cbranch_scc1 ATT_SLOW_STAGE
  s_barrier
  s_nop 4
  v_mov_b32 v2, v88
  v_mov_b32 v3, v88
  s_nop 1
  v_permlane32_swap_b32 v2, v3
  v_rcp_f32 v3, v3
  s_nop 0
  v_mul_f32 v80, v80, v3
  v_mul_f32 v81, v81, v3
  v_mul_f32 v82, v82, v3
  v_mul_f32 v83, v83, v3
  v_mul_f32 v84, v84, v3
  v_mul_f32 v85, v85, v3
  v_mul_f32 v86, v86, v3
  v_mul_f32 v87, v87, v3
  v_mul_f32 v88, v88, v3
  v_mul_f32 v89, v89, v3
  v_mul_f32 v90, v90, v3
  v_mul_f32 v91, v91, v3
  v_cvt_pk_bf16_f32 v72, v80, v81
  v_cvt_pk_bf16_f32 v73, v82, v83
  v_cvt_pk_bf16_f32 v74, v84, v85
  v_cvt_pk_bf16_f32 v75, v86, v87
  v_cvt_pk_bf16_f32 v76, v88, v89
  v_cvt_pk_bf16_f32 v77, v90, v91
  v_and_b32 v4, 31, v1
  s_lshl_b32 s9, s8, 5
  v_add_u32 v4, s9, v4
  v_lshlrev_b32 v4, 1, v4
  v_lshrrev_b32 v5, 5, v1
  v_lshl_add_u32 v4, v5, 11, v4
  ds_write_b16 v4, v72 offset:0
  ds_write_b16_d16_hi v4, v72 offset:512
  ds_write_b16 v4, v73 offset:1024
  ds_write_b16_d16_hi v4, v73 offset:1536
  ds_write_b16 v4, v74 offset:4096
  ds_write_b16_d16_hi v4, v74 offset:4608
  ds_write_b16 v4, v75 offset:5120
  ds_write_b16_d16_hi v4, v75 offset:5632
  s_mov_b32 exec_hi, 0
  ds_write_b16 v4, v76 offset:8192
  ds_write_b16_d16_hi v4, v76 offset:8704
  ds_write_b16 v4, v77 offset:9216
  ds_write_b16_d16_hi v4, v77 offset:9728
  s_mov_b64 exec, -1
  s_waitcnt lgkmcnt(0)
  s_branch P4_STAGED
P4_STAGED:
  s_waitcnt vmcnt(0)
  s_barrier
  s_and_b32 s3, s2, 7
  s_lshr_b32 s13, s2, 3
  s_lshl_b32 s14, s3, 2
  s_and_b32 s15, s13, 3
  s_add_u32 s11, s14, s15
  s_lshr_b32 s12, s13, 2
  s_and_b32 s28, s31, 1
  s_lshr_b32 s29, s31, 1
  s_lshl_b32 s9, s11, 6
  s_lshl_b32 s10, s28, 5
  s_add_u32 s30, s9, s10
  s_cmp_ge_u32 s8, 4
  s_cbranch_scc1 P4_LOADER
  v_lshlrev_b32 v5, 4, v1
  s_mul_i32 s9, s8, 2560
  v_add_u32 v5, s9, v5
  ds_read_b128 v[40:43], v5 offset:0
  ds_read_b128 v[44:47], v5 offset:1024
  ds_read_b128 v[48:51], v5 offset:2048
  s_waitcnt lgkmcnt(2)
  buffer_store_dwordx4 v[40:43], v128, s[24:27], 0 offen sc1
  s_waitcnt lgkmcnt(1)
  buffer_store_dwordx4 v[44:47], v129, s[24:27], 0 offen sc1
  s_waitcnt lgkmcnt(0)
  buffer_store_dwordx4 v[48:51], v130, s[24:27], 0 offen sc1
  s_barrier
  s_waitcnt vmcnt(0)
  v_mov_b32 v20, 163600
  v_mov_b32 v21, 1
  s_mov_b64 exec, 1
  ds_add_rtn_u32 v22, v20, v21
  s_waitcnt lgkmcnt(0)
  v_readfirstlane_b32 s9, v22
  s_mov_b64 exec, -1
  s_cmp_lg_u32 s9, 3
  s_cbranch_scc1 P3O_NL
  s_add_u32 s56, s86, 29655040
  s_addc_u32 s57, s87, 0
  s_mov_b32 s58, 229376
  s_mov_b32 s59, 0x00020000
  s_lshl_b32 s9, s2, 7
  s_add_u32 s9, s9, 98304
  v_mov_b32 v20, s9
  v_mov_b32 v21, s60
  s_mov_b64 exec, 1
  buffer_store_dword v21, v20, s[56:59], 0 offen sc1
  s_mov_b64 exec, -1
P3O_NL:
  s_branch P4_COMPUTE
P4_LOADER:
  s_barrier
  v_lshrrev_b32 v2, 3, v1
  v_bfe_u32 v3, v1, 4, 1
  v_and_b32 v4, 7, v1
  s_mul_i32 s34, s29, 320
  s_lshl_b32 s9, s28, 5
  s_add_u32 s34, s34, s9
  v_add_u32 v2, s34, v2
  v_lshlrev_b32 v2, 12, v2
  s_lshl_b32 s9, s11, 7
  v_add_u32 v2, s9, v2
  v_or_b32 v5, 0, v3
  v_lshlrev_b32 v5, 1, v5
  v_xor_b32 v5, v5, v4
  v_lshlrev_b32 v5, 4, v5
  v_add_u32 v5, 0, v5
  v_add_u32 v8, v2, v5
  v_or_b32 v5, 2, v3
  v_lshlrev_b32 v5, 1, v5
  v_xor_b32 v5, v5, v4
  v_lshlrev_b32 v5, 4, v5
  v_add_u32 v5, 31744, v5
  v_add_u32 v9, v2, v5
  v_or_b32 v5, 0, v3
  v_lshlrev_b32 v5, 1, v5
  v_xor_b32 v5, v5, v4
  v_lshlrev_b32 v5, 4, v5
  v_add_u32 v5, 63488, v5
  v_add_u32 v10, v2, v5
  v_or_b32 v5, 2, v3
  v_lshlrev_b32 v5, 1, v5
  v_xor_b32 v5, v5, v4
  v_lshlrev_b32 v5, 4, v5
  v_add_u32 v5, 95232, v5
  v_add_u32 v11, v2, v5
  v_lshlrev_b32 v2, 4, v1
  s_mul_i32 s9, s12, 102400
  s_mul_i32 s10, s29, 51200
  s_add_u32 s9, s9, s10
  s_mul_i32 s10, s28, 5120
  s_add_u32 s9, s9, s10
  v_add_u32 v12, s9, v2
  v_add_u32 v13, 4096, v12
  s_lshl_b32 s13, s31, 12
  s_mul_i32 s15, s29, 10240
  s_mul_i32 s10, s28, 5120
  s_add_u32 s15, s15, s10
  s_add_u32 s16, s86, 11075584
  s_addc_u32 s17, s87, 0
  s_mov_b32 s18, 2621440
  s_mov_b32 s19, 0x00020000
  s_add_u32 s20, s86, 22609920
  s_addc_u32 s21, s87, 0
  s_mov_b32 s22, 819200
  s_mov_b32 s23, 0x00020000
  s_add_u32 m0, s15, 65536
  s_mov_b32 s14, 0
  buffer_load_dwordx4 v12, s[20:23], s14 offen offset:0 sc1 lds
  buffer_load_dwordx4 v12, s[20:23], s14 offen offset:1024 sc1 lds
  buffer_load_dwordx4 v12, s[20:23], s14 offen offset:2048 sc1 lds
  buffer_load_dwordx4 v12, s[20:23], s14 offen offset:3072 sc1 lds
  s_add_u32 m0, s15, 69632
  s_nop 0
  buffer_load_dwordx4 v13, s[20:23], s14 offen sc1 lds
  s_add_u32 m0, s15, 86016
  s_mov_b32 s14, 10240
  buffer_load_dwordx4 v12, s[20:23], s14 offen offset:0 sc1 lds
  buffer_load_dwordx4 v12, s[20:23], s14 offen offset:1024 sc1 lds
  buffer_load_dwordx4 v12, s[20:23], s14 offen offset:2048 sc1 lds
  buffer_load_dwordx4 v12, s[20:23], s14 offen offset:3072 sc1 lds
  s_add_u32 m0, s15, 90112
  s_nop 0
  buffer_load_dwordx4 v13, s[20:23], s14 offen sc1 lds
  s_add_u32 m0, s15, 106496
  s_mov_b32 s14, 20480
  buffer_load_dwordx4 v12, s[20:23], s14 offen offset:0 sc1 lds
  buffer_load_dwordx4 v12, s[20:23], s14 offen offset:1024 sc1 lds
  buffer_load_dwordx4 v12, s[20:23], s14 offen offset:2048 sc1 lds
  buffer_load_dwordx4 v12, s[20:23], s14 offen offset:3072 sc1 lds
  s_add_u32 m0, s15, 110592
  s_nop 0
  buffer_load_dwordx4 v13, s[20:23], s14 offen sc1 lds
  s_mov_b32 s24, s64
  s_mov_b32 s25, s65
  s_mov_b32 s26, 2621440
  s_mov_b32 s27, 0x00020000
  s_mov_b32 s36, s86
  s_mov_b32 s37, s87
  s_mov_b32 s38, 15360
  s_mov_b32 s39, 0x00020000
  v_and_b32 v16, 255, v0
  s_lshl_b32 s9, s11, 6
  s_mul_i32 s10, s12, 160
  v_add_u32 v17, 0, v16
  v_mul_u32_u24 v18, 6554, v17
  v_lshrrev_b32 v18, 16, v18
  v_mul_u32_u24 v19, 10, v18
  v_sub_u32 v19, v17, v19
  v_add_u32 v18, s9, v18
  v_mul_u32_u24 v18, 1280, v18
  v_lshl_add_u32 v18, v19, 4, v18
  v_add_u32 v18, s10, v18
  s_lshl_b32 s14, s31, 10
  s_add_u32 m0, s14, 147456
  s_nop 0
  buffer_load_dwordx4 v18, s[24:27], 0 offen sc1 lds
  v_add_u32 v17, 256, v16
  v_mul_u32_u24 v18, 6554, v17
  v_lshrrev_b32 v18, 16, v18
  v_mul_u32_u24 v19, 10, v18
  v_sub_u32 v19, v17, v19
  v_add_u32 v18, s9, v18
  v_mul_u32_u24 v18, 1280, v18
  v_lshl_add_u32 v18, v19, 4, v18
  v_add_u32 v18, s10, v18
  s_lshl_b32 s14, s31, 10
  s_add_u32 m0, s14, 151552
  s_nop 0
  buffer_load_dwordx4 v18, s[24:27], 0 offen sc1 lds
  v_add_u32 v17, 512, v16
  v_mul_u32_u24 v18, 6554, v17
  v_lshrrev_b32 v18, 16, v18
  v_mul_u32_u24 v19, 10, v18
  v_sub_u32 v19, v17, v19
  v_add_u32 v18, s9, v18
  v_mul_u32_u24 v18, 1280, v18
  v_lshl_add_u32 v18, v19, 4, v18
  v_add_u32 v18, s10, v18
  v_cmp_gt_u32 vcc, 640, v17
  v_mov_b32 v19, 0x7ffffff0
  s_nop 0
  v_cndmask_b32 v18, v19, v18, vcc
  s_lshl_b32 s14, s31, 10
  s_add_u32 m0, s14, 155648
  s_cmp_ge_u32 s31, 2
  s_cbranch_scc1 NRD_SKIP2
  buffer_load_dwordx4 v18, s[24:27], 0 offen sc1 lds
NRD_SKIP2:
  s_cmp_lg_u32 s31, 3
  s_cbranch_scc1 NRD_NG2
  v_lshlrev_b32 v18, 4, v1
  s_mul_i32 s14, s12, 320
  s_add_u32 s14, s14, 5120
  s_mov_b32 m0, 157696
  s_mov_b32 exec_lo, 0xfffff
  s_mov_b32 exec_hi, 0
  buffer_load_dwordx4 v18, s[36:39], s14 offen sc1 lds
  s_mov_b64 exec, -1
NRD_NG2:
  s_cmp_lg_u32 s8, 4
  s_cbranch_scc1 P4L_GO
  s_add_u32 s56, s86, 29655040
  s_addc_u32 s57, s87, 0
  s_mov_b32 s58, 229376
  s_mov_b32 s59, 0x00020000
  s_lshl_b32 s9, s3, 5
  v_and_b32 v20, 63, v0
  v_add_u32 v20, s9, v20
  v_lshlrev_b32 v20, 7, v20
  v_add_u32 v20, 98304, v20
  s_mov_b32 s14, 0
  s_mov_b32 exec_lo, -1
  s_mov_b32 exec_hi, 0
  s_waitcnt vmcnt(0)
  buffer_load_dword v226, v20, s[56:59], 0 offen sc1
P4L_O_P:
  buffer_load_dword v227, v20, s[56:59], 0 offen sc1
  s_waitcnt vmcnt(1)
  v_cmp_ne_u32 vcc, s60, v226
  s_cmp_eq_u64 vcc, 0
  s_cbranch_scc1 P4L_O_R
  buffer_load_dword v226, v20, s[56:59], 0 offen sc1
  s_waitcnt vmcnt(1)
  v_cmp_ne_u32 vcc, s60, v227
  s_cmp_eq_u64 vcc, 0
  s_cbranch_scc1 P4L_O_R
  s_add_u32 s14, s14, 1
  s_cmp_gt_u32 s14, 30000
  s_cbranch_scc0 P4L_O_P
P4L_O_R:
  s_mov_b64 exec, -1
P4L_GO:
  s_barrier
  s_add_u32 m0, s13, 0
  s_mov_b32 s14, 0
  buffer_load_dwordx4 v8, s[16:19], s14 offen offset:0 sc1 lds
  buffer_load_dwordx4 v9, s[16:19], s14 offen offset:1024 sc1 lds
  buffer_load_dwordx4 v10, s[16:19], s14 offen offset:2048 sc1 lds
  buffer_load_dwordx4 v11, s[16:19], s14 offen offset:3072 sc1 lds
  s_add_u32 m0, s13, 16384
  s_mov_b32 s14, 262144
  buffer_load_dwordx4 v8, s[16:19], s14 offen offset:0 sc1 lds
  buffer_load_dwordx4 v9, s[16:19], s14 offen offset:1024 sc1 lds
  buffer_load_dwordx4 v10, s[16:19], s14 offen offset:2048 sc1 lds
  buffer_load_dwordx4 v11, s[16:19], s14 offen offset:3072 sc1 lds
  s_add_u32 m0, s13, 32768
  s_mov_b32 s14, 524288
  buffer_load_dwordx4 v8, s[16:19], s14 offen offset:0 sc1 lds
  buffer_load_dwordx4 v9, s[16:19], s14 offen offset:1024 sc1 lds
  buffer_load_dwordx4 v10, s[16:19], s14 offen offset:2048 sc1 lds
  buffer_load_dwordx4 v11, s[16:19], s14 offen offset:3072 sc1 lds
  s_waitcnt vmcnt(8)
  s_barrier
  s_waitcnt vmcnt(4)
  s_barrier
  s_add_u32 m0, s13, 49152
  s_mov_b32 s14, 786432
  buffer_load_dwordx4 v8, s[16:19], s14 offen offset:0 sc1 lds
  buffer_load_dwordx4 v9, s[16:19], s14 offen offset:1024 sc1 lds
  buffer_load_dwordx4 v10, s[16:19], s14 offen offset:2048 sc1 lds
  buffer_load_dwordx4 v11, s[16:19], s14 offen offset:3072 sc1 lds
  s_add_u32 m0, s15, 126976
  s_mov_b32 s14, 30720
  buffer_load_dwordx4 v12, s[20:23], s14 offen offset:0 sc1 lds
  buffer_load_dwordx4 v12, s[20:23], s14 offen offset:1024 sc1 lds
  buffer_load_dwordx4 v12, s[20:23], s14 offen offset:2048 sc1 lds
  buffer_load_dwordx4 v12, s[20:23], s14 offen offset:3072 sc1 lds
  s_add_u32 m0, s15, 131072
  s_nop 0
  buffer_load_dwordx4 v13, s[20:23], s14 offen sc1 lds
  s_waitcnt vmcnt(9)
  s_barrier
  s_add_u32 m0, s13, 0
  s_mov_b32 s14, 1048576
  buffer_load_dwordx4 v8, s[16:19], s14 offen offset:0 sc1 lds
  buffer_load_dwordx4 v9, s[16:19], s14 offen offset:1024 sc1 lds
  buffer_load_dwordx4 v10, s[16:19], s14 offen offset:2048 sc1 lds
  buffer_load_dwordx4 v11, s[16:19], s14 offen offset:3072 sc1 lds
  s_add_u32 m0, s15, 65536
  s_mov_b32 s14, 40960
  buffer_load_dwordx4 v12, s[20:23], s14 offen offset:0 sc1 lds
  buffer_load_dwordx4 v12, s[20:23], s14 offen offset:1024 sc1 lds
  buffer_load_dwordx4 v12, s[20:23], s14 offen offset:2048 sc1 lds
  buffer_load_dwordx4 v12, s[20:23], s14 offen offset:3072 sc1 lds
  s_add_u32 m0, s15, 69632
  s_nop 0
  buffer_load_dwordx4 v13, s[20:23], s14 offen sc1 lds
  s_waitcnt vmcnt(9)
  s_barrier
  s_waitcnt vmcnt(0)
  s_barrier
  s_barrier
  s_lshr_b32 s35, s11, 1
  s_lshl_b32 s35, s35, 4
  s_and_b32 s36, s11, 1
  s_lshl_b32 s36, s36, 3
  s_add_u32 s35, s35, s36
  s_add_u32 s35, s35, s12
  s_and_b32 s3, s2, 7
  s_lshr_b32 s13, s2, 3
  s_and_b32 s14, s3, 1
  s_lshl_b32 s14, s14, 3
  s_and_b32 s15, s13, 7
  s_add_u32 s11, s14, s15
  s_lshr_b32 s14, s3, 1
  s_lshl_b32 s14, s14, 2
  s_lshr_b32 s15, s13, 3
  s_add_u32 s12, s14, s15
  s_lshl_b32 s9, s11, 7
  s_lshl_b32 s10, s31, 5
  s_add_u32 s9, s9, s10
  v_lshrrev_b32 v2, 3, v1
  v_lshrrev_b32 v3, 4, v1
  v_and_b32 v4, 7, v1
  v_add_u32 v2, s9, v2
  s_mov_b32 s10, 1280
  v_mul_lo_u32 v2, s10, v2
  v_xor_b32 v5, 0, v3
  v_xor_b32 v5, v5, v4
  v_lshlrev_b32 v5, 4, v5
  v_add_u32 v5, 0, v5
  v_add_u32 v8, v2, v5
  v_xor_b32 v5, 4, v3
  v_xor_b32 v5, v5, v4
  v_lshlrev_b32 v5, 4, v5
  v_add_u32 v5, 9216, v5
  v_add_u32 v9, v2, v5
  v_xor_b32 v5, 0, v3
  v_xor_b32 v5, v5, v4
  v_lshlrev_b32 v5, 4, v5
  v_add_u32 v5, 18432, v5
  v_add_u32 v10, v2, v5
  v_xor_b32 v5, 4, v3
  v_xor_b32 v5, v5, v4
  v_lshlrev_b32 v5, 4, v5
  v_add_u32 v5, 27648, v5
  v_add_u32 v11, v2, v5
  v_lshlrev_b32 v2, 4, v1
  s_mul_i32 s9, s31, 6144
  s_mul_i32 s10, s12, 245760
  s_add_u32 s9, s9, s10
  v_add_u32 v12, s9, v2
  v_add_u32 v13, 4096, v12
  s_lshl_b32 s13, s31, 12
  s_mul_i32 s15, s31, 6144
  s_add_u32 s16, s86, 13697024
  s_addc_u32 s17, s87, 0
  s_mov_b32 s18, 2621440
  s_mov_b32 s19, 0x00020000
  s_add_u32 s20, s86, 25395200
  s_addc_u32 s21, s87, 0
  s_mov_b32 s22, 3932160
  s_mov_b32 s23, 0x00020000
  s_add_u32 m0, s15, 65536
  s_mov_b32 s14, 0
  buffer_load_dwordx4 v12, s[20:23], s14 offen offset:0 sc1 lds
  buffer_load_dwordx4 v12, s[20:23], s14 offen offset:1024 sc1 lds
  buffer_load_dwordx4 v12, s[20:23], s14 offen offset:2048 sc1 lds
  buffer_load_dwordx4 v12, s[20:23], s14 offen offset:3072 sc1 lds
  s_add_u32 m0, s15, 69632
  s_nop 0
  buffer_load_dwordx4 v13, s[20:23], s14 offen offset:0 sc1 lds
  buffer_load_dwordx4 v13, s[20:23], s14 offen offset:1024 sc1 lds
  s_add_u32 m0, s15, 90112
  s_mov_b32 s14, 24576
  buffer_load_dwordx4 v12, s[20:23], s14 offen offset:0 sc1 lds
  buffer_load_dwordx4 v12, s[20:23], s14 offen offset:1024 sc1 lds
  buffer_load_dwordx4 v12, s[20:23], s14 offen offset:2048 sc1 lds
  buffer_load_dwordx4 v12, s[20:23], s14 offen offset:3072 sc1 lds
  s_add_u32 m0, s15, 94208
  s_nop 0
  buffer_load_dwordx4 v13, s[20:23], s14 offen offset:0 sc1 lds
  buffer_load_dwordx4 v13, s[20:23], s14 offen offset:1024 sc1 lds
  s_add_u32 m0, s15, 114688
  s_mov_b32 s14, 49152
  buffer_load_dwordx4 v12, s[20:23], s14 offen offset:0 sc1 lds
  buffer_load_dwordx4 v12, s[20:23], s14 offen offset:1024 sc1 lds
  buffer_load_dwordx4 v12, s[20:23], s14 offen offset:2048 sc1 lds
  buffer_load_dwordx4 v12, s[20:23], s14 offen offset:3072 sc1 lds
  s_add_u32 m0, s15, 118784
  s_nop 0
  buffer_load_dwordx4 v13, s[20:23], s14 offen offset:0 sc1 lds
  buffer_load_dwordx4 v13, s[20:23], s14 offen offset:1024 sc1 lds
  s_barrier
  s_cmp_lg_u32 s8, 4
  s_cbranch_scc1 P5L_GO
  s_add_u32 s56, s86, 29655040
  s_addc_u32 s57, s87, 0
  s_mov_b32 s58, 229376
  s_mov_b32 s59, 0x00020000
  s_lshl_b32 s9, s35, 7
  s_add_u32 s9, s9, 131072
  v_mov_b32 v20, s9
  v_mov_b32 v21, s60
  s_mov_b64 exec, 1
  buffer_store_dword v21, v20, s[56:59], 0 offen sc1
  s_mov_b64 exec, -1
  s_add_u32 s56, s86, 29655040
  s_addc_u32 s57, s87, 0
  s_mov_b32 s58, 229376
  s_mov_b32 s59, 0x00020000
  s_lshl_b32 s9, s11, 4
  v_and_b32 v20, 63, v0
  v_add_u32 v20, s9, v20
  v_lshlrev_b32 v20, 7, v20
  v_add_u32 v20, 131072, v20
  s_mov_b32 s14, 0
  s_mov_b64 exec, 0xffff
  s_waitcnt vmcnt(0)
  buffer_load_dword v226, v20, s[56:59], 0 offen sc1
P5L_X_P:
  buffer_load_dword v227, v20, s[56:59], 0 offen sc1
  s_waitcnt vmcnt(1)
  v_cmp_ne_u32 vcc, s60, v226
  s_cmp_eq_u64 vcc, 0
  s_cbranch_scc1 P5L_X_R
  buffer_load_dword v226, v20, s[56:59], 0 offen sc1
  s_waitcnt vmcnt(1)
  v_cmp_ne_u32 vcc, s60, v227
  s_cmp_eq_u64 vcc, 0
  s_cbranch_scc1 P5L_X_R
  s_add_u32 s14, s14, 1
  s_cmp_gt_u32 s14, 30000
  s_cbranch_scc0 P5L_X_P
P5L_X_R:
  s_mov_b64 exec, -1
P5L_GO:
  s_barrier
  s_add_u32 m0, s13, 0
  s_mov_b32 s14, 0
  buffer_load_dwordx4 v8, s[16:19], s14 offen offset:0 sc1 lds
  buffer_load_dwordx4 v9, s[16:19], s14 offen offset:1024 sc1 lds
  buffer_load_dwordx4 v10, s[16:19], s14 offen offset:2048 sc1 lds
  buffer_load_dwordx4 v11, s[16:19], s14 offen offset:3072 sc1 lds
  s_add_u32 m0, s13, 16384
  s_mov_b32 s14, 128
  buffer_load_dwordx4 v8, s[16:19], s14 offen offset:0 sc1 lds
  buffer_load_dwordx4 v9, s[16:19], s14 offen offset:1024 sc1 lds
  buffer_load_dwordx4 v10, s[16:19], s14 offen offset:2048 sc1 lds
  buffer_load_dwordx4 v11, s[16:19], s14 offen offset:3072 sc1 lds
  s_add_u32 m0, s13, 32768
  s_mov_b32 s14, 256
  buffer_load_dwordx4 v8, s[16:19], s14 offen offset:0 sc1 lds
  buffer_load_dwordx4 v9, s[16:19], s14 offen offset:1024 sc1 lds
  buffer_load_dwordx4 v10, s[16:19], s14 offen offset:2048 sc1 lds
  buffer_load_dwordx4 v11, s[16:19], s14 offen offset:3072 sc1 lds
  s_waitcnt vmcnt(8)
  s_barrier
  s_waitcnt vmcnt(4)
  s_barrier
  s_add_u32 m0, s13, 49152
  s_mov_b32 s14, 384
  buffer_load_dwordx4 v8, s[16:19], s14 offen offset:0 sc1 lds
  buffer_load_dwordx4 v9, s[16:19], s14 offen offset:1024 sc1 lds
  buffer_load_dwordx4 v10, s[16:19], s14 offen offset:2048 sc1 lds
  buffer_load_dwordx4 v11, s[16:19], s14 offen offset:3072 sc1 lds
  s_add_u32 m0, s15, 139264
  s_mov_b32 s14, 73728
  buffer_load_dwordx4 v12, s[20:23], s14 offen offset:0 sc1 lds
  buffer_load_dwordx4 v12, s[20:23], s14 offen offset:1024 sc1 lds
  buffer_load_dwordx4 v12, s[20:23], s14 offen offset:2048 sc1 lds
  buffer_load_dwordx4 v12, s[20:23], s14 offen offset:3072 sc1 lds
  s_add_u32 m0, s15, 143360
  s_nop 0
  buffer_load_dwordx4 v13, s[20:23], s14 offen offset:0 sc1 lds
  buffer_load_dwordx4 v13, s[20:23], s14 offen offset:1024 sc1 lds
  s_waitcnt vmcnt(10)
  s_barrier
  s_add_u32 m0, s13, 0
  s_mov_b32 s14, 512
  buffer_load_dwordx4 v8, s[16:19], s14 offen offset:0 sc1 lds
  buffer_load_dwordx4 v9, s[16:19], s14 offen offset:1024 sc1 lds
  buffer_load_dwordx4 v10, s[16:19], s14 offen offset:2048 sc1 lds
  buffer_load_dwordx4 v11, s[16:19], s14 offen offset:3072 sc1 lds
  s_add_u32 m0, s15, 65536
  s_mov_b32 s14, 98304
  buffer_load_dwordx4 v12, s[20:23], s14 offen offset:0 sc1 lds
  buffer_load_dwordx4 v12, s[20:23], s14 offen offset:1024 sc1 lds
  buffer_load_dwordx4 v12, s[20:23], s14 offen offset:2048 sc1 lds
  buffer_load_dwordx4 v12, s[20:23], s14 offen offset:3072 sc1 lds
  s_add_u32 m0, s15, 69632
  s_nop 0
  buffer_load_dwordx4 v13, s[20:23], s14 offen offset:0 sc1 lds
  buffer_load_dwordx4 v13, s[20:23], s14 offen offset:1024 sc1 lds
  s_cmp_lg_u32 s8, 5
  s_cbranch_scc1 P5L_OA
  s_add_u32 s56, s86, 29655040
  s_addc_u32 s57, s87, 0
  s_mov_b32 s58, 229376
  s_mov_b32 s59, 0x00020000
  v_and_b32 v24, 63, v0
  v_lshlrev_b32 v24, 7, v24
  v_add_u32 v24, 98304, v24
  v_add_u32 v25, 8192, v24
  v_add_u32 v26, 16384, v24
  v_add_u32 v27, 24576, v24
  buffer_load_dword v28, v24, s[56:59], 0 offen sc1
  buffer_load_dword v29, v25, s[56:59], 0 offen sc1
  buffer_load_dword v30, v26, s[56:59], 0 offen sc1
  buffer_load_dword v31, v27, s[56:59], 0 offen sc1
P5L_OA:
  s_waitcnt vmcnt(10)
  s_barrier
  s_add_u32 m0, s13, 16384
  s_mov_b32 s14, 640
  buffer_load_dwordx4 v8, s[16:19], s14 offen offset:0 sc1 lds
  buffer_load_dwordx4 v9, s[16:19], s14 offen offset:1024 sc1 lds
  buffer_load_dwordx4 v10, s[16:19], s14 offen offset:2048 sc1 lds
  buffer_load_dwordx4 v11, s[16:19], s14 offen offset:3072 sc1 lds
  s_add_u32 m0, s15, 90112
  s_mov_b32 s14, 122880
  buffer_load_dwordx4 v12, s[20:23], s14 offen offset:0 sc1 lds
  buffer_load_dwordx4 v12, s[20:23], s14 offen offset:1024 sc1 lds
  buffer_load_dwordx4 v12, s[20:23], s14 offen offset:2048 sc1 lds
  buffer_load_dwordx4 v12, s[20:23], s14 offen offset:3072 sc1 lds
  s_add_u32 m0, s15, 94208
  s_nop 0
  buffer_load_dwordx4 v13, s[20:23], s14 offen offset:0 sc1 lds
  buffer_load_dwordx4 v13, s[20:23], s14 offen offset:1024 sc1 lds
  s_waitcnt vmcnt(10)
  s_barrier
  s_add_u32 m0, s13, 32768
  s_mov_b32 s14, 768
  buffer_load_dwordx4 v8, s[16:19], s14 offen offset:0 sc1 lds
  buffer_load_dwordx4 v9, s[16:19], s14 offen offset:1024 sc1 lds
  buffer_load_dwordx4 v10, s[16:19], s14 offen offset:2048 sc1 lds
  buffer_load_dwordx4 v11, s[16:19], s14 offen offset:3072 sc1 lds
  s_add_u32 m0, s15, 114688
  s_mov_b32 s14, 147456
  buffer_load_dwordx4 v12, s[20:23], s14 offen offset:0 sc1 lds
  buffer_load_dwordx4 v12, s[20:23], s14 offen offset:1024 sc1 lds
  buffer_load_dwordx4 v12, s[20:23], s14 offen offset:2048 sc1 lds
  buffer_load_dwordx4 v12, s[20:23], s14 offen offset:3072 sc1 lds
  s_add_u32 m0, s15, 118784
  s_nop 0
  buffer_load_dwordx4 v13, s[20:23], s14 offen offset:0 sc1 lds
  buffer_load_dwordx4 v13, s[20:23], s14 offen offset:1024 sc1 lds
  s_waitcnt vmcnt(10)
  s_barrier
  s_add_u32 m0, s13, 49152
  s_mov_b32 s14, 896
  buffer_load_dwordx4 v8, s[16:19], s14 offen offset:0 sc1 lds
  buffer_load_dwordx4 v9, s[16:19], s14 offen offset:1024 sc1 lds
  buffer_load_dwordx4 v10, s[16:19], s14 offen offset:2048 sc1 lds
  buffer_load_dwordx4 v11, s[16:19], s14 offen offset:3072 sc1 lds
  s_add_u32 m0, s15, 139264
  s_mov_b32 s14, 172032
  buffer_load_dwordx4 v12, s[20:23], s14 offen offset:0 sc1 lds
  buffer_load_dwordx4 v12, s[20:23], s14 offen offset:1024 sc1 lds
  buffer_load_dwordx4 v12, s[20:23], s14 offen offset:2048 sc1 lds
  buffer_load_dwordx4 v12, s[20:23], s14 offen offset:3072 sc1 lds
  s_add_u32 m0, s15, 143360
  s_nop 0
  buffer_load_dwordx4 v13, s[20:23], s14 offen offset:0 sc1 lds
  buffer_load_dwordx4 v13, s[20:23], s14 offen offset:1024 sc1 lds
  s_waitcnt vmcnt(10)
  s_barrier
  s_add_u32 m0, s13, 0
  s_mov_b32 s14, 1024
  buffer_load_dwordx4 v8, s[16:19], s14 offen offset:0 sc1 lds
  buffer_load_dwordx4 v9, s[16:19], s14 offen offset:1024 sc1 lds
  buffer_load_dwordx4 v10, s[16:19], s14 offen offset:2048 sc1 lds
  buffer_load_dwordx4 v11, s[16:19], s14 offen offset:3072 sc1 lds
  s_add_u32 m0, s15, 65536
  s_mov_b32 s14, 196608
  buffer_load_dwordx4 v12, s[20:23], s14 offen offset:0 sc1 lds
  buffer_load_dwordx4 v12, s[20:23], s14 offen offset:1024 sc1 lds
  buffer_load_dwordx4 v12, s[20:23], s14 offen offset:2048 sc1 lds
  buffer_load_dwordx4 v12, s[20:23], s14 offen offset:3072 sc1 lds
  s_add_u32 m0, s15, 69632
  s_nop 0
  buffer_load_dwordx4 v13, s[20:23], s14 offen offset:0 sc1 lds
  buffer_load_dwordx4 v13, s[20:23], s14 offen offset:1024 sc1 lds
  s_waitcnt vmcnt(10)
  s_barrier
  s_add_u32 m0, s13, 16384
  s_mov_b32 s14, 1152
  buffer_load_dwordx4 v8, s[16:19], s14 offen offset:0 sc1 lds
  buffer_load_dwordx4 v9, s[16:19], s14 offen offset:1024 sc1 lds
  buffer_load_dwordx4 v10, s[16:19], s14 offen offset:2048 sc1 lds
  buffer_load_dwordx4 v11, s[16:19], s14 offen offset:3072 sc1 lds
  s_add_u32 m0, s15, 90112
  s_mov_b32 s14, 221184
  buffer_load_dwordx4 v12, s[20:23], s14 offen offset:0 sc1 lds
  buffer_load_dwordx4 v12, s[20:23], s14 offen offset:1024 sc1 lds
  buffer_load_dwordx4 v12, s[20:23], s14 offen offset:2048 sc1 lds
  buffer_load_dwordx4 v12, s[20:23], s14 offen offset:3072 sc1 lds
  s_add_u32 m0, s15, 94208
  s_nop 0
  buffer_load_dwordx4 v13, s[20:23], s14 offen offset:0 sc1 lds
  buffer_load_dwordx4 v13, s[20:23], s14 offen offset:1024 sc1 lds
  s_waitcnt vmcnt(10)
  s_barrier
  s_cmp_lg_u32 s8, 5
  s_cbranch_scc1 P5L_OB
  s_waitcnt vmcnt(0)
  v_cmp_ne_u32 vcc, s60, v28
  v_cmp_ne_u32 s[62:63], s60, v29
  s_or_b64 vcc, vcc, s[62:63]
  v_cmp_ne_u32 s[62:63], s60, v30
  s_or_b64 vcc, vcc, s[62:63]
  v_cmp_ne_u32 s[62:63], s60, v31
  s_or_b64 vcc, vcc, s[62:63]
  s_cmp_eq_u64 vcc, 0
  s_cbranch_scc1 P5L_OALL_OK
  s_add_u32 s56, s86, 29655040
  s_addc_u32 s57, s87, 0
  s_mov_b32 s58, 229376
  s_mov_b32 s59, 0x00020000
  v_and_b32 v24, 63, v0
  v_lshlrev_b32 v24, 7, v24
  v_add_u32 v24, 98304, v24
  v_add_u32 v25, 8192, v24
  v_add_u32 v26, 16384, v24
  v_add_u32 v27, 24576, v24
  s_mov_b32 s14, 0
P5L_OALL_P:
  buffer_load_dword v28, v24, s[56:59], 0 offen sc1
  buffer_load_dword v29, v25, s[56:59], 0 offen sc1
  buffer_load_dword v30, v26, s[56:59], 0 offen sc1
  buffer_load_dword v31, v27, s[56:59], 0 offen sc1
  s_waitcnt vmcnt(0)
  v_cmp_ne_u32 vcc, s60, v28
  v_cmp_ne_u32 s[62:63], s60, v29
  s_or_b64 vcc, vcc, s[62:63]
  v_cmp_ne_u32 s[62:63], s60, v30
  s_or_b64 vcc, vcc, s[62:63]
  v_cmp_ne_u32 s[62:63], s60, v31
  s_or_b64 vcc, vcc, s[62:63]
  s_cmp_eq_u64 vcc, 0
  s_cbranch_scc1 P5L_OALL_R
  s_add_u32 s14, s14, 1
  s_cmp_gt_u32 s14, 30000
  s_cbranch_scc1 P5L_OALL_R
  s_sleep 2
  s_branch P5L_OALL_P
P5L_OALL_R:
P5L_OALL_OK:
P5L_OB:
  s_add_u32 s24, s86, 16384
  s_addc_u32 s25, s87, 0
  s_mov_b32 s26, 24576
  s_mov_b32 s27, 0x00020000
  v_lshlrev_b32 v2, 4, v1
  s_mul_i32 s14, s12, 1536
  s_and_b32 s9, s31, 1
  s_lshl_b32 s9, s9, 10
  s_add_u32 s14, s14, s9
  s_add_u32 m0, s9, 32768
  s_nop 0
  buffer_load_dwordx4 v2, s[24:27], s14 offen sc1 lds
  s_add_u32 s24, s86, 29523968
  s_addc_u32 s25, s87, 0
  s_mov_b32 s26, 131072
  s_mov_b32 s27, 0x00020000
  s_lshl_b32 s14, s11, 13
  s_lshl_b32 s9, s31, 11
  s_add_u32 s14, s14, s9
  s_add_u32 m0, s9, 36864
  s_nop 0
  buffer_load_dwordx4 v2, s[24:27], s14 offen sc1 lds
  buffer_load_dwordx4 v2, s[24:27], s14 offen offset:1024 sc1 lds
  s_waitcnt vmcnt(3)
  s_barrier
  s_waitcnt vmcnt(0)
  s_barrier
  s_lshl_b32 s35, s11, 4
  s_add_u32 s35, s35, s12
  s_and_b32 s3, s2, 7
  s_lshr_b32 s13, s2, 3
  s_lshl_b32 s14, s3, 2
  s_and_b32 s15, s13, 3
  s_add_u32 s11, s14, s15
  s_lshr_b32 s12, s13, 2
  s_and_b32 s28, s31, 1
  s_lshr_b32 s29, s31, 1
  s_lshl_b32 s9, s11, 6
  s_lshl_b32 s10, s28, 5
  s_add_u32 s30, s9, s10
  s_mul_i32 s34, s29, 1536
  v_lshrrev_b32 v2, 3, v1
  v_lshrrev_b32 v3, 4, v1
  v_and_b32 v4, 7, v1
  v_add_u32 v2, s30, v2
  s_mov_b32 s10, 3072
  v_mul_lo_u32 v2, s10, v2
  v_add_u32 v2, s34, v2
  v_xor_b32 v5, 0, v3
  v_xor_b32 v5, v5, v4
  v_lshlrev_b32 v5, 4, v5
  v_add_u32 v5, 0, v5
  v_add_u32 v8, v2, v5
  v_xor_b32 v5, 4, v3
  v_xor_b32 v5, v5, v4
  v_lshlrev_b32 v5, 4, v5
  v_add_u32 v5, 23552, v5
  v_add_u32 v9, v2, v5
  v_xor_b32 v5, 0, v3
  v_xor_b32 v5, v5, v4
  v_lshlrev_b32 v5, 4, v5
  v_add_u32 v5, 47104, v5
  v_add_u32 v10, v2, v5
  v_xor_b32 v5, 4, v3
  v_xor_b32 v5, v5, v4
  v_lshlrev_b32 v5, 4, v5
  v_add_u32 v5, 70656, v5
  v_add_u32 v11, v2, v5
  v_lshlrev_b32 v2, 4, v1
  s_mul_i32 s9, s12, 245760
  s_mul_i32 s10, s29, 122880
  s_add_u32 s9, s9, s10
  s_mul_i32 s10, s28, 5120
  s_add_u32 s9, s9, s10
  v_add_u32 v12, s9, v2
  v_add_u32 v13, 4096, v12
  s_lshl_b32 s13, s31, 12
  s_mul_i32 s15, s29, 10240
  s_mul_i32 s10, s28, 5120
  s_add_u32 s15, s15, s10
  s_add_u32 s16, s86, 16318464
  s_addc_u32 s17, s87, 0
  s_mov_b32 s18, 6291456
  s_mov_b32 s19, 0x00020000
  s_add_u32 s20, s86, 23429120
  s_addc_u32 s21, s87, 0
  s_mov_b32 s22, 1966080
  s_mov_b32 s23, 0x00020000
  s_add_u32 m0, s15, 65536
  s_mov_b32 s14, 0
  buffer_load_dwordx4 v12, s[20:23], s14 offen offset:0 sc1 lds
  buffer_load_dwordx4 v12, s[20:23], s14 offen offset:1024 sc1 lds
  buffer_load_dwordx4 v12, s[20:23], s14 offen offset:2048 sc1 lds
  buffer_load_dwordx4 v12, s[20:23], s14 offen offset:3072 sc1 lds
  s_add_u32 m0, s15, 69632
  s_nop 0
  buffer_load_dwordx4 v13, s[20:23], s14 offen sc1 lds
  s_add_u32 m0, s15, 86016
  s_mov_b32 s14, 10240
  buffer_load_dwordx4 v12, s[20:23], s14 offen offset:0 sc1 lds
  buffer_load_dwordx4 v12, s[20:23], s14 offen offset:1024 sc1 lds
  buffer_load_dwordx4 v12, s[20:23], s14 offen offset:2048 sc1 lds
  buffer_load_dwordx4 v12, s[20:23], s14 offen offset:3072 sc1 lds
  s_add_u32 m0, s15, 90112
  s_nop 0
  buffer_load_dwordx4 v13, s[20:23], s14 offen sc1 lds
  s_add_u32 m0, s15, 106496
  s_mov_b32 s14, 20480
  buffer_load_dwordx4 v12, s[20:23], s14 offen offset:0 sc1 lds
  buffer_load_dwordx4 v12, s[20:23], s14 offen offset:1024 sc1 lds
  buffer_load_dwordx4 v12, s[20:23], s14 offen offset:2048 sc1 lds
  buffer_load_dwordx4 v12, s[20:23], s14 offen offset:3072 sc1 lds
  s_add_u32 m0, s15, 110592
  s_nop 0
  buffer_load_dwordx4 v13, s[20:23], s14 offen sc1 lds
  s_barrier
  s_cmp_lg_u32 s8, 4
  s_cbranch_scc1 P6L_GO
  s_add_u32 s56, s86, 29655040
  s_addc_u32 s57, s87, 0
  s_mov_b32 s58, 229376
  s_mov_b32 s59, 0x00020000
  s_lshl_b32 s9, s35, 7
  s_add_u32 s9, s9, 163840
  v_mov_b32 v20, s9
  v_mov_b32 v21, s60
  s_mov_b64 exec, 1
  buffer_store_dword v21, v20, s[56:59], 0 offen sc1
  s_mov_b64 exec, -1
  s_add_u32 s56, s86, 29655040
  s_addc_u32 s57, s87, 0
  s_mov_b32 s58, 229376
  s_mov_b32 s59, 0x00020000
  s_lshr_b32 s9, s11, 1
  s_lshl_b32 s9, s9, 4
  v_and_b32 v20, 63, v0
  v_add_u32 v20, s9, v20
  v_lshlrev_b32 v20, 7, v20
  v_add_u32 v20, 163840, v20
  s_mov_b32 s14, 0
  s_mov_b64 exec, 0xffff
  s_waitcnt vmcnt(0)
  buffer_load_dword v226, v20, s[56:59], 0 offen sc1
P6L_G_P:
  buffer_load_dword v227, v20, s[56:59], 0 offen sc1
  s_waitcnt vmcnt(1)
  v_cmp_ne_u32 vcc, s60, v226
  s_cmp_eq_u64 vcc, 0
  s_cbranch_scc1 P6L_G_R
  buffer_load_dword v226, v20, s[56:59], 0 offen sc1
  s_waitcnt vmcnt(1)
  v_cmp_ne_u32 vcc, s60, v227
  s_cmp_eq_u64 vcc, 0
  s_cbranch_scc1 P6L_G_R
  s_add_u32 s14, s14, 1
  s_cmp_gt_u32 s14, 30000
  s_cbranch_scc0 P6L_G_P
P6L_G_R:
  s_mov_b64 exec, -1
P6L_GO:
  s_barrier
  s_add_u32 m0, s13, 0
  s_mov_b32 s14, 0
  buffer_load_dwordx4 v8, s[16:19], s14 offen offset:0 sc1 lds
  buffer_load_dwordx4 v9, s[16:19], s14 offen offset:1024 sc1 lds
  buffer_load_dwordx4 v10, s[16:19], s14 offen offset:2048 sc1 lds
  buffer_load_dwordx4 v11, s[16:19], s14 offen offset:3072 sc1 lds
  s_add_u32 m0, s13, 16384
  s_mov_b32 s14, 128
  buffer_load_dwordx4 v8, s[16:19], s14 offen offset:0 sc1 lds
  buffer_load_dwordx4 v9, s[16:19], s14 offen offset:1024 sc1 lds
  buffer_load_dwordx4 v10, s[16:19], s14 offen offset:2048 sc1 lds
  buffer_load_dwordx4 v11, s[16:19], s14 offen offset:3072 sc1 lds
  s_add_u32 m0, s13, 32768
  s_mov_b32 s14, 256
  buffer_load_dwordx4 v8, s[16:19], s14 offen offset:0 sc1 lds
  buffer_load_dwordx4 v9, s[16:19], s14 offen offset:1024 sc1 lds
  buffer_load_dwordx4 v10, s[16:19], s14 offen offset:2048 sc1 lds
  buffer_load_dwordx4 v11, s[16:19], s14 offen offset:3072 sc1 lds
  s_waitcnt vmcnt(8)
  s_barrier
  s_waitcnt vmcnt(4)
  s_barrier
  s_add_u32 m0, s13, 49152
  s_mov_b32 s14, 384
  buffer_load_dwordx4 v8, s[16:19], s14 offen offset:0 sc1 lds
  buffer_load_dwordx4 v9, s[16:19], s14 offen offset:1024 sc1 lds
  buffer_load_dwordx4 v10, s[16:19], s14 offen offset:2048 sc1 lds
  buffer_load_dwordx4 v11, s[16:19], s14 offen offset:3072 sc1 lds
  s_add_u32 m0, s15, 126976
  s_mov_b32 s14, 30720
  buffer_load_dwordx4 v12, s[20:23], s14 offen offset:0 sc1 lds
  buffer_load_dwordx4 v12, s[20:23], s14 offen offset:1024 sc1 lds
  buffer_load_dwordx4 v12, s[20:23], s14 offen offset:2048 sc1 lds
  buffer_load_dwordx4 v12, s[20:23], s14 offen offset:3072 sc1 lds
  s_add_u32 m0, s15, 131072
  s_nop 0
  buffer_load_dwordx4 v13, s[20:23], s14 offen sc1 lds
  s_waitcnt vmcnt(9)
  s_barrier
  s_add_u32 m0, s13, 0
  s_mov_b32 s14, 512
  buffer_load_dwordx4 v8, s[16:19], s14 offen offset:0 sc1 lds
  buffer_load_dwordx4 v9, s[16:19], s14 offen offset:1024 sc1 lds
  buffer_load_dwordx4 v10, s[16:19], s14 offen offset:2048 sc1 lds
  buffer_load_dwordx4 v11, s[16:19], s14 offen offset:3072 sc1 lds
  s_add_u32 m0, s15, 65536
  s_mov_b32 s14, 40960
  buffer_load_dwordx4 v12, s[20:23], s14 offen offset:0 sc1 lds
  buffer_load_dwordx4 v12, s[20:23], s14 offen offset:1024 sc1 lds
  buffer_load_dwordx4 v12, s[20:23], s14 offen offset:2048 sc1 lds
  buffer_load_dwordx4 v12, s[20:23], s14 offen offset:3072 sc1 lds
  s_add_u32 m0, s15, 69632
  s_nop 0
  buffer_load_dwordx4 v13, s[20:23], s14 offen sc1 lds
  s_add_u32 s24, s86, 13697024
  s_addc_u32 s25, s87, 0
  s_mov_b32 s26, 2621440
  s_mov_b32 s27, 0x00020000
  s_mov_b32 s36, s86
  s_mov_b32 s37, s87
  s_mov_b32 s38, 15360
  s_mov_b32 s39, 0x00020000
  v_and_b32 v16, 255, v0
  s_lshl_b32 s9, s11, 6
  s_mul_i32 s10, s12, 160
  v_add_u32 v17, 0, v16
  v_mul_u32_u24 v18, 6554, v17
  v_lshrrev_b32 v18, 16, v18
  v_mul_u32_u24 v19, 10, v18
  v_sub_u32 v19, v17, v19
  v_add_u32 v18, s9, v18
  v_mul_u32_u24 v18, 1280, v18
  v_lshl_add_u32 v18, v19, 4, v18
  v_add_u32 v18, s10, v18
  s_lshl_b32 s14, s31, 10
  s_add_u32 m0, s14, 147456
  s_nop 0
  buffer_load_dwordx4 v18, s[24:27], 0 offen sc1 lds
  v_add_u32 v17, 256, v16
  v_mul_u32_u24 v18, 6554, v17
  v_lshrrev_b32 v18, 16, v18
  v_mul_u32_u24 v19, 10, v18
  v_sub_u32 v19, v17, v19
  v_add_u32 v18, s9, v18
  v_mul_u32_u24 v18, 1280, v18
  v_lshl_add_u32 v18, v19, 4, v18
  v_add_u32 v18, s10, v18
  s_lshl_b32 s14, s31, 10
  s_add_u32 m0, s14, 151552
  s_nop 0
  buffer_load_dwordx4 v18, s[24:27], 0 offen sc1 lds
  v_add_u32 v17, 512, v16
  v_mul_u32_u24 v18, 6554, v17
  v_lshrrev_b32 v18, 16, v18
  v_mul_u32_u24 v19, 10, v18
  v_sub_u32 v19, v17, v19
  v_add_u32 v18, s9, v18
  v_mul_u32_u24 v18, 1280, v18
  v_lshl_add_u32 v18, v19, 4, v18
  v_add_u32 v18, s10, v18
  v_cmp_gt_u32 vcc, 640, v17
  v_mov_b32 v19, 0x7ffffff0
  s_nop 0
  v_cndmask_b32 v18, v19, v18, vcc
  s_lshl_b32 s14, s31, 10
  s_add_u32 m0, s14, 155648
  s_cmp_ge_u32 s31, 2
  s_cbranch_scc1 NRD_SKIP5
  buffer_load_dwordx4 v18, s[24:27], 0 offen sc1 lds
NRD_SKIP5:
  s_cmp_lg_u32 s31, 3
  s_cbranch_scc1 NRD_NG5
  v_lshlrev_b32 v18, 4, v1
  s_mul_i32 s14, s12, 320
  s_add_u32 s14, s14, 12800
  s_mov_b32 m0, 157696
  s_mov_b32 exec_lo, 0xfffff
  s_mov_b32 exec_hi, 0
  buffer_load_dwordx4 v18, s[36:39], s14 offen sc1 lds
  s_mov_b64 exec, -1
NRD_NG5:
  s_waitcnt vmcnt(9)
  s_barrier
  s_add_u32 m0, s13, 16384
  s_mov_b32 s14, 640
  buffer_load_dwordx4 v8, s[16:19], s14 offen offset:0 sc1 lds
  buffer_load_dwordx4 v9, s[16:19], s14 offen offset:1024 sc1 lds
  buffer_load_dwordx4 v10, s[16:19], s14 offen offset:2048 sc1 lds
  buffer_load_dwordx4 v11, s[16:19], s14 offen offset:3072 sc1 lds
  s_add_u32 m0, s15, 86016
  s_mov_b32 s14, 51200
  buffer_load_dwordx4 v12, s[20:23], s14 offen offset:0 sc1 lds
  buffer_load_dwordx4 v12, s[20:23], s14 offen offset:1024 sc1 lds
  buffer_load_dwordx4 v12, s[20:23], s14 offen offset:2048 sc1 lds
  buffer_load_dwordx4 v12, s[20:23], s14 offen offset:3072 sc1 lds
  s_add_u32 m0, s15, 90112
  s_nop 0
  buffer_load_dwordx4 v13, s[20:23], s14 offen sc1 lds
  s_waitcnt vmcnt(9)
  s_barrier
  s_add_u32 m0, s13, 32768
  s_mov_b32 s14, 768
  buffer_load_dwordx4 v8, s[16:19], s14 offen offset:0 sc1 lds
  buffer_load_dwordx4 v9, s[16:19], s14 offen offset:1024 sc1 lds
  buffer_load_dwordx4 v10, s[16:19], s14 offen offset:2048 sc1 lds
  buffer_load_dwordx4 v11, s[16:19], s14 offen offset:3072 sc1 lds
  s_add_u32 m0, s15, 106496
  s_mov_b32 s14, 61440
  buffer_load_dwordx4 v12, s[20:23], s14 offen offset:0 sc1 lds
  buffer_load_dwordx4 v12, s[20:23], s14 offen offset:1024 sc1 lds
  buffer_load_dwordx4 v12, s[20:23], s14 offen offset:2048 sc1 lds
  buffer_load_dwordx4 v12, s[20:23], s14 offen offset:3072 sc1 lds
  s_add_u32 m0, s15, 110592
  s_nop 0
  buffer_load_dwordx4 v13, s[20:23], s14 offen sc1 lds
  s_waitcnt vmcnt(9)
  s_barrier
  s_add_u32 m0, s13, 49152
  s_mov_b32 s14, 896
  buffer_load_dwordx4 v8, s[16:19], s14 offen offset:0 sc1 lds
  buffer_load_dwordx4 v9, s[16:19], s14 offen offset:1024 sc1 lds
  buffer_load_dwordx4 v10, s[16:19], s14 offen offset:2048 sc1 lds
  buffer_load_dwordx4 v11, s[16:19], s14 offen offset:3072 sc1 lds
  s_add_u32 m0, s15, 126976
  s_mov_b32 s14, 71680
  buffer_load_dwordx4 v12, s[20:23], s14 offen offset:0 sc1 lds
  buffer_load_dwordx4 v12, s[20:23], s14 offen offset:1024 sc1 lds
  buffer_load_dwordx4 v12, s[20:23], s14 offen offset:2048 sc1 lds
  buffer_load_dwordx4 v12, s[20:23], s14 offen offset:3072 sc1 lds
  s_add_u32 m0, s15, 131072
  s_nop 0
  buffer_load_dwordx4 v13, s[20:23], s14 offen sc1 lds
  s_waitcnt vmcnt(9)
  s_barrier
  s_add_u32 m0, s13, 0
  s_mov_b32 s14, 1024
  buffer_load_dwordx4 v8, s[16:19], s14 offen offset:0 sc1 lds
  buffer_load_dwordx4 v9, s[16:19], s14 offen offset:1024 sc1 lds
  buffer_load_dwordx4 v10, s[16:19], s14 offen offset:2048 sc1 lds
  buffer_load_dwordx4 v11, s[16:19], s14 offen offset:3072 sc1 lds
  s_add_u32 m0, s15, 65536
  s_mov_b32 s14, 81920
  buffer_load_dwordx4 v12, s[20:23], s14 offen offset:0 sc1 lds
  buffer_load_dwordx4 v12, s[20:23], s14 offen offset:1024 sc1 lds
  buffer_load_dwordx4 v12, s[20:23], s14 offen offset:2048 sc1 lds
  buffer_load_dwordx4 v12, s[20:23], s14 offen offset:3072 sc1 lds
  s_add_u32 m0, s15, 69632
  s_nop 0
  buffer_load_dwordx4 v13, s[20:23], s14 offen sc1 lds
  s_waitcnt vmcnt(9)
  s_barrier
  s_add_u32 m0, s13, 16384
  s_mov_b32 s14, 1152
  buffer_load_dwordx4 v8, s[16:19], s14 offen offset:0 sc1 lds
  buffer_load_dwordx4 v9, s[16:19], s14 offen offset:1024 sc1 lds
  buffer_load_dwordx4 v10, s[16:19], s14 offen offset:2048 sc1 lds
  buffer_load_dwordx4 v11, s[16:19], s14 offen offset:3072 sc1 lds
  s_add_u32 m0, s15, 86016
  s_mov_b32 s14, 92160
  buffer_load_dwordx4 v12, s[20:23], s14 offen offset:0 sc1 lds
  buffer_load_dwordx4 v12, s[20:23], s14 offen offset:1024 sc1 lds
  buffer_load_dwordx4 v12, s[20:23], s14 offen offset:2048 sc1 lds
  buffer_load_dwordx4 v12, s[20:23], s14 offen offset:3072 sc1 lds
  s_add_u32 m0, s15, 90112
  s_nop 0
  buffer_load_dwordx4 v13, s[20:23], s14 offen sc1 lds
  s_waitcnt vmcnt(9)
  s_barrier
  s_add_u32 m0, s13, 32768
  s_mov_b32 s14, 1280
  buffer_load_dwordx4 v8, s[16:19], s14 offen offset:0 sc1 lds
  buffer_load_dwordx4 v9, s[16:19], s14 offen offset:1024 sc1 lds
  buffer_load_dwordx4 v10, s[16:19], s14 offen offset:2048 sc1 lds
  buffer_load_dwordx4 v11, s[16:19], s14 offen offset:3072 sc1 lds
  s_add_u32 m0, s15, 106496
  s_mov_b32 s14, 102400
  buffer_load_dwordx4 v12, s[20:23], s14 offen offset:0 sc1 lds
  buffer_load_dwordx4 v12, s[20:23], s14 offen offset:1024 sc1 lds
  buffer_load_dwordx4 v12, s[20:23], s14 offen offset:2048 sc1 lds
  buffer_load_dwordx4 v12, s[20:23], s14 offen offset:3072 sc1 lds
  s_add_u32 m0, s15, 110592
  s_nop 0
  buffer_load_dwordx4 v13, s[20:23], s14 offen sc1 lds
  s_waitcnt vmcnt(9)
  s_barrier
  s_add_u32 m0, s13, 49152
  s_mov_b32 s14, 1408
  buffer_load_dwordx4 v8, s[16:19], s14 offen offset:0 sc1 lds
  buffer_load_dwordx4 v9, s[16:19], s14 offen offset:1024 sc1 lds
  buffer_load_dwordx4 v10, s[16:19], s14 offen offset:2048 sc1 lds
  buffer_load_dwordx4 v11, s[16:19], s14 offen offset:3072 sc1 lds
  s_add_u32 m0, s15, 126976
  s_mov_b32 s14, 112640
  buffer_load_dwordx4 v12, s[20:23], s14 offen offset:0 sc1 lds
  buffer_load_dwordx4 v12, s[20:23], s14 offen offset:1024 sc1 lds
  buffer_load_dwordx4 v12, s[20:23], s14 offen offset:2048 sc1 lds
  buffer_load_dwordx4 v12, s[20:23], s14 offen offset:3072 sc1 lds
  s_add_u32 m0, s15, 131072
  s_nop 0
  buffer_load_dwordx4 v13, s[20:23], s14 offen sc1 lds
  s_waitcnt vmcnt(9)
  s_barrier
  s_waitcnt vmcnt(0)
  s_barrier
  s_barrier
  s_branch F_END
P4_COMPUTE:
  v_and_b32 v2, 15, v1
  v_lshrrev_b32 v3, 4, v1
  v_lshrrev_b32 v10, 1, v2
  v_lshlrev_b32 v2, 7, v2
  s_lshl_b32 s13, s8, 12
  v_add_u32 v2, s13, v2
  v_bfe_u32 v10, v1, 2, 2
  v_lshl_add_u32 v2, v3, 3, v10
  v_lshlrev_b32 v2, 7, v2
  v_and_b32 v11, 3, v1
  v_lshl_add_u32 v2, v11, 3, v2
  s_lshl_b32 s9, s29, 13
  v_add_u32 v2, s9, v2
  v_lshrrev_b32 v10, 1, v10
  v_and_b32 v11, 1, v3
  v_lshl_or_b32 v10, v11, 1, v10
  s_lshl_b32 s9, s28, 1
  s_add_u32 s9, s9, 0
  v_xor_b32 v11, s9, v10
  v_lshl_add_u32 v4, v11, 5, v2
  s_lshl_b32 s9, s28, 1
  s_add_u32 s9, s9, 1
  v_xor_b32 v11, s9, v10
  v_lshl_add_u32 v5, v11, 5, v2
  v_lshrrev_b32 v2, 5, v1
  v_lshlrev_b32 v2, 4, v2
  v_bfe_u32 v10, v1, 4, 1
  v_lshl_add_u32 v2, v10, 2, v2
  v_bfe_u32 v10, v1, 2, 2
  v_add_u32 v2, v2, v10
  v_mul_u32_u24 v2, 160, v2
  v_and_b32 v10, 3, v1
  v_lshl_add_u32 v2, v10, 3, v2
  s_mul_i32 s10, s29, 10240
  s_add_u32 s10, s10, 65536
  v_add_u32 v6, s10, v2
  v_add_u32 v7, 40960, v6
  v_and_b32 v2, 15, v1
  s_lshl_b32 s10, s29, 4
  s_add_u32 s10, s10, s30
  v_add_u32 v2, s10, v2
  v_mul_u32_u24 v8, 1280, v2
  s_mul_i32 s10, s12, 160
  v_lshl_add_u32 v8, v3, 3, v8
  v_add_u32 v8, s10, v8
  s_mul_i32 s10, s12, 320
  v_lshlrev_b32 v9, 4, v3
  v_add_u32 v9, s10, v9
  s_add_u32 s32, s86, 13697024
  s_addc_u32 s33, s87, 0
  s_mov_b32 s34, 2621440
  s_mov_b32 s35, 0x00020000
  v_lshlrev_b32 v10, 4, v1
  s_mul_i32 s9, s8, 5120
  s_add_u32 s9, s9, 16384
  v_add_u32 v151, s9, v10
  s_xor_b32 s10, s8, 2
  s_mul_i32 s10, s10, 5120
  s_add_u32 s10, s10, 16384
  v_add_u32 v152, s10, v10
  v_and_b32 v10, 15, v1
  s_lshl_b32 s10, s29, 4
  s_lshl_b32 s9, s28, 5
  s_add_u32 s10, s10, s9
  v_add_u32 v11, s10, v10
  v_mul_u32_u24 v11, 160, v11
  v_lshrrev_b32 v140, 4, v1
  v_lshl_add_u32 v11, v140, 3, v11
  v_add_u32 v153, 147456, v11
  v_lshlrev_b32 v140, 4, v140
  v_add_u32 v154, 157696, v140
  s_lshl_b32 s10, s29, 4
  s_lshl_b32 s9, s28, 5
  s_add_u32 s10, s10, s9
  v_add_u32 v11, s10, v10
  v_lshlrev_b32 v155, 3, v11
  s_lshl_b32 s9, s11, 12
  s_lshl_b32 s10, s12, 9
  s_add_u32 s9, s9, s10
  v_add_u32 v155, s9, v155
  s_mul_i32 s9, s8, 3072
  s_add_u32 s9, s9, 36864
  s_lshl_b32 s10, s29, 4
  s_add_u32 s10, s10, s30
  s_mul_i32 s40, s12, 160
  v_add_u32 v10, 0, v1
  v_mul_u32_u24 v11, 6554, v10
  v_lshrrev_b32 v11, 16, v11
  v_mul_u32_u24 v140, 10, v11
  v_sub_u32 v140, v10, v140
  v_lshlrev_b32 v140, 4, v140
  v_mul_u32_u24 v141, 176, v11
  v_add3_u32 v144, v141, v140, s9
  v_add_u32 v11, s10, v11
  v_mul_u32_u24 v11, 1280, v11
  v_add3_u32 v148, v11, v140, s40
  v_add_u32 v10, 64, v1
  v_mul_u32_u24 v11, 6554, v10
  v_lshrrev_b32 v11, 16, v11
  v_mul_u32_u24 v140, 10, v11
  v_sub_u32 v140, v10, v140
  v_lshlrev_b32 v140, 4, v140
  v_mul_u32_u24 v141, 176, v11
  v_add3_u32 v145, v141, v140, s9
  v_add_u32 v11, s10, v11
  v_mul_u32_u24 v11, 1280, v11
  v_add3_u32 v149, v11, v140, s40
  v_add_u32 v10, 128, v1
  v_mul_u32_u24 v11, 6554, v10
  v_lshrrev_b32 v11, 16, v11
  v_mul_u32_u24 v140, 10, v11
  v_sub_u32 v140, v10, v140
  v_lshlrev_b32 v140, 4, v140
  v_mul_u32_u24 v141, 176, v11
  v_add3_u32 v146, v141, v140, s9
  v_add_u32 v11, s10, v11
  v_mul_u32_u24 v11, 1280, v11
  v_add3_u32 v150, v11, v140, s40
  v_cmp_gt_u32 vcc, 32, v1
  v_mov_b32 v10, 0x7ffffff0
  s_nop 0
  v_cndmask_b32 v150, v10, v150, vcc
  v_and_b32 v10, 15, v1
  v_mul_u32_u24 v10, 176, v10
  v_lshrrev_b32 v11, 4, v1
  v_lshlrev_b32 v11, 3, v11
  v_add3_u32 v147, v10, v11, s9
  s_barrier
  s_barrier
  ds_read_b64_tr_b16 v[12:13], v4 offset:0
  ds_read_b64_tr_b16 v[14:15], v4 offset:512
  ds_read_b64_tr_b16 v[16:17], v5 offset:0
  ds_read_b64_tr_b16 v[18:19], v5 offset:512
  ds_read_b64_tr_b16 v[28:29], v6 offset:0
  ds_read_b64_tr_b16 v[30:31], v6 offset:1280
  ds_read_b64_tr_b16 v[32:33], v6 offset:32
  ds_read_b64_tr_b16 v[34:35], v6 offset:1312
  ds_read_b64_tr_b16 v[36:37], v6 offset:64
  ds_read_b64_tr_b16 v[38:39], v6 offset:1344
  ds_read_b64_tr_b16 v[40:41], v6 offset:96
  ds_read_b64_tr_b16 v[42:43], v6 offset:1376
  ds_read_b64_tr_b16 v[44:45], v6 offset:128
  ds_read_b64_tr_b16 v[46:47], v6 offset:1408
  s_waitcnt lgkmcnt(8)
  v_mfma_f32_16x16x32_bf16 v[68:71], v[28:31], v[12:15], 0
  v_mfma_f32_16x16x32_bf16 v[72:75], v[28:31], v[16:19], 0
  ds_read_b64_tr_b16 v[20:21], v4 offset:4096
  ds_read_b64_tr_b16 v[22:23], v4 offset:4608
  ds_read_b64_tr_b16 v[24:25], v5 offset:4096
  ds_read_b64_tr_b16 v[26:27], v5 offset:4608
  ds_read_b64_tr_b16 v[48:49], v6 offset:5120
  ds_read_b64_tr_b16 v[50:51], v6 offset:6400
  s_waitcnt lgkmcnt(12)
  v_mfma_f32_16x16x32_bf16 v[76:79], v[32:35], v[12:15], 0
  v_mfma_f32_16x16x32_bf16 v[80:83], v[32:35], v[16:19], 0
  ds_read_b64_tr_b16 v[52:53], v6 offset:5152
  ds_read_b64_tr_b16 v[54:55], v6 offset:6432
  s_waitcnt lgkmcnt(12)
  v_mfma_f32_16x16x32_bf16 v[84:87], v[36:39], v[12:15], 0
  v_mfma_f32_16x16x32_bf16 v[88:91], v[36:39], v[16:19], 0
  ds_read_b64_tr_b16 v[56:57], v6 offset:5184
  ds_read_b64_tr_b16 v[58:59], v6 offset:6464
  s_waitcnt lgkmcnt(12)
  v_mfma_f32_16x16x32_bf16 v[92:95], v[40:43], v[12:15], 0
  v_mfma_f32_16x16x32_bf16 v[96:99], v[40:43], v[16:19], 0
  ds_read_b64_tr_b16 v[60:61], v6 offset:5216
  ds_read_b64_tr_b16 v[62:63], v6 offset:6496
  s_waitcnt lgkmcnt(12)
  v_mfma_f32_16x16x32_bf16 v[100:103], v[44:47], v[12:15], 0
  v_mfma_f32_16x16x32_bf16 v[104:107], v[44:47], v[16:19], 0
  ds_read_b64_tr_b16 v[64:65], v6 offset:5248
  ds_read_b64_tr_b16 v[66:67], v6 offset:6528
  s_barrier
  s_waitcnt lgkmcnt(8)
  v_mfma_f32_16x16x32_bf16 v[68:71], v[48:51], v[20:23], v[68:71]
  v_mfma_f32_16x16x32_bf16 v[72:75], v[48:51], v[24:27], v[72:75]
  ds_read_b64_tr_b16 v[12:13], v4 offset:16384
  ds_read_b64_tr_b16 v[14:15], v4 offset:16896
  ds_read_b64_tr_b16 v[16:17], v5 offset:16384
  ds_read_b64_tr_b16 v[18:19], v5 offset:16896
  ds_read_b64_tr_b16 v[28:29], v6 offset:20480
  ds_read_b64_tr_b16 v[30:31], v6 offset:21760
  s_waitcnt lgkmcnt(12)
  v_mfma_f32_16x16x32_bf16 v[76:79], v[52:55], v[20:23], v[76:79]
  v_mfma_f32_16x16x32_bf16 v[80:83], v[52:55], v[24:27], v[80:83]
  ds_read_b64_tr_b16 v[32:33], v6 offset:20512
  ds_read_b64_tr_b16 v[34:35], v6 offset:21792
  s_waitcnt lgkmcnt(12)
  v_mfma_f32_16x16x32_bf16 v[84:87], v[56:59], v[20:23], v[84:87]
  v_mfma_f32_16x16x32_bf16 v[88:91], v[56:59], v[24:27], v[88:91]
  ds_read_b64_tr_b16 v[36:37], v6 offset:20544
  ds_read_b64_tr_b16 v[38:39], v6 offset:21824
  s_waitcnt lgkmcnt(12)
  v_mfma_f32_16x16x32_bf16 v[92:95], v[60:63], v[20:23], v[92:95]
  v_mfma_f32_16x16x32_bf16 v[96:99], v[60:63], v[24:27], v[96:99]
  ds_read_b64_tr_b16 v[40:41], v6 offset:20576
  ds_read_b64_tr_b16 v[42:43], v6 offset:21856
  s_waitcnt lgkmcnt(12)
  v_mfma_f32_16x16x32_bf16 v[100:103], v[64:67], v[20:23], v[100:103]
  v_mfma_f32_16x16x32_bf16 v[104:107], v[64:67], v[24:27], v[104:107]
  ds_read_b64_tr_b16 v[44:45], v6 offset:20608
  ds_read_b64_tr_b16 v[46:47], v6 offset:21888
  s_waitcnt lgkmcnt(8)
  v_mfma_f32_16x16x32_bf16 v[68:71], v[28:31], v[12:15], v[68:71]
  v_mfma_f32_16x16x32_bf16 v[72:75], v[28:31], v[16:19], v[72:75]
  ds_read_b64_tr_b16 v[20:21], v4 offset:20480
  ds_read_b64_tr_b16 v[22:23], v4 offset:20992
  ds_read_b64_tr_b16 v[24:25], v5 offset:20480
  ds_read_b64_tr_b16 v[26:27], v5 offset:20992
  ds_read_b64_tr_b16 v[48:49], v6 offset:25600
  ds_read_b64_tr_b16 v[50:51], v6 offset:26880
  s_waitcnt lgkmcnt(12)
  v_mfma_f32_16x16x32_bf16 v[76:79], v[32:35], v[12:15], v[76:79]
  v_mfma_f32_16x16x32_bf16 v[80:83], v[32:35], v[16:19], v[80:83]
  ds_read_b64_tr_b16 v[52:53], v6 offset:25632
  ds_read_b64_tr_b16 v[54:55], v6 offset:26912
  s_waitcnt lgkmcnt(12)
  v_mfma_f32_16x16x32_bf16 v[84:87], v[36:39], v[12:15], v[84:87]
  v_mfma_f32_16x16x32_bf16 v[88:91], v[36:39], v[16:19], v[88:91]
  ds_read_b64_tr_b16 v[56:57], v6 offset:25664
  ds_read_b64_tr_b16 v[58:59], v6 offset:26944
  s_waitcnt lgkmcnt(12)
  v_mfma_f32_16x16x32_bf16 v[92:95], v[40:43], v[12:15], v[92:95]
  v_mfma_f32_16x16x32_bf16 v[96:99], v[40:43], v[16:19], v[96:99]
  ds_read_b64_tr_b16 v[60:61], v6 offset:25696
  ds_read_b64_tr_b16 v[62:63], v6 offset:26976
  s_waitcnt lgkmcnt(12)
  v_mfma_f32_16x16x32_bf16 v[100:103], v[44:47], v[12:15], v[100:103]
  v_mfma_f32_16x16x32_bf16 v[104:107], v[44:47], v[16:19], v[104:107]
  ds_read_b64_tr_b16 v[64:65], v6 offset:25728
  ds_read_b64_tr_b16 v[66:67], v6 offset:27008
  s_barrier
  s_waitcnt lgkmcnt(8)
  v_mfma_f32_16x16x32_bf16 v[68:71], v[48:51], v[20:23], v[68:71]
  v_mfma_f32_16x16x32_bf16 v[72:75], v[48:51], v[24:27], v[72:75]
  ds_read_b64_tr_b16 v[12:13], v4 offset:32768
  ds_read_b64_tr_b16 v[14:15], v4 offset:33280
  ds_read_b64_tr_b16 v[16:17], v5 offset:32768
  ds_read_b64_tr_b16 v[18:19], v5 offset:33280
  ds_read_b64_tr_b16 v[28:29], v7 offset:0
  ds_read_b64_tr_b16 v[30:31], v7 offset:1280
  s_waitcnt lgkmcnt(12)
  v_mfma_f32_16x16x32_bf16 v[76:79], v[52:55], v[20:23], v[76:79]
  v_mfma_f32_16x16x32_bf16 v[80:83], v[52:55], v[24:27], v[80:83]
  ds_read_b64_tr_b16 v[32:33], v7 offset:32
  ds_read_b64_tr_b16 v[34:35], v7 offset:1312
  s_waitcnt lgkmcnt(12)
  v_mfma_f32_16x16x32_bf16 v[84:87], v[56:59], v[20:23], v[84:87]
  v_mfma_f32_16x16x32_bf16 v[88:91], v[56:59], v[24:27], v[88:91]
  ds_read_b64_tr_b16 v[36:37], v7 offset:64
  ds_read_b64_tr_b16 v[38:39], v7 offset:1344
  s_waitcnt lgkmcnt(12)
  v_mfma_f32_16x16x32_bf16 v[92:95], v[60:63], v[20:23], v[92:95]
  v_mfma_f32_16x16x32_bf16 v[96:99], v[60:63], v[24:27], v[96:99]
  ds_read_b64_tr_b16 v[40:41], v7 offset:96
  ds_read_b64_tr_b16 v[42:43], v7 offset:1376
  s_waitcnt lgkmcnt(12)
  v_mfma_f32_16x16x32_bf16 v[100:103], v[64:67], v[20:23], v[100:103]
  v_mfma_f32_16x16x32_bf16 v[104:107], v[64:67], v[24:27], v[104:107]
  ds_read_b64_tr_b16 v[44:45], v7 offset:128
  ds_read_b64_tr_b16 v[46:47], v7 offset:1408
  s_waitcnt lgkmcnt(8)
  v_mfma_f32_16x16x32_bf16 v[68:71], v[28:31], v[12:15], v[68:71]
  v_mfma_f32_16x16x32_bf16 v[72:75], v[28:31], v[16:19], v[72:75]
  ds_read_b64_tr_b16 v[20:21], v4 offset:36864
  ds_read_b64_tr_b16 v[22:23], v4 offset:37376
  ds_read_b64_tr_b16 v[24:25], v5 offset:36864
  ds_read_b64_tr_b16 v[26:27], v5 offset:37376
  ds_read_b64_tr_b16 v[48:49], v7 offset:5120
  ds_read_b64_tr_b16 v[50:51], v7 offset:6400
  s_waitcnt lgkmcnt(12)
  v_mfma_f32_16x16x32_bf16 v[76:79], v[32:35], v[12:15], v[76:79]
  v_mfma_f32_16x16x32_bf16 v[80:83], v[32:35], v[16:19], v[80:83]
  ds_read_b64_tr_b16 v[52:53], v7 offset:5152
  ds_read_b64_tr_b16 v[54:55], v7 offset:6432
  s_waitcnt lgkmcnt(12)
  v_mfma_f32_16x16x32_bf16 v[84:87], v[36:39], v[12:15], v[84:87]
  v_mfma_f32_16x16x32_bf16 v[88:91], v[36:39], v[16:19], v[88:91]
  ds_read_b64_tr_b16 v[56:57], v7 offset:5184
  ds_read_b64_tr_b16 v[58:59], v7 offset:6464
  s_waitcnt lgkmcnt(12)
  v_mfma_f32_16x16x32_bf16 v[92:95], v[40:43], v[12:15], v[92:95]
  v_mfma_f32_16x16x32_bf16 v[96:99], v[40:43], v[16:19], v[96:99]
  ds_read_b64_tr_b16 v[60:61], v7 offset:5216
  ds_read_b64_tr_b16 v[62:63], v7 offset:6496
  s_waitcnt lgkmcnt(12)
  v_mfma_f32_16x16x32_bf16 v[100:103], v[44:47], v[12:15], v[100:103]
  v_mfma_f32_16x16x32_bf16 v[104:107], v[44:47], v[16:19], v[104:107]
  ds_read_b64_tr_b16 v[64:65], v7 offset:5248
  ds_read_b64_tr_b16 v[66:67], v7 offset:6528
  s_barrier
  s_waitcnt lgkmcnt(8)
  v_mfma_f32_16x16x32_bf16 v[68:71], v[48:51], v[20:23], v[68:71]
  v_mfma_f32_16x16x32_bf16 v[72:75], v[48:51], v[24:27], v[72:75]
  ds_read_b64_tr_b16 v[12:13], v4 offset:49152
  ds_read_b64_tr_b16 v[14:15], v4 offset:49664
  ds_read_b64_tr_b16 v[16:17], v5 offset:49152
  ds_read_b64_tr_b16 v[18:19], v5 offset:49664
  ds_read_b64_tr_b16 v[28:29], v7 offset:20480
  ds_read_b64_tr_b16 v[30:31], v7 offset:21760
  s_waitcnt lgkmcnt(12)
  v_mfma_f32_16x16x32_bf16 v[76:79], v[52:55], v[20:23], v[76:79]
  v_mfma_f32_16x16x32_bf16 v[80:83], v[52:55], v[24:27], v[80:83]
  ds_read_b64_tr_b16 v[32:33], v7 offset:20512
  ds_read_b64_tr_b16 v[34:35], v7 offset:21792
  s_waitcnt lgkmcnt(12)
  v_mfma_f32_16x16x32_bf16 v[84:87], v[56:59], v[20:23], v[84:87]
  v_mfma_f32_16x16x32_bf16 v[88:91], v[56:59], v[24:27], v[88:91]
  ds_read_b64_tr_b16 v[36:37], v7 offset:20544
  ds_read_b64_tr_b16 v[38:39], v7 offset:21824
  s_waitcnt lgkmcnt(12)
  v_mfma_f32_16x16x32_bf16 v[92:95], v[60:63], v[20:23], v[92:95]
  v_mfma_f32_16x16x32_bf16 v[96:99], v[60:63], v[24:27], v[96:99]
  ds_read_b64_tr_b16 v[40:41], v7 offset:20576
  ds_read_b64_tr_b16 v[42:43], v7 offset:21856
  s_waitcnt lgkmcnt(12)
  v_mfma_f32_16x16x32_bf16 v[100:103], v[64:67], v[20:23], v[100:103]
  v_mfma_f32_16x16x32_bf16 v[104:107], v[64:67], v[24:27], v[104:107]
  ds_read_b64_tr_b16 v[44:45], v7 offset:20608
  ds_read_b64_tr_b16 v[46:47], v7 offset:21888
  s_waitcnt lgkmcnt(8)
  v_mfma_f32_16x16x32_bf16 v[68:71], v[28:31], v[12:15], v[68:71]
  v_mfma_f32_16x16x32_bf16 v[72:75], v[28:31], v[16:19], v[72:75]
  ds_read_b64_tr_b16 v[20:21], v4 offset:53248
  ds_read_b64_tr_b16 v[22:23], v4 offset:53760
  ds_read_b64_tr_b16 v[24:25], v5 offset:53248
  ds_read_b64_tr_b16 v[26:27], v5 offset:53760
  ds_read_b64_tr_b16 v[48:49], v7 offset:25600
  ds_read_b64_tr_b16 v[50:51], v7 offset:26880
  s_waitcnt lgkmcnt(12)
  v_mfma_f32_16x16x32_bf16 v[76:79], v[32:35], v[12:15], v[76:79]
  v_mfma_f32_16x16x32_bf16 v[80:83], v[32:35], v[16:19], v[80:83]
  ds_read_b64_tr_b16 v[52:53], v7 offset:25632
  ds_read_b64_tr_b16 v[54:55], v7 offset:26912
  s_waitcnt lgkmcnt(12)
  v_mfma_f32_16x16x32_bf16 v[84:87], v[36:39], v[12:15], v[84:87]
  v_mfma_f32_16x16x32_bf16 v[88:91], v[36:39], v[16:19], v[88:91]
  ds_read_b64_tr_b16 v[56:57], v7 offset:25664
  ds_read_b64_tr_b16 v[58:59], v7 offset:26944
  s_waitcnt lgkmcnt(12)
  v_mfma_f32_16x16x32_bf16 v[92:95], v[40:43], v[12:15], v[92:95]
  v_mfma_f32_16x16x32_bf16 v[96:99], v[40:43], v[16:19], v[96:99]
  ds_read_b64_tr_b16 v[60:61], v7 offset:25696
  ds_read_b64_tr_b16 v[62:63], v7 offset:26976
  s_waitcnt lgkmcnt(12)
  v_mfma_f32_16x16x32_bf16 v[100:103], v[44:47], v[12:15], v[100:103]
  v_mfma_f32_16x16x32_bf16 v[104:107], v[44:47], v[16:19], v[104:107]
  ds_read_b64_tr_b16 v[64:65], v7 offset:25728
  ds_read_b64_tr_b16 v[66:67], v7 offset:27008
  s_barrier
  s_waitcnt lgkmcnt(8)
  v_mfma_f32_16x16x32_bf16 v[68:71], v[48:51], v[20:23], v[68:71]
  v_mfma_f32_16x16x32_bf16 v[72:75], v[48:51], v[24:27], v[72:75]
  ds_read_b64_tr_b16 v[12:13], v4 offset:0
  ds_read_b64_tr_b16 v[14:15], v4 offset:512
  ds_read_b64_tr_b16 v[16:17], v5 offset:0
  ds_read_b64_tr_b16 v[18:19], v5 offset:512
  ds_read_b64_tr_b16 v[28:29], v6 offset:0
  ds_read_b64_tr_b16 v[30:31], v6 offset:1280
  s_waitcnt lgkmcnt(12)
  v_mfma_f32_16x16x32_bf16 v[76:79], v[52:55], v[20:23], v[76:79]
  v_mfma_f32_16x16x32_bf16 v[80:83], v[52:55], v[24:27], v[80:83]
  ds_read_b64_tr_b16 v[32:33], v6 offset:32
  ds_read_b64_tr_b16 v[34:35], v6 offset:1312
  s_waitcnt lgkmcnt(12)
  v_mfma_f32_16x16x32_bf16 v[84:87], v[56:59], v[20:23], v[84:87]
  v_mfma_f32_16x16x32_bf16 v[88:91], v[56:59], v[24:27], v[88:91]
  ds_read_b64_tr_b16 v[36:37], v6 offset:64
  ds_read_b64_tr_b16 v[38:39], v6 offset:1344
  s_waitcnt lgkmcnt(12)
  v_mfma_f32_16x16x32_bf16 v[92:95], v[60:63], v[20:23], v[92:95]
  v_mfma_f32_16x16x32_bf16 v[96:99], v[60:63], v[24:27], v[96:99]
  ds_read_b64_tr_b16 v[40:41], v6 offset:96
  ds_read_b64_tr_b16 v[42:43], v6 offset:1376
  s_waitcnt lgkmcnt(12)
  v_mfma_f32_16x16x32_bf16 v[100:103], v[64:67], v[20:23], v[100:103]
  v_mfma_f32_16x16x32_bf16 v[104:107], v[64:67], v[24:27], v[104:107]
  ds_read_b64_tr_b16 v[44:45], v6 offset:128
  ds_read_b64_tr_b16 v[46:47], v6 offset:1408
  s_waitcnt lgkmcnt(8)
  v_mfma_f32_16x16x32_bf16 v[68:71], v[28:31], v[12:15], v[68:71]
  v_mfma_f32_16x16x32_bf16 v[72:75], v[28:31], v[16:19], v[72:75]
  ds_read_b64_tr_b16 v[20:21], v4 offset:4096
  ds_read_b64_tr_b16 v[22:23], v4 offset:4608
  ds_read_b64_tr_b16 v[24:25], v5 offset:4096
  ds_read_b64_tr_b16 v[26:27], v5 offset:4608
  ds_read_b64_tr_b16 v[48:49], v6 offset:5120
  ds_read_b64_tr_b16 v[50:51], v6 offset:6400
  s_waitcnt lgkmcnt(12)
  v_mfma_f32_16x16x32_bf16 v[76:79], v[32:35], v[12:15], v[76:79]
  v_mfma_f32_16x16x32_bf16 v[80:83], v[32:35], v[16:19], v[80:83]
  ds_read_b64_tr_b16 v[52:53], v6 offset:5152
  ds_read_b64_tr_b16 v[54:55], v6 offset:6432
  s_waitcnt lgkmcnt(12)
  v_mfma_f32_16x16x32_bf16 v[84:87], v[36:39], v[12:15], v[84:87]
  v_mfma_f32_16x16x32_bf16 v[88:91], v[36:39], v[16:19], v[88:91]
  ds_read_b64_tr_b16 v[56:57], v6 offset:5184
  ds_read_b64_tr_b16 v[58:59], v6 offset:6464
  s_waitcnt lgkmcnt(12)
  v_mfma_f32_16x16x32_bf16 v[92:95], v[40:43], v[12:15], v[92:95]
  v_mfma_f32_16x16x32_bf16 v[96:99], v[40:43], v[16:19], v[96:99]
  ds_read_b64_tr_b16 v[60:61], v6 offset:5216
  ds_read_b64_tr_b16 v[62:63], v6 offset:6496
  s_waitcnt lgkmcnt(12)
  v_mfma_f32_16x16x32_bf16 v[100:103], v[44:47], v[12:15], v[100:103]
  v_mfma_f32_16x16x32_bf16 v[104:107], v[44:47], v[16:19], v[104:107]
  ds_read_b64_tr_b16 v[64:65], v6 offset:5248
  ds_read_b64_tr_b16 v[66:67], v6 offset:6528
  s_waitcnt lgkmcnt(8)
  v_mfma_f32_16x16x32_bf16 v[68:71], v[48:51], v[20:23], v[68:71]
  v_mfma_f32_16x16x32_bf16 v[72:75], v[48:51], v[24:27], v[72:75]
  s_waitcnt lgkmcnt(6)
  v_mfma_f32_16x16x32_bf16 v[76:79], v[52:55], v[20:23], v[76:79]
  v_mfma_f32_16x16x32_bf16 v[80:83], v[52:55], v[24:27], v[80:83]
  s_waitcnt lgkmcnt(4)
  v_mfma_f32_16x16x32_bf16 v[84:87], v[56:59], v[20:23], v[84:87]
  v_mfma_f32_16x16x32_bf16 v[88:91], v[56:59], v[24:27], v[88:91]
  s_waitcnt lgkmcnt(2)
  v_mfma_f32_16x16x32_bf16 v[92:95], v[60:63], v[20:23], v[92:95]
  v_mfma_f32_16x16x32_bf16 v[96:99], v[60:63], v[24:27], v[96:99]
  s_waitcnt lgkmcnt(0)
  v_mfma_f32_16x16x32_bf16 v[100:103], v[64:67], v[20:23], v[100:103]
  v_mfma_f32_16x16x32_bf16 v[104:107], v[64:67], v[24:27], v[104:107]
  s_cmp_eq_u32 s29, 0
  s_cbranch_scc1 P4C_KH0
  ds_write_b128 v151, v[68:71] offset:0
  ds_write_b128 v151, v[76:79] offset:1024
  ds_write_b128 v151, v[84:87] offset:2048
  ds_write_b128 v151, v[92:95] offset:3072
  s_nop 0
  ds_write_b128 v151, v[100:103] offset:4096
  v_pk_mov_b32 v[68:69], v[72:73], v[72:73] op_sel:[0,1]
  v_pk_mov_b32 v[70:71], v[74:75], v[74:75] op_sel:[0,1]
  v_pk_mov_b32 v[76:77], v[80:81], v[80:81] op_sel:[0,1]
  v_pk_mov_b32 v[78:79], v[82:83], v[82:83] op_sel:[0,1]
  v_pk_mov_b32 v[84:85], v[88:89], v[88:89] op_sel:[0,1]
  v_pk_mov_b32 v[86:87], v[90:91], v[90:91] op_sel:[0,1]
  v_pk_mov_b32 v[92:93], v[96:97], v[96:97] op_sel:[0,1]
  v_pk_mov_b32 v[94:95], v[98:99], v[98:99] op_sel:[0,1]
  v_pk_mov_b32 v[100:101], v[104:105], v[104:105] op_sel:[0,1]
  v_pk_mov_b32 v[102:103], v[106:107], v[106:107] op_sel:[0,1]
  s_branch P4C_JOIN
P4C_KH0:
  ds_write_b128 v151, v[72:75] offset:0
  ds_write_b128 v151, v[80:83] offset:1024
  ds_write_b128 v151, v[88:91] offset:2048
  ds_write_b128 v151, v[96:99] offset:3072
  s_nop 1
  ds_write_b128 v151, v[104:107] offset:4096
P4C_JOIN:
  ds_read_b64 v[108:109], v153 offset:0
  ds_read_b128 v[120:123], v154 offset:0
  ds_read_b64 v[110:111], v153 offset:32
  ds_read_b128 v[124:127], v154 offset:64
  ds_read_b64 v[112:113], v153 offset:64
  ds_read_b128 v[128:131], v154 offset:128
  ds_read_b64 v[114:115], v153 offset:96
  ds_read_b128 v[132:135], v154 offset:192
  ds_read_b64 v[116:117], v153 offset:128
  ds_read_b128 v[136:139], v154 offset:256
  s_waitcnt lgkmcnt(10)
  s_barrier
  ds_read_b128 v[28:31], v152 offset:0
  ds_read_b128 v[32:35], v152 offset:1024
  ds_read_b128 v[36:39], v152 offset:2048
  ds_read_b128 v[40:43], v152 offset:3072
  ds_read_b128 v[44:47], v152 offset:4096
  s_waitcnt lgkmcnt(4)
  v_pk_add_f32 v[68:69], v[68:69], v[28:29]
  v_pk_add_f32 v[70:71], v[70:71], v[30:31]
  v_lshlrev_b32 v22, 16, v108
  v_and_b32 v23, 0xffff0000, v108
  v_lshlrev_b32 v24, 16, v109
  v_and_b32 v25, 0xffff0000, v109
  v_pk_fma_f32 v[22:23], v[68:69], v[120:121], v[22:23]
  v_pk_fma_f32 v[24:25], v[70:71], v[122:123], v[24:25]
  v_cvt_pk_bf16_f32 v12, v22, v23
  v_cvt_pk_bf16_f32 v13, v24, v25
  ds_write_b64 v147, v[12:13] offset:0
  s_waitcnt lgkmcnt(4)
  v_pk_add_f32 v[76:77], v[76:77], v[32:33]
  v_pk_add_f32 v[78:79], v[78:79], v[34:35]
  v_lshlrev_b32 v22, 16, v110
  v_and_b32 v23, 0xffff0000, v110
  v_lshlrev_b32 v24, 16, v111
  v_and_b32 v25, 0xffff0000, v111
  v_pk_fma_f32 v[22:23], v[76:77], v[124:125], v[22:23]
  v_pk_fma_f32 v[24:25], v[78:79], v[126:127], v[24:25]
  v_cvt_pk_bf16_f32 v14, v22, v23
  v_cvt_pk_bf16_f32 v15, v24, v25
  ds_write_b64 v147, v[14:15] offset:32
  s_waitcnt lgkmcnt(4)
  v_pk_add_f32 v[84:85], v[84:85], v[36:37]
  v_pk_add_f32 v[86:87], v[86:87], v[38:39]
  v_lshlrev_b32 v22, 16, v112
  v_and_b32 v23, 0xffff0000, v112
  v_lshlrev_b32 v24, 16, v113
  v_and_b32 v25, 0xffff0000, v113
  v_pk_fma_f32 v[22:23], v[84:85], v[128:129], v[22:23]
  v_pk_fma_f32 v[24:25], v[86:87], v[130:131], v[24:25]
  v_cvt_pk_bf16_f32 v16, v22, v23
  v_cvt_pk_bf16_f32 v17, v24, v25
  ds_write_b64 v147, v[16:17] offset:64
  s_waitcnt lgkmcnt(4)
  v_pk_add_f32 v[92:93], v[92:93], v[40:41]
  v_pk_add_f32 v[94:95], v[94:95], v[42:43]
  v_lshlrev_b32 v22, 16, v114
  v_and_b32 v23, 0xffff0000, v114
  v_lshlrev_b32 v24, 16, v115
  v_and_b32 v25, 0xffff0000, v115
  v_pk_fma_f32 v[22:23], v[92:93], v[132:133], v[22:23]
  v_pk_fma_f32 v[24:25], v[94:95], v[134:135], v[24:25]
  v_cvt_pk_bf16_f32 v18, v22, v23
  v_cvt_pk_bf16_f32 v19, v24, v25
  ds_write_b64 v147, v[18:19] offset:96
  s_waitcnt lgkmcnt(4)
  v_pk_add_f32 v[100:101], v[100:101], v[44:45]
  v_pk_add_f32 v[102:103], v[102:103], v[46:47]
  v_lshlrev_b32 v22, 16, v116
  v_and_b32 v23, 0xffff0000, v116
  v_lshlrev_b32 v24, 16, v117
  v_and_b32 v25, 0xffff0000, v117
  v_pk_fma_f32 v[22:23], v[100:101], v[136:137], v[22:23]
  v_pk_fma_f32 v[24:25], v[102:103], v[138:139], v[24:25]
  v_cvt_pk_bf16_f32 v20, v22, v23
  v_cvt_pk_bf16_f32 v21, v24, v25
  ds_write_b64 v147, v[20:21] offset:128
  s_waitcnt lgkmcnt(0)
  ds_read_b128 v[28:31], v144
  ds_read_b128 v[32:35], v145
  ds_read_b128 v[36:39], v146
  s_waitcnt lgkmcnt(2)
  buffer_store_dwordx4 v[28:31], v148, s[32:35], 0 offen sc1
  s_waitcnt lgkmcnt(1)
  buffer_store_dwordx4 v[32:35], v149, s[32:35], 0 offen sc1
  s_waitcnt lgkmcnt(0)
  buffer_store_dwordx4 v[36:39], v150, s[32:35], 0 offen sc1
  v_lshlrev_b32 v22, 16, v12
  v_and_b32 v23, 0xffff0000, v12
  v_lshlrev_b32 v24, 16, v13
  v_and_b32 v25, 0xffff0000, v13
  v_pk_add_f32 v[26:27], v[22:23], v[24:25]
  v_pk_mul_f32 v[44:45], v[22:23], v[22:23]
  v_pk_fma_f32 v[44:45], v[24:25], v[24:25], v[44:45]
  v_lshlrev_b32 v22, 16, v14
  v_and_b32 v23, 0xffff0000, v14
  v_lshlrev_b32 v24, 16, v15
  v_and_b32 v25, 0xffff0000, v15
  v_pk_add_f32 v[26:27], v[26:27], v[22:23]
  v_pk_fma_f32 v[44:45], v[22:23], v[22:23], v[44:45]
  v_pk_add_f32 v[26:27], v[26:27], v[24:25]
  v_pk_fma_f32 v[44:45], v[24:25], v[24:25], v[44:45]
  v_lshlrev_b32 v22, 16, v16
  v_and_b32 v23, 0xffff0000, v16
  v_lshlrev_b32 v24, 16, v17
  v_and_b32 v25, 0xffff0000, v17
  v_pk_add_f32 v[26:27], v[26:27], v[22:23]
  v_pk_fma_f32 v[44:45], v[22:23], v[22:23], v[44:45]
  v_pk_add_f32 v[26:27], v[26:27], v[24:25]
  v_pk_fma_f32 v[44:45], v[24:25], v[24:25], v[44:45]
  v_lshlrev_b32 v22, 16, v18
  v_and_b32 v23, 0xffff0000, v18
  v_lshlrev_b32 v24, 16, v19
  v_and_b32 v25, 0xffff0000, v19
  v_pk_add_f32 v[26:27], v[26:27], v[22:23]
  v_pk_fma_f32 v[44:45], v[22:23], v[22:23], v[44:45]
  v_pk_add_f32 v[26:27], v[26:27], v[24:25]
  v_pk_fma_f32 v[44:45], v[24:25], v[24:25], v[44:45]
  v_lshlrev_b32 v22, 16, v20
  v_and_b32 v23, 0xffff0000, v20
  v_lshlrev_b32 v24, 16, v21
  v_and_b32 v25, 0xffff0000, v21
  v_pk_add_f32 v[26:27], v[26:27], v[22:23]
  v_pk_fma_f32 v[44:45], v[22:23], v[22:23], v[44:45]
  v_pk_add_f32 v[26:27], v[26:27], v[24:25]
  v_pk_fma_f32 v[44:45], v[24:25], v[24:25], v[44:45]
  v_add_f32 v26, v26, v27
  v_add_f32 v27, v44, v45
  v_mov_b32 v44, v26
  v_mov_b32 v45, v27
  s_nop 0
  v_permlane32_swap_b32 v26, v44
  v_permlane32_swap_b32 v27, v45
  v_add_f32 v26, v26, v44
  v_add_f32 v27, v27, v45
  v_mov_b32 v44, v26
  v_mov_b32 v45, v27
  s_nop 0
  v_permlane16_swap_b32 v26, v44
  v_permlane16_swap_b32 v27, v45
  v_add_f32 v26, v26, v44
  v_add_f32 v27, v27, v45
  s_add_u32 s24, s86, 29523968
  s_addc_u32 s25, s87, 0
  s_mov_b32 s26, 131072
  s_mov_b32 s27, 0x00020000
  s_mov_b64 exec, 0xffff
  buffer_store_dwordx2 v[26:27], v155, s[24:27], 0 offen sc1
  s_mov_b64 exec, -1
  s_waitcnt vmcnt(0)
  s_barrier
  s_and_b32 s3, s2, 7
  s_lshr_b32 s13, s2, 3
  s_and_b32 s14, s3, 1
  s_lshl_b32 s14, s14, 3
  s_and_b32 s15, s13, 7
  s_add_u32 s11, s14, s15
  s_lshr_b32 s14, s3, 1
  s_lshl_b32 s14, s14, 2
  s_lshr_b32 s15, s13, 3
  s_add_u32 s12, s14, s15
  v_and_b32 v2, 31, v1
  v_lshrrev_b32 v3, 5, v1
  v_bfe_u32 v14, v2, 1, 3
  v_lshlrev_b32 v2, 7, v2
  s_lshl_b32 s10, s8, 12
  v_add_u32 v2, s10, v2
  v_add_u32 v15, 0, v3
  v_xor_b32 v15, v15, v14
  v_lshl_add_u32 v4, v15, 4, v2
  v_add_u32 v15, 2, v3
  v_xor_b32 v15, v15, v14
  v_lshl_add_u32 v5, v15, 4, v2
  v_add_u32 v15, 4, v3
  v_xor_b32 v15, v15, v14
  v_lshl_add_u32 v6, v15, 4, v2
  v_add_u32 v15, 6, v3
  v_xor_b32 v15, v15, v14
  v_lshl_add_u32 v7, v15, 4, v2
  v_lshrrev_b32 v2, 5, v1
  v_bfe_u32 v3, v1, 2, 2
  v_lshl_add_u32 v2, v2, 3, v3
  v_mul_u32_u24 v2, 192, v2
  v_bfe_u32 v14, v1, 4, 1
  v_lshl_add_u32 v2, v14, 5, v2
  v_and_b32 v14, 3, v1
  v_lshl_add_u32 v2, v14, 3, v2
  v_add_u32 v8, 65536, v2
  v_add_u32 v9, 114688, v2
  v_and_b32 v2, 31, v1
  s_lshl_b32 s9, s11, 7
  s_lshl_b32 s10, s8, 5
  s_add_u32 s9, s9, s10
  v_add_u32 v2, s9, v2
  v_lshlrev_b32 v2, 6, v2
  s_add_u32 s44, s86, 29523968
  s_addc_u32 s45, s87, 0
  s_mov_b32 s46, 131072
  s_mov_b32 s47, 0x00020000
  s_mul_i32 s9, s8, 6656
  s_add_u32 s9, s9, 131072
  s_lshl_b32 s10, s11, 7
  s_lshl_b32 s34, s8, 5
  s_add_u32 s10, s10, s34
  s_mul_i32 s34, s12, 192
  v_add_u32 v14, 0, v1
  v_mul_u32_u24 v15, 5462, v14
  v_lshrrev_b32 v15, 16, v15
  v_mul_u32_u24 v16, 12, v15
  v_sub_u32 v16, v14, v16
  v_lshlrev_b32 v16, 4, v16
  v_mul_u32_u24 v17, 208, v15
  v_add3_u32 v200, v17, v16, s9
  v_add_u32 v15, s10, v15
  v_mul_u32_u24 v15, 3072, v15
  v_add3_u32 v206, v15, v16, s34
  v_add_u32 v14, 64, v1
  v_mul_u32_u24 v15, 5462, v14
  v_lshrrev_b32 v15, 16, v15
  v_mul_u32_u24 v16, 12, v15
  v_sub_u32 v16, v14, v16
  v_lshlrev_b32 v16, 4, v16
  v_mul_u32_u24 v17, 208, v15
  v_add3_u32 v201, v17, v16, s9
  v_add_u32 v15, s10, v15
  v_mul_u32_u24 v15, 3072, v15
  v_add3_u32 v207, v15, v16, s34
  v_add_u32 v14, 128, v1
  v_mul_u32_u24 v15, 5462, v14
  v_lshrrev_b32 v15, 16, v15
  v_mul_u32_u24 v16, 12, v15
  v_sub_u32 v16, v14, v16
  v_lshlrev_b32 v16, 4, v16
  v_mul_u32_u24 v17, 208, v15
  v_add3_u32 v202, v17, v16, s9
  v_add_u32 v15, s10, v15
  v_mul_u32_u24 v15, 3072, v15
  v_add3_u32 v208, v15, v16, s34
  v_add_u32 v14, 192, v1
  v_mul_u32_u24 v15, 5462, v14
  v_lshrrev_b32 v15, 16, v15
  v_mul_u32_u24 v16, 12, v15
  v_sub_u32 v16, v14, v16
  v_lshlrev_b32 v16, 4, v16
  v_mul_u32_u24 v17, 208, v15
  v_add3_u32 v203, v17, v16, s9
  v_add_u32 v15, s10, v15
  v_mul_u32_u24 v15, 3072, v15
  v_add3_u32 v209, v15, v16, s34
  v_add_u32 v14, 256, v1
  v_mul_u32_u24 v15, 5462, v14
  v_lshrrev_b32 v15, 16, v15
  v_mul_u32_u24 v16, 12, v15
  v_sub_u32 v16, v14, v16
  v_lshlrev_b32 v16, 4, v16
  v_mul_u32_u24 v17, 208, v15
  v_add3_u32 v204, v17, v16, s9
  v_add_u32 v15, s10, v15
  v_mul_u32_u24 v15, 3072, v15
  v_add3_u32 v210, v15, v16, s34
  v_add_u32 v14, 320, v1
  v_mul_u32_u24 v15, 5462, v14
  v_lshrrev_b32 v15, 16, v15
  v_mul_u32_u24 v16, 12, v15
  v_sub_u32 v16, v14, v16
  v_lshlrev_b32 v16, 4, v16
  v_mul_u32_u24 v17, 208, v15
  v_add3_u32 v205, v17, v16, s9
  v_add_u32 v15, s10, v15
  v_mul_u32_u24 v15, 3072, v15
  v_add3_u32 v211, v15, v16, s34
  v_and_b32 v14, 31, v1
  v_mul_u32_u24 v14, 208, v14
  v_lshrrev_b32 v15, 5, v1
  v_lshlrev_b32 v15, 4, v15
  v_add3_u32 v212, v14, v15, s9
  s_barrier
  s_barrier
  ds_read_b128 v[16:19], v4 offset:0
  ds_read_b64_tr_b16 v[24:25], v8 offset:0
  ds_read_b64_tr_b16 v[26:27], v8 offset:768
  ds_read_b64_tr_b16 v[28:29], v8 offset:64
  ds_read_b64_tr_b16 v[30:31], v8 offset:832
  ds_read_b64_tr_b16 v[32:33], v8 offset:128
  ds_read_b64_tr_b16 v[34:35], v8 offset:896
  ds_read_b64_tr_b16 v[36:37], v8 offset:12288
  ds_read_b64_tr_b16 v[38:39], v8 offset:13056
  ds_read_b64_tr_b16 v[40:41], v8 offset:12352
  ds_read_b64_tr_b16 v[42:43], v8 offset:13120
  ds_read_b64_tr_b16 v[44:45], v8 offset:12416
  ds_read_b64_tr_b16 v[46:47], v8 offset:13184
  s_waitcnt lgkmcnt(10)
  v_mfma_f32_32x32x16_bf16 v[72:87], v[24:27], v[16:19], 0
  ds_read_b128 v[20:23], v5 offset:0
  ds_read_b64_tr_b16 v[48:49], v8 offset:3072
  ds_read_b64_tr_b16 v[50:51], v8 offset:3840
  s_waitcnt lgkmcnt(11)
  v_mfma_f32_32x32x16_bf16 v[88:103], v[28:31], v[16:19], 0
  ds_read_b64_tr_b16 v[52:53], v8 offset:3136
  ds_read_b64_tr_b16 v[54:55], v8 offset:3904
  s_waitcnt lgkmcnt(11)
  v_mfma_f32_32x32x16_bf16 v[104:119], v[32:35], v[16:19], 0
  ds_read_b64_tr_b16 v[56:57], v8 offset:3200
  ds_read_b64_tr_b16 v[58:59], v8 offset:3968
  s_waitcnt lgkmcnt(11)
  v_mfma_f32_32x32x16_bf16 v[120:135], v[36:39], v[16:19], 0
  ds_read_b64_tr_b16 v[60:61], v8 offset:15360
  ds_read_b64_tr_b16 v[62:63], v8 offset:16128
  s_waitcnt lgkmcnt(11)
  v_mfma_f32_32x32x16_bf16 v[136:151], v[40:43], v[16:19], 0
  ds_read_b64_tr_b16 v[64:65], v8 offset:15424
  ds_read_b64_tr_b16 v[66:67], v8 offset:16192
  s_waitcnt lgkmcnt(11)
  v_mfma_f32_32x32x16_bf16 v[152:167], v[44:47], v[16:19], 0
  ds_read_b64_tr_b16 v[68:69], v8 offset:15488
  ds_read_b64_tr_b16 v[70:71], v8 offset:16256
  s_waitcnt lgkmcnt(10)
  v_mfma_f32_32x32x16_bf16 v[72:87], v[48:51], v[20:23], v[72:87]
  ds_read_b128 v[16:19], v6 offset:0
  ds_read_b64_tr_b16 v[24:25], v8 offset:6144
  ds_read_b64_tr_b16 v[26:27], v8 offset:6912
  s_waitcnt lgkmcnt(11)
  v_mfma_f32_32x32x16_bf16 v[88:103], v[52:55], v[20:23], v[88:103]
  ds_read_b64_tr_b16 v[28:29], v8 offset:6208
  ds_read_b64_tr_b16 v[30:31], v8 offset:6976
  s_waitcnt lgkmcnt(11)
  v_mfma_f32_32x32x16_bf16 v[104:119], v[56:59], v[20:23], v[104:119]
  ds_read_b64_tr_b16 v[32:33], v8 offset:6272
  ds_read_b64_tr_b16 v[34:35], v8 offset:7040
  s_waitcnt lgkmcnt(11)
  v_mfma_f32_32x32x16_bf16 v[120:135], v[60:63], v[20:23], v[120:135]
  ds_read_b64_tr_b16 v[36:37], v8 offset:18432
  ds_read_b64_tr_b16 v[38:39], v8 offset:19200
  s_waitcnt lgkmcnt(11)
  v_mfma_f32_32x32x16_bf16 v[136:151], v[64:67], v[20:23], v[136:151]
  ds_read_b64_tr_b16 v[40:41], v8 offset:18496
  ds_read_b64_tr_b16 v[42:43], v8 offset:19264
  s_waitcnt lgkmcnt(11)
  v_mfma_f32_32x32x16_bf16 v[152:167], v[68:71], v[20:23], v[152:167]
  ds_read_b64_tr_b16 v[44:45], v8 offset:18560
  ds_read_b64_tr_b16 v[46:47], v8 offset:19328
  s_waitcnt lgkmcnt(10)
  v_mfma_f32_32x32x16_bf16 v[72:87], v[24:27], v[16:19], v[72:87]
  ds_read_b128 v[20:23], v7 offset:0
  ds_read_b64_tr_b16 v[48:49], v8 offset:9216
  ds_read_b64_tr_b16 v[50:51], v8 offset:9984
  s_waitcnt lgkmcnt(11)
  v_mfma_f32_32x32x16_bf16 v[88:103], v[28:31], v[16:19], v[88:103]
  ds_read_b64_tr_b16 v[52:53], v8 offset:9280
  ds_read_b64_tr_b16 v[54:55], v8 offset:10048
  s_waitcnt lgkmcnt(11)
  v_mfma_f32_32x32x16_bf16 v[104:119], v[32:35], v[16:19], v[104:119]
  ds_read_b64_tr_b16 v[56:57], v8 offset:9344
  ds_read_b64_tr_b16 v[58:59], v8 offset:10112
  s_waitcnt lgkmcnt(11)
  v_mfma_f32_32x32x16_bf16 v[120:135], v[36:39], v[16:19], v[120:135]
  ds_read_b64_tr_b16 v[60:61], v8 offset:21504
  ds_read_b64_tr_b16 v[62:63], v8 offset:22272
  s_waitcnt lgkmcnt(11)
  v_mfma_f32_32x32x16_bf16 v[136:151], v[40:43], v[16:19], v[136:151]
  ds_read_b64_tr_b16 v[64:65], v8 offset:21568
  ds_read_b64_tr_b16 v[66:67], v8 offset:22336
  s_waitcnt lgkmcnt(11)
  v_mfma_f32_32x32x16_bf16 v[152:167], v[44:47], v[16:19], v[152:167]
  ds_read_b64_tr_b16 v[68:69], v8 offset:21632
  ds_read_b64_tr_b16 v[70:71], v8 offset:22400
  s_barrier
  s_waitcnt lgkmcnt(10)
  v_mfma_f32_32x32x16_bf16 v[72:87], v[48:51], v[20:23], v[72:87]
  ds_read_b128 v[16:19], v4 offset:16384
  ds_read_b64_tr_b16 v[24:25], v8 offset:24576
  ds_read_b64_tr_b16 v[26:27], v8 offset:25344
  s_waitcnt lgkmcnt(11)
  v_mfma_f32_32x32x16_bf16 v[88:103], v[52:55], v[20:23], v[88:103]
  ds_read_b64_tr_b16 v[28:29], v8 offset:24640
  ds_read_b64_tr_b16 v[30:31], v8 offset:25408
  s_waitcnt lgkmcnt(11)
  v_mfma_f32_32x32x16_bf16 v[104:119], v[56:59], v[20:23], v[104:119]
  ds_read_b64_tr_b16 v[32:33], v8 offset:24704
  ds_read_b64_tr_b16 v[34:35], v8 offset:25472
  s_waitcnt lgkmcnt(11)
  v_mfma_f32_32x32x16_bf16 v[120:135], v[60:63], v[20:23], v[120:135]
  ds_read_b64_tr_b16 v[36:37], v8 offset:36864
  ds_read_b64_tr_b16 v[38:39], v8 offset:37632
  s_waitcnt lgkmcnt(11)
  v_mfma_f32_32x32x16_bf16 v[136:151], v[64:67], v[20:23], v[136:151]
  ds_read_b64_tr_b16 v[40:41], v8 offset:36928
  ds_read_b64_tr_b16 v[42:43], v8 offset:37696
  s_waitcnt lgkmcnt(11)
  v_mfma_f32_32x32x16_bf16 v[152:167], v[68:71], v[20:23], v[152:167]
  ds_read_b64_tr_b16 v[44:45], v8 offset:36992
  ds_read_b64_tr_b16 v[46:47], v8 offset:37760
  s_waitcnt lgkmcnt(10)
  v_mfma_f32_32x32x16_bf16 v[72:87], v[24:27], v[16:19], v[72:87]
  ds_read_b128 v[20:23], v5 offset:16384
  ds_read_b64_tr_b16 v[48:49], v8 offset:27648
  ds_read_b64_tr_b16 v[50:51], v8 offset:28416
  s_waitcnt lgkmcnt(11)
  v_mfma_f32_32x32x16_bf16 v[88:103], v[28:31], v[16:19], v[88:103]
  ds_read_b64_tr_b16 v[52:53], v8 offset:27712
  ds_read_b64_tr_b16 v[54:55], v8 offset:28480
  s_waitcnt lgkmcnt(11)
  v_mfma_f32_32x32x16_bf16 v[104:119], v[32:35], v[16:19], v[104:119]
  ds_read_b64_tr_b16 v[56:57], v8 offset:27776
  ds_read_b64_tr_b16 v[58:59], v8 offset:28544
  s_waitcnt lgkmcnt(11)
  v_mfma_f32_32x32x16_bf16 v[120:135], v[36:39], v[16:19], v[120:135]
  ds_read_b64_tr_b16 v[60:61], v8 offset:39936
  ds_read_b64_tr_b16 v[62:63], v8 offset:40704
  s_waitcnt lgkmcnt(11)
  v_mfma_f32_32x32x16_bf16 v[136:151], v[40:43], v[16:19], v[136:151]
  ds_read_b64_tr_b16 v[64:65], v8 offset:40000
  ds_read_b64_tr_b16 v[66:67], v8 offset:40768
  s_waitcnt lgkmcnt(11)
  v_mfma_f32_32x32x16_bf16 v[152:167], v[44:47], v[16:19], v[152:167]
  ds_read_b64_tr_b16 v[68:69], v8 offset:40064
  ds_read_b64_tr_b16 v[70:71], v8 offset:40832
  s_waitcnt lgkmcnt(10)
  v_mfma_f32_32x32x16_bf16 v[72:87], v[48:51], v[20:23], v[72:87]
  ds_read_b128 v[16:19], v6 offset:16384
  ds_read_b64_tr_b16 v[24:25], v8 offset:30720
  ds_read_b64_tr_b16 v[26:27], v8 offset:31488
  s_waitcnt lgkmcnt(11)
  v_mfma_f32_32x32x16_bf16 v[88:103], v[52:55], v[20:23], v[88:103]
  ds_read_b64_tr_b16 v[28:29], v8 offset:30784
  ds_read_b64_tr_b16 v[30:31], v8 offset:31552
  s_waitcnt lgkmcnt(11)
  v_mfma_f32_32x32x16_bf16 v[104:119], v[56:59], v[20:23], v[104:119]
  ds_read_b64_tr_b16 v[32:33], v8 offset:30848
  ds_read_b64_tr_b16 v[34:35], v8 offset:31616
  s_waitcnt lgkmcnt(11)
  v_mfma_f32_32x32x16_bf16 v[120:135], v[60:63], v[20:23], v[120:135]
  ds_read_b64_tr_b16 v[36:37], v8 offset:43008
  ds_read_b64_tr_b16 v[38:39], v8 offset:43776
  s_waitcnt lgkmcnt(11)
  v_mfma_f32_32x32x16_bf16 v[136:151], v[64:67], v[20:23], v[136:151]
  ds_read_b64_tr_b16 v[40:41], v8 offset:43072
  ds_read_b64_tr_b16 v[42:43], v8 offset:43840
  s_waitcnt lgkmcnt(11)
  v_mfma_f32_32x32x16_bf16 v[152:167], v[68:71], v[20:23], v[152:167]
  ds_read_b64_tr_b16 v[44:45], v8 offset:43136
  ds_read_b64_tr_b16 v[46:47], v8 offset:43904
  s_waitcnt lgkmcnt(10)
  v_mfma_f32_32x32x16_bf16 v[72:87], v[24:27], v[16:19], v[72:87]
  ds_read_b128 v[20:23], v7 offset:16384
  ds_read_b64_tr_b16 v[48:49], v8 offset:33792
  ds_read_b64_tr_b16 v[50:51], v8 offset:34560
  s_waitcnt lgkmcnt(11)
  v_mfma_f32_32x32x16_bf16 v[88:103], v[28:31], v[16:19], v[88:103]
  ds_read_b64_tr_b16 v[52:53], v8 offset:33856
  ds_read_b64_tr_b16 v[54:55], v8 offset:34624
  s_waitcnt lgkmcnt(11)
  v_mfma_f32_32x32x16_bf16 v[104:119], v[32:35], v[16:19], v[104:119]
  ds_read_b64_tr_b16 v[56:57], v8 offset:33920
  ds_read_b64_tr_b16 v[58:59], v8 offset:34688
  s_waitcnt lgkmcnt(11)
  v_mfma_f32_32x32x16_bf16 v[120:135], v[36:39], v[16:19], v[120:135]
  ds_read_b64_tr_b16 v[60:61], v8 offset:46080
  ds_read_b64_tr_b16 v[62:63], v8 offset:46848
  s_waitcnt lgkmcnt(11)
  v_mfma_f32_32x32x16_bf16 v[136:151], v[40:43], v[16:19], v[136:151]
  ds_read_b64_tr_b16 v[64:65], v8 offset:46144
  ds_read_b64_tr_b16 v[66:67], v8 offset:46912
  s_waitcnt lgkmcnt(11)
  v_mfma_f32_32x32x16_bf16 v[152:167], v[44:47], v[16:19], v[152:167]
  ds_read_b64_tr_b16 v[68:69], v8 offset:46208
  ds_read_b64_tr_b16 v[70:71], v8 offset:46976
  s_barrier
  s_waitcnt lgkmcnt(10)
  v_mfma_f32_32x32x16_bf16 v[72:87], v[48:51], v[20:23], v[72:87]
  ds_read_b128 v[16:19], v4 offset:32768
  ds_read_b64_tr_b16 v[24:25], v9 offset:0
  ds_read_b64_tr_b16 v[26:27], v9 offset:768
  s_waitcnt lgkmcnt(11)
  v_mfma_f32_32x32x16_bf16 v[88:103], v[52:55], v[20:23], v[88:103]
  ds_read_b64_tr_b16 v[28:29], v9 offset:64
  ds_read_b64_tr_b16 v[30:31], v9 offset:832
  s_waitcnt lgkmcnt(11)
  v_mfma_f32_32x32x16_bf16 v[104:119], v[56:59], v[20:23], v[104:119]
  ds_read_b64_tr_b16 v[32:33], v9 offset:128
  ds_read_b64_tr_b16 v[34:35], v9 offset:896
  s_waitcnt lgkmcnt(11)
  v_mfma_f32_32x32x16_bf16 v[120:135], v[60:63], v[20:23], v[120:135]
  ds_read_b64_tr_b16 v[36:37], v9 offset:12288
  ds_read_b64_tr_b16 v[38:39], v9 offset:13056
  s_waitcnt lgkmcnt(11)
  v_mfma_f32_32x32x16_bf16 v[136:151], v[64:67], v[20:23], v[136:151]
  ds_read_b64_tr_b16 v[40:41], v9 offset:12352
  ds_read_b64_tr_b16 v[42:43], v9 offset:13120
  s_waitcnt lgkmcnt(11)
  v_mfma_f32_32x32x16_bf16 v[152:167], v[68:71], v[20:23], v[152:167]
  ds_read_b64_tr_b16 v[44:45], v9 offset:12416
  ds_read_b64_tr_b16 v[46:47], v9 offset:13184
  s_waitcnt lgkmcnt(10)
  v_mfma_f32_32x32x16_bf16 v[72:87], v[24:27], v[16:19], v[72:87]
  ds_read_b128 v[20:23], v5 offset:32768
  ds_read_b64_tr_b16 v[48:49], v9 offset:3072
  ds_read_b64_tr_b16 v[50:51], v9 offset:3840
  s_waitcnt lgkmcnt(11)
  v_mfma_f32_32x32x16_bf16 v[88:103], v[28:31], v[16:19], v[88:103]
  ds_read_b64_tr_b16 v[52:53], v9 offset:3136
  ds_read_b64_tr_b16 v[54:55], v9 offset:3904
  s_waitcnt lgkmcnt(11)
  v_mfma_f32_32x32x16_bf16 v[104:119], v[32:35], v[16:19], v[104:119]
  ds_read_b64_tr_b16 v[56:57], v9 offset:3200
  ds_read_b64_tr_b16 v[58:59], v9 offset:3968
  s_waitcnt lgkmcnt(11)
  v_mfma_f32_32x32x16_bf16 v[120:135], v[36:39], v[16:19], v[120:135]
  ds_read_b64_tr_b16 v[60:61], v9 offset:15360
  ds_read_b64_tr_b16 v[62:63], v9 offset:16128
  s_waitcnt lgkmcnt(11)
  v_mfma_f32_32x32x16_bf16 v[136:151], v[40:43], v[16:19], v[136:151]
  ds_read_b64_tr_b16 v[64:65], v9 offset:15424
  ds_read_b64_tr_b16 v[66:67], v9 offset:16192
  s_waitcnt lgkmcnt(11)
  v_mfma_f32_32x32x16_bf16 v[152:167], v[44:47], v[16:19], v[152:167]
  ds_read_b64_tr_b16 v[68:69], v9 offset:15488
  ds_read_b64_tr_b16 v[70:71], v9 offset:16256
  s_waitcnt lgkmcnt(10)
  v_mfma_f32_32x32x16_bf16 v[72:87], v[48:51], v[20:23], v[72:87]
  ds_read_b128 v[16:19], v6 offset:32768
  ds_read_b64_tr_b16 v[24:25], v9 offset:6144
  ds_read_b64_tr_b16 v[26:27], v9 offset:6912
  s_waitcnt lgkmcnt(11)
  v_mfma_f32_32x32x16_bf16 v[88:103], v[52:55], v[20:23], v[88:103]
  ds_read_b64_tr_b16 v[28:29], v9 offset:6208
  ds_read_b64_tr_b16 v[30:31], v9 offset:6976
  s_waitcnt lgkmcnt(11)
  v_mfma_f32_32x32x16_bf16 v[104:119], v[56:59], v[20:23], v[104:119]
  ds_read_b64_tr_b16 v[32:33], v9 offset:6272
  ds_read_b64_tr_b16 v[34:35], v9 offset:7040
  s_waitcnt lgkmcnt(11)
  v_mfma_f32_32x32x16_bf16 v[120:135], v[60:63], v[20:23], v[120:135]
  ds_read_b64_tr_b16 v[36:37], v9 offset:18432
  ds_read_b64_tr_b16 v[38:39], v9 offset:19200
  s_waitcnt lgkmcnt(11)
  v_mfma_f32_32x32x16_bf16 v[136:151], v[64:67], v[20:23], v[136:151]
  ds_read_b64_tr_b16 v[40:41], v9 offset:18496
  ds_read_b64_tr_b16 v[42:43], v9 offset:19264
  s_waitcnt lgkmcnt(11)
  v_mfma_f32_32x32x16_bf16 v[152:167], v[68:71], v[20:23], v[152:167]
  ds_read_b64_tr_b16 v[44:45], v9 offset:18560
  ds_read_b64_tr_b16 v[46:47], v9 offset:19328
  s_waitcnt lgkmcnt(10)
  v_mfma_f32_32x32x16_bf16 v[72:87], v[24:27], v[16:19], v[72:87]
  ds_read_b128 v[20:23], v7 offset:32768
  ds_read_b64_tr_b16 v[48:49], v9 offset:9216
  ds_read_b64_tr_b16 v[50:51], v9 offset:9984
  s_waitcnt lgkmcnt(11)
  v_mfma_f32_32x32x16_bf16 v[88:103], v[28:31], v[16:19], v[88:103]
  ds_read_b64_tr_b16 v[52:53], v9 offset:9280
  ds_read_b64_tr_b16 v[54:55], v9 offset:10048
  s_waitcnt lgkmcnt(11)
  v_mfma_f32_32x32x16_bf16 v[104:119], v[32:35], v[16:19], v[104:119]
  ds_read_b64_tr_b16 v[56:57], v9 offset:9344
  ds_read_b64_tr_b16 v[58:59], v9 offset:10112
  s_waitcnt lgkmcnt(11)
  v_mfma_f32_32x32x16_bf16 v[120:135], v[36:39], v[16:19], v[120:135]
  ds_read_b64_tr_b16 v[60:61], v9 offset:21504
  ds_read_b64_tr_b16 v[62:63], v9 offset:22272
  s_waitcnt lgkmcnt(11)
  v_mfma_f32_32x32x16_bf16 v[136:151], v[40:43], v[16:19], v[136:151]
  ds_read_b64_tr_b16 v[64:65], v9 offset:21568
  ds_read_b64_tr_b16 v[66:67], v9 offset:22336
  s_waitcnt lgkmcnt(11)
  v_mfma_f32_32x32x16_bf16 v[152:167], v[44:47], v[16:19], v[152:167]
  ds_read_b64_tr_b16 v[68:69], v9 offset:21632
  ds_read_b64_tr_b16 v[70:71], v9 offset:22400
  s_barrier
  s_waitcnt lgkmcnt(10)
  v_mfma_f32_32x32x16_bf16 v[72:87], v[48:51], v[20:23], v[72:87]
  ds_read_b128 v[16:19], v4 offset:49152
  ds_read_b64_tr_b16 v[24:25], v9 offset:24576
  ds_read_b64_tr_b16 v[26:27], v9 offset:25344
  s_waitcnt lgkmcnt(11)
  v_mfma_f32_32x32x16_bf16 v[88:103], v[52:55], v[20:23], v[88:103]
  ds_read_b64_tr_b16 v[28:29], v9 offset:24640
  ds_read_b64_tr_b16 v[30:31], v9 offset:25408
  s_waitcnt lgkmcnt(11)
  v_mfma_f32_32x32x16_bf16 v[104:119], v[56:59], v[20:23], v[104:119]
  ds_read_b64_tr_b16 v[32:33], v9 offset:24704
  ds_read_b64_tr_b16 v[34:35], v9 offset:25472
  s_waitcnt lgkmcnt(11)
  v_mfma_f32_32x32x16_bf16 v[120:135], v[60:63], v[20:23], v[120:135]
  ds_read_b64_tr_b16 v[36:37], v9 offset:36864
  ds_read_b64_tr_b16 v[38:39], v9 offset:37632
  s_waitcnt lgkmcnt(11)
  v_mfma_f32_32x32x16_bf16 v[136:151], v[64:67], v[20:23], v[136:151]
  ds_read_b64_tr_b16 v[40:41], v9 offset:36928
  ds_read_b64_tr_b16 v[42:43], v9 offset:37696
  s_waitcnt lgkmcnt(11)
  v_mfma_f32_32x32x16_bf16 v[152:167], v[68:71], v[20:23], v[152:167]
  ds_read_b64_tr_b16 v[44:45], v9 offset:36992
  ds_read_b64_tr_b16 v[46:47], v9 offset:37760
  s_waitcnt lgkmcnt(10)
  v_mfma_f32_32x32x16_bf16 v[72:87], v[24:27], v[16:19], v[72:87]
  ds_read_b128 v[20:23], v5 offset:49152
  ds_read_b64_tr_b16 v[48:49], v9 offset:27648
  ds_read_b64_tr_b16 v[50:51], v9 offset:28416
  s_waitcnt lgkmcnt(11)
  v_mfma_f32_32x32x16_bf16 v[88:103], v[28:31], v[16:19], v[88:103]
  ds_read_b64_tr_b16 v[52:53], v9 offset:27712
  ds_read_b64_tr_b16 v[54:55], v9 offset:28480
  s_waitcnt lgkmcnt(11)
  v_mfma_f32_32x32x16_bf16 v[104:119], v[32:35], v[16:19], v[104:119]
  ds_read_b64_tr_b16 v[56:57], v9 offset:27776
  ds_read_b64_tr_b16 v[58:59], v9 offset:28544
  s_waitcnt lgkmcnt(11)
  v_mfma_f32_32x32x16_bf16 v[120:135], v[36:39], v[16:19], v[120:135]
  ds_read_b64_tr_b16 v[60:61], v9 offset:39936
  ds_read_b64_tr_b16 v[62:63], v9 offset:40704
  s_waitcnt lgkmcnt(11)
  v_mfma_f32_32x32x16_bf16 v[136:151], v[40:43], v[16:19], v[136:151]
  ds_read_b64_tr_b16 v[64:65], v9 offset:40000
  ds_read_b64_tr_b16 v[66:67], v9 offset:40768
  s_waitcnt lgkmcnt(11)
  v_mfma_f32_32x32x16_bf16 v[152:167], v[44:47], v[16:19], v[152:167]
  ds_read_b64_tr_b16 v[68:69], v9 offset:40064
  ds_read_b64_tr_b16 v[70:71], v9 offset:40832
  s_waitcnt lgkmcnt(10)
  v_mfma_f32_32x32x16_bf16 v[72:87], v[48:51], v[20:23], v[72:87]
  ds_read_b128 v[16:19], v6 offset:49152
  ds_read_b64_tr_b16 v[24:25], v9 offset:30720
  ds_read_b64_tr_b16 v[26:27], v9 offset:31488
  s_waitcnt lgkmcnt(11)
  v_mfma_f32_32x32x16_bf16 v[88:103], v[52:55], v[20:23], v[88:103]
  ds_read_b64_tr_b16 v[28:29], v9 offset:30784
  ds_read_b64_tr_b16 v[30:31], v9 offset:31552
  s_waitcnt lgkmcnt(11)
  v_mfma_f32_32x32x16_bf16 v[104:119], v[56:59], v[20:23], v[104:119]
  ds_read_b64_tr_b16 v[32:33], v9 offset:30848
  ds_read_b64_tr_b16 v[34:35], v9 offset:31616
  s_waitcnt lgkmcnt(11)
  v_mfma_f32_32x32x16_bf16 v[120:135], v[60:63], v[20:23], v[120:135]
  ds_read_b64_tr_b16 v[36:37], v9 offset:43008
  ds_read_b64_tr_b16 v[38:39], v9 offset:43776
  s_waitcnt lgkmcnt(11)
  v_mfma_f32_32x32x16_bf16 v[136:151], v[64:67], v[20:23], v[136:151]
  ds_read_b64_tr_b16 v[40:41], v9 offset:43072
  ds_read_b64_tr_b16 v[42:43], v9 offset:43840
  s_waitcnt lgkmcnt(11)
  v_mfma_f32_32x32x16_bf16 v[152:167], v[68:71], v[20:23], v[152:167]
  ds_read_b64_tr_b16 v[44:45], v9 offset:43136
  ds_read_b64_tr_b16 v[46:47], v9 offset:43904
  s_waitcnt lgkmcnt(10)
  v_mfma_f32_32x32x16_bf16 v[72:87], v[24:27], v[16:19], v[72:87]
  ds_read_b128 v[20:23], v7 offset:49152
  ds_read_b64_tr_b16 v[48:49], v9 offset:33792
  ds_read_b64_tr_b16 v[50:51], v9 offset:34560
  s_waitcnt lgkmcnt(11)
  v_mfma_f32_32x32x16_bf16 v[88:103], v[28:31], v[16:19], v[88:103]
  ds_read_b64_tr_b16 v[52:53], v9 offset:33856
  ds_read_b64_tr_b16 v[54:55], v9 offset:34624
  s_waitcnt lgkmcnt(11)
  v_mfma_f32_32x32x16_bf16 v[104:119], v[32:35], v[16:19], v[104:119]
  ds_read_b64_tr_b16 v[56:57], v9 offset:33920
  ds_read_b64_tr_b16 v[58:59], v9 offset:34688
  s_waitcnt lgkmcnt(11)
  v_mfma_f32_32x32x16_bf16 v[120:135], v[36:39], v[16:19], v[120:135]
  ds_read_b64_tr_b16 v[60:61], v9 offset:46080
  ds_read_b64_tr_b16 v[62:63], v9 offset:46848
  s_waitcnt lgkmcnt(11)
  v_mfma_f32_32x32x16_bf16 v[136:151], v[40:43], v[16:19], v[136:151]
  ds_read_b64_tr_b16 v[64:65], v9 offset:46144
  ds_read_b64_tr_b16 v[66:67], v9 offset:46912
  s_waitcnt lgkmcnt(11)
  v_mfma_f32_32x32x16_bf16 v[152:167], v[44:47], v[16:19], v[152:167]
  ds_read_b64_tr_b16 v[68:69], v9 offset:46208
  ds_read_b64_tr_b16 v[70:71], v9 offset:46976
  s_barrier
  s_waitcnt lgkmcnt(10)
  v_mfma_f32_32x32x16_bf16 v[72:87], v[48:51], v[20:23], v[72:87]
  ds_read_b128 v[16:19], v4 offset:0
  ds_read_b64_tr_b16 v[24:25], v8 offset:0
  ds_read_b64_tr_b16 v[26:27], v8 offset:768
  s_waitcnt lgkmcnt(11)
  v_mfma_f32_32x32x16_bf16 v[88:103], v[52:55], v[20:23], v[88:103]
  ds_read_b64_tr_b16 v[28:29], v8 offset:64
  ds_read_b64_tr_b16 v[30:31], v8 offset:832
  s_waitcnt lgkmcnt(11)
  v_mfma_f32_32x32x16_bf16 v[104:119], v[56:59], v[20:23], v[104:119]
  ds_read_b64_tr_b16 v[32:33], v8 offset:128
  ds_read_b64_tr_b16 v[34:35], v8 offset:896
  s_waitcnt lgkmcnt(11)
  v_mfma_f32_32x32x16_bf16 v[120:135], v[60:63], v[20:23], v[120:135]
  ds_read_b64_tr_b16 v[36:37], v8 offset:12288
  ds_read_b64_tr_b16 v[38:39], v8 offset:13056
  s_waitcnt lgkmcnt(11)
  v_mfma_f32_32x32x16_bf16 v[136:151], v[64:67], v[20:23], v[136:151]
  ds_read_b64_tr_b16 v[40:41], v8 offset:12352
  ds_read_b64_tr_b16 v[42:43], v8 offset:13120
  s_waitcnt lgkmcnt(11)
  v_mfma_f32_32x32x16_bf16 v[152:167], v[68:71], v[20:23], v[152:167]
  ds_read_b64_tr_b16 v[44:45], v8 offset:12416
  ds_read_b64_tr_b16 v[46:47], v8 offset:13184
  s_waitcnt lgkmcnt(10)
  v_mfma_f32_32x32x16_bf16 v[72:87], v[24:27], v[16:19], v[72:87]
  ds_read_b128 v[20:23], v5 offset:0
  ds_read_b64_tr_b16 v[48:49], v8 offset:3072
  ds_read_b64_tr_b16 v[50:51], v8 offset:3840
  s_waitcnt lgkmcnt(11)
  v_mfma_f32_32x32x16_bf16 v[88:103], v[28:31], v[16:19], v[88:103]
  ds_read_b64_tr_b16 v[52:53], v8 offset:3136
  ds_read_b64_tr_b16 v[54:55], v8 offset:3904
  s_waitcnt lgkmcnt(11)
  v_mfma_f32_32x32x16_bf16 v[104:119], v[32:35], v[16:19], v[104:119]
  ds_read_b64_tr_b16 v[56:57], v8 offset:3200
  ds_read_b64_tr_b16 v[58:59], v8 offset:3968
  s_waitcnt lgkmcnt(11)
  v_mfma_f32_32x32x16_bf16 v[120:135], v[36:39], v[16:19], v[120:135]
  ds_read_b64_tr_b16 v[60:61], v8 offset:15360
  ds_read_b64_tr_b16 v[62:63], v8 offset:16128
  s_waitcnt lgkmcnt(11)
  v_mfma_f32_32x32x16_bf16 v[136:151], v[40:43], v[16:19], v[136:151]
  ds_read_b64_tr_b16 v[64:65], v8 offset:15424
  ds_read_b64_tr_b16 v[66:67], v8 offset:16192
  s_waitcnt lgkmcnt(11)
  v_mfma_f32_32x32x16_bf16 v[152:167], v[44:47], v[16:19], v[152:167]
  ds_read_b64_tr_b16 v[68:69], v8 offset:15488
  ds_read_b64_tr_b16 v[70:71], v8 offset:16256
  s_waitcnt lgkmcnt(10)
  v_mfma_f32_32x32x16_bf16 v[72:87], v[48:51], v[20:23], v[72:87]
  ds_read_b128 v[16:19], v6 offset:0
  ds_read_b64_tr_b16 v[24:25], v8 offset:6144
  ds_read_b64_tr_b16 v[26:27], v8 offset:6912
  s_waitcnt lgkmcnt(11)
  v_mfma_f32_32x32x16_bf16 v[88:103], v[52:55], v[20:23], v[88:103]
  ds_read_b64_tr_b16 v[28:29], v8 offset:6208
  ds_read_b64_tr_b16 v[30:31], v8 offset:6976
  s_waitcnt lgkmcnt(11)
  v_mfma_f32_32x32x16_bf16 v[104:119], v[56:59], v[20:23], v[104:119]
  ds_read_b64_tr_b16 v[32:33], v8 offset:6272
  ds_read_b64_tr_b16 v[34:35], v8 offset:7040
  s_waitcnt lgkmcnt(11)
  v_mfma_f32_32x32x16_bf16 v[120:135], v[60:63], v[20:23], v[120:135]
  ds_read_b64_tr_b16 v[36:37], v8 offset:18432
  ds_read_b64_tr_b16 v[38:39], v8 offset:19200
  s_waitcnt lgkmcnt(11)
  v_mfma_f32_32x32x16_bf16 v[136:151], v[64:67], v[20:23], v[136:151]
  ds_read_b64_tr_b16 v[40:41], v8 offset:18496
  ds_read_b64_tr_b16 v[42:43], v8 offset:19264
  s_waitcnt lgkmcnt(11)
  v_mfma_f32_32x32x16_bf16 v[152:167], v[68:71], v[20:23], v[152:167]
  ds_read_b64_tr_b16 v[44:45], v8 offset:18560
  ds_read_b64_tr_b16 v[46:47], v8 offset:19328
  s_waitcnt lgkmcnt(10)
  v_mfma_f32_32x32x16_bf16 v[72:87], v[24:27], v[16:19], v[72:87]
  ds_read_b128 v[20:23], v7 offset:0
  ds_read_b64_tr_b16 v[48:49], v8 offset:9216
  ds_read_b64_tr_b16 v[50:51], v8 offset:9984
  s_waitcnt lgkmcnt(11)
  v_mfma_f32_32x32x16_bf16 v[88:103], v[28:31], v[16:19], v[88:103]
  ds_read_b64_tr_b16 v[52:53], v8 offset:9280
  ds_read_b64_tr_b16 v[54:55], v8 offset:10048
  s_waitcnt lgkmcnt(11)
  v_mfma_f32_32x32x16_bf16 v[104:119], v[32:35], v[16:19], v[104:119]
  ds_read_b64_tr_b16 v[56:57], v8 offset:9344
  ds_read_b64_tr_b16 v[58:59], v8 offset:10112
  s_waitcnt lgkmcnt(11)
  v_mfma_f32_32x32x16_bf16 v[120:135], v[36:39], v[16:19], v[120:135]
  ds_read_b64_tr_b16 v[60:61], v8 offset:21504
  ds_read_b64_tr_b16 v[62:63], v8 offset:22272
  s_waitcnt lgkmcnt(11)
  v_mfma_f32_32x32x16_bf16 v[136:151], v[40:43], v[16:19], v[136:151]
  ds_read_b64_tr_b16 v[64:65], v8 offset:21568
  ds_read_b64_tr_b16 v[66:67], v8 offset:22336
  s_waitcnt lgkmcnt(11)
  v_mfma_f32_32x32x16_bf16 v[152:167], v[44:47], v[16:19], v[152:167]
  ds_read_b64_tr_b16 v[68:69], v8 offset:21632
  ds_read_b64_tr_b16 v[70:71], v8 offset:22400
  s_barrier
  s_waitcnt lgkmcnt(10)
  v_mfma_f32_32x32x16_bf16 v[72:87], v[48:51], v[20:23], v[72:87]
  ds_read_b128 v[16:19], v4 offset:16384
  ds_read_b64_tr_b16 v[24:25], v8 offset:24576
  ds_read_b64_tr_b16 v[26:27], v8 offset:25344
  s_waitcnt lgkmcnt(11)
  v_mfma_f32_32x32x16_bf16 v[88:103], v[52:55], v[20:23], v[88:103]
  ds_read_b64_tr_b16 v[28:29], v8 offset:24640
  ds_read_b64_tr_b16 v[30:31], v8 offset:25408
  s_waitcnt lgkmcnt(11)
  v_mfma_f32_32x32x16_bf16 v[104:119], v[56:59], v[20:23], v[104:119]
  ds_read_b64_tr_b16 v[32:33], v8 offset:24704
  ds_read_b64_tr_b16 v[34:35], v8 offset:25472
  s_waitcnt lgkmcnt(11)
  v_mfma_f32_32x32x16_bf16 v[120:135], v[60:63], v[20:23], v[120:135]
  ds_read_b64_tr_b16 v[36:37], v8 offset:36864
  ds_read_b64_tr_b16 v[38:39], v8 offset:37632
  s_waitcnt lgkmcnt(11)
  v_mfma_f32_32x32x16_bf16 v[136:151], v[64:67], v[20:23], v[136:151]
  ds_read_b64_tr_b16 v[40:41], v8 offset:36928
  ds_read_b64_tr_b16 v[42:43], v8 offset:37696
  s_waitcnt lgkmcnt(11)
  v_mfma_f32_32x32x16_bf16 v[152:167], v[68:71], v[20:23], v[152:167]
  ds_read_b64_tr_b16 v[44:45], v8 offset:36992
  ds_read_b64_tr_b16 v[46:47], v8 offset:37760
  s_waitcnt lgkmcnt(10)
  v_mfma_f32_32x32x16_bf16 v[72:87], v[24:27], v[16:19], v[72:87]
  ds_read_b128 v[20:23], v5 offset:16384
  ds_read_b64_tr_b16 v[48:49], v8 offset:27648
  ds_read_b64_tr_b16 v[50:51], v8 offset:28416
  s_waitcnt lgkmcnt(11)
  v_mfma_f32_32x32x16_bf16 v[88:103], v[28:31], v[16:19], v[88:103]
  ds_read_b64_tr_b16 v[52:53], v8 offset:27712
  ds_read_b64_tr_b16 v[54:55], v8 offset:28480
  s_waitcnt lgkmcnt(11)
  v_mfma_f32_32x32x16_bf16 v[104:119], v[32:35], v[16:19], v[104:119]
  ds_read_b64_tr_b16 v[56:57], v8 offset:27776
  ds_read_b64_tr_b16 v[58:59], v8 offset:28544
  s_waitcnt lgkmcnt(11)
  v_mfma_f32_32x32x16_bf16 v[120:135], v[36:39], v[16:19], v[120:135]
  ds_read_b64_tr_b16 v[60:61], v8 offset:39936
  ds_read_b64_tr_b16 v[62:63], v8 offset:40704
  s_waitcnt lgkmcnt(11)
  v_mfma_f32_32x32x16_bf16 v[136:151], v[40:43], v[16:19], v[136:151]
  ds_read_b64_tr_b16 v[64:65], v8 offset:40000
  ds_read_b64_tr_b16 v[66:67], v8 offset:40768
  s_waitcnt lgkmcnt(11)
  v_mfma_f32_32x32x16_bf16 v[152:167], v[44:47], v[16:19], v[152:167]
  ds_read_b64_tr_b16 v[68:69], v8 offset:40064
  ds_read_b64_tr_b16 v[70:71], v8 offset:40832
  s_waitcnt lgkmcnt(10)
  v_mfma_f32_32x32x16_bf16 v[72:87], v[48:51], v[20:23], v[72:87]
  ds_read_b128 v[16:19], v6 offset:16384
  ds_read_b64_tr_b16 v[24:25], v8 offset:30720
  ds_read_b64_tr_b16 v[26:27], v8 offset:31488
  s_waitcnt lgkmcnt(11)
  v_mfma_f32_32x32x16_bf16 v[88:103], v[52:55], v[20:23], v[88:103]
  ds_read_b64_tr_b16 v[28:29], v8 offset:30784
  ds_read_b64_tr_b16 v[30:31], v8 offset:31552
  s_waitcnt lgkmcnt(11)
  v_mfma_f32_32x32x16_bf16 v[104:119], v[56:59], v[20:23], v[104:119]
  ds_read_b64_tr_b16 v[32:33], v8 offset:30848
  ds_read_b64_tr_b16 v[34:35], v8 offset:31616
  s_waitcnt lgkmcnt(11)
  v_mfma_f32_32x32x16_bf16 v[120:135], v[60:63], v[20:23], v[120:135]
  ds_read_b64_tr_b16 v[36:37], v8 offset:43008
  ds_read_b64_tr_b16 v[38:39], v8 offset:43776
  s_waitcnt lgkmcnt(11)
  v_mfma_f32_32x32x16_bf16 v[136:151], v[64:67], v[20:23], v[136:151]
  ds_read_b64_tr_b16 v[40:41], v8 offset:43072
  ds_read_b64_tr_b16 v[42:43], v8 offset:43840
  s_waitcnt lgkmcnt(11)
  v_mfma_f32_32x32x16_bf16 v[152:167], v[68:71], v[20:23], v[152:167]
  ds_read_b64_tr_b16 v[44:45], v8 offset:43136
  ds_read_b64_tr_b16 v[46:47], v8 offset:43904
  s_waitcnt lgkmcnt(10)
  v_mfma_f32_32x32x16_bf16 v[72:87], v[24:27], v[16:19], v[72:87]
  ds_read_b128 v[20:23], v7 offset:16384
  ds_read_b64_tr_b16 v[48:49], v8 offset:33792
  ds_read_b64_tr_b16 v[50:51], v8 offset:34560
  s_waitcnt lgkmcnt(11)
  v_mfma_f32_32x32x16_bf16 v[88:103], v[28:31], v[16:19], v[88:103]
  ds_read_b64_tr_b16 v[52:53], v8 offset:33856
  ds_read_b64_tr_b16 v[54:55], v8 offset:34624
  s_waitcnt lgkmcnt(11)
  v_mfma_f32_32x32x16_bf16 v[104:119], v[32:35], v[16:19], v[104:119]
  ds_read_b64_tr_b16 v[56:57], v8 offset:33920
  ds_read_b64_tr_b16 v[58:59], v8 offset:34688
  s_waitcnt lgkmcnt(11)
  v_mfma_f32_32x32x16_bf16 v[120:135], v[36:39], v[16:19], v[120:135]
  ds_read_b64_tr_b16 v[60:61], v8 offset:46080
  ds_read_b64_tr_b16 v[62:63], v8 offset:46848
  s_waitcnt lgkmcnt(11)
  v_mfma_f32_32x32x16_bf16 v[136:151], v[40:43], v[16:19], v[136:151]
  ds_read_b64_tr_b16 v[64:65], v8 offset:46144
  ds_read_b64_tr_b16 v[66:67], v8 offset:46912
  s_waitcnt lgkmcnt(11)
  v_mfma_f32_32x32x16_bf16 v[152:167], v[44:47], v[16:19], v[152:167]
  ds_read_b64_tr_b16 v[68:69], v8 offset:46208
  ds_read_b64_tr_b16 v[70:71], v8 offset:46976
  s_barrier
  s_waitcnt lgkmcnt(10)
  v_mfma_f32_32x32x16_bf16 v[72:87], v[48:51], v[20:23], v[72:87]
  ds_read_b128 v[16:19], v4 offset:32768
  ds_read_b64_tr_b16 v[24:25], v9 offset:0
  ds_read_b64_tr_b16 v[26:27], v9 offset:768
  s_waitcnt lgkmcnt(11)
  v_mfma_f32_32x32x16_bf16 v[88:103], v[52:55], v[20:23], v[88:103]
  ds_read_b64_tr_b16 v[28:29], v9 offset:64
  ds_read_b64_tr_b16 v[30:31], v9 offset:832
  s_waitcnt lgkmcnt(11)
  v_mfma_f32_32x32x16_bf16 v[104:119], v[56:59], v[20:23], v[104:119]
  ds_read_b64_tr_b16 v[32:33], v9 offset:128
  ds_read_b64_tr_b16 v[34:35], v9 offset:896
  s_waitcnt lgkmcnt(11)
  v_mfma_f32_32x32x16_bf16 v[120:135], v[60:63], v[20:23], v[120:135]
  ds_read_b64_tr_b16 v[36:37], v9 offset:12288
  ds_read_b64_tr_b16 v[38:39], v9 offset:13056
  s_waitcnt lgkmcnt(11)
  v_mfma_f32_32x32x16_bf16 v[136:151], v[64:67], v[20:23], v[136:151]
  ds_read_b64_tr_b16 v[40:41], v9 offset:12352
  ds_read_b64_tr_b16 v[42:43], v9 offset:13120
  s_waitcnt lgkmcnt(11)
  v_mfma_f32_32x32x16_bf16 v[152:167], v[68:71], v[20:23], v[152:167]
  ds_read_b64_tr_b16 v[44:45], v9 offset:12416
  ds_read_b64_tr_b16 v[46:47], v9 offset:13184
  s_waitcnt lgkmcnt(10)
  v_mfma_f32_32x32x16_bf16 v[72:87], v[24:27], v[16:19], v[72:87]
  ds_read_b128 v[20:23], v5 offset:32768
  ds_read_b64_tr_b16 v[48:49], v9 offset:3072
  ds_read_b64_tr_b16 v[50:51], v9 offset:3840
  s_waitcnt lgkmcnt(11)
  v_mfma_f32_32x32x16_bf16 v[88:103], v[28:31], v[16:19], v[88:103]
  ds_read_b64_tr_b16 v[52:53], v9 offset:3136
  ds_read_b64_tr_b16 v[54:55], v9 offset:3904
  s_waitcnt lgkmcnt(11)
  v_mfma_f32_32x32x16_bf16 v[104:119], v[32:35], v[16:19], v[104:119]
  ds_read_b64_tr_b16 v[56:57], v9 offset:3200
  ds_read_b64_tr_b16 v[58:59], v9 offset:3968
  s_waitcnt lgkmcnt(11)
  v_mfma_f32_32x32x16_bf16 v[120:135], v[36:39], v[16:19], v[120:135]
  ds_read_b64_tr_b16 v[60:61], v9 offset:15360
  ds_read_b64_tr_b16 v[62:63], v9 offset:16128
  s_waitcnt lgkmcnt(11)
  v_mfma_f32_32x32x16_bf16 v[136:151], v[40:43], v[16:19], v[136:151]
  ds_read_b64_tr_b16 v[64:65], v9 offset:15424
  ds_read_b64_tr_b16 v[66:67], v9 offset:16192
  s_waitcnt lgkmcnt(11)
  v_mfma_f32_32x32x16_bf16 v[152:167], v[44:47], v[16:19], v[152:167]
  ds_read_b64_tr_b16 v[68:69], v9 offset:15488
  ds_read_b64_tr_b16 v[70:71], v9 offset:16256
  s_waitcnt lgkmcnt(10)
  v_mfma_f32_32x32x16_bf16 v[72:87], v[48:51], v[20:23], v[72:87]
  ds_read_b128 v[16:19], v6 offset:32768
  ds_read_b64_tr_b16 v[24:25], v9 offset:6144
  ds_read_b64_tr_b16 v[26:27], v9 offset:6912
  s_waitcnt lgkmcnt(11)
  v_mfma_f32_32x32x16_bf16 v[88:103], v[52:55], v[20:23], v[88:103]
  ds_read_b64_tr_b16 v[28:29], v9 offset:6208
  ds_read_b64_tr_b16 v[30:31], v9 offset:6976
  s_waitcnt lgkmcnt(11)
  v_mfma_f32_32x32x16_bf16 v[104:119], v[56:59], v[20:23], v[104:119]
  ds_read_b64_tr_b16 v[32:33], v9 offset:6272
  ds_read_b64_tr_b16 v[34:35], v9 offset:7040
  s_waitcnt lgkmcnt(11)
  v_mfma_f32_32x32x16_bf16 v[120:135], v[60:63], v[20:23], v[120:135]
  ds_read_b64_tr_b16 v[36:37], v9 offset:18432
  ds_read_b64_tr_b16 v[38:39], v9 offset:19200
  s_waitcnt lgkmcnt(11)
  v_mfma_f32_32x32x16_bf16 v[136:151], v[64:67], v[20:23], v[136:151]
  ds_read_b64_tr_b16 v[40:41], v9 offset:18496
  ds_read_b64_tr_b16 v[42:43], v9 offset:19264
  s_waitcnt lgkmcnt(11)
  v_mfma_f32_32x32x16_bf16 v[152:167], v[68:71], v[20:23], v[152:167]
  ds_read_b64_tr_b16 v[44:45], v9 offset:18560
  ds_read_b64_tr_b16 v[46:47], v9 offset:19328
  s_waitcnt lgkmcnt(10)
  v_mfma_f32_32x32x16_bf16 v[72:87], v[24:27], v[16:19], v[72:87]
  ds_read_b128 v[20:23], v7 offset:32768
  ds_read_b64_tr_b16 v[48:49], v9 offset:9216
  ds_read_b64_tr_b16 v[50:51], v9 offset:9984
  s_waitcnt lgkmcnt(11)
  v_mfma_f32_32x32x16_bf16 v[88:103], v[28:31], v[16:19], v[88:103]
  ds_read_b64_tr_b16 v[52:53], v9 offset:9280
  ds_read_b64_tr_b16 v[54:55], v9 offset:10048
  s_waitcnt lgkmcnt(11)
  v_mfma_f32_32x32x16_bf16 v[104:119], v[32:35], v[16:19], v[104:119]
  ds_read_b64_tr_b16 v[56:57], v9 offset:9344
  ds_read_b64_tr_b16 v[58:59], v9 offset:10112
  s_waitcnt lgkmcnt(11)
  v_mfma_f32_32x32x16_bf16 v[120:135], v[36:39], v[16:19], v[120:135]
  ds_read_b64_tr_b16 v[60:61], v9 offset:21504
  ds_read_b64_tr_b16 v[62:63], v9 offset:22272
  s_waitcnt lgkmcnt(11)
  v_mfma_f32_32x32x16_bf16 v[136:151], v[40:43], v[16:19], v[136:151]
  ds_read_b64_tr_b16 v[64:65], v9 offset:21568
  ds_read_b64_tr_b16 v[66:67], v9 offset:22336
  s_waitcnt lgkmcnt(11)
  v_mfma_f32_32x32x16_bf16 v[152:167], v[44:47], v[16:19], v[152:167]
  ds_read_b64_tr_b16 v[68:69], v9 offset:21632
  ds_read_b64_tr_b16 v[70:71], v9 offset:22400
  s_barrier
  s_waitcnt lgkmcnt(10)
  v_mfma_f32_32x32x16_bf16 v[72:87], v[48:51], v[20:23], v[72:87]
  ds_read_b128 v[16:19], v4 offset:49152
  ds_read_b64_tr_b16 v[24:25], v9 offset:24576
  ds_read_b64_tr_b16 v[26:27], v9 offset:25344
  s_waitcnt lgkmcnt(11)
  v_mfma_f32_32x32x16_bf16 v[88:103], v[52:55], v[20:23], v[88:103]
  ds_read_b64_tr_b16 v[28:29], v9 offset:24640
  ds_read_b64_tr_b16 v[30:31], v9 offset:25408
  s_waitcnt lgkmcnt(11)
  v_mfma_f32_32x32x16_bf16 v[104:119], v[56:59], v[20:23], v[104:119]
  ds_read_b64_tr_b16 v[32:33], v9 offset:24704
  ds_read_b64_tr_b16 v[34:35], v9 offset:25472
  s_waitcnt lgkmcnt(11)
  v_mfma_f32_32x32x16_bf16 v[120:135], v[60:63], v[20:23], v[120:135]
  ds_read_b64_tr_b16 v[36:37], v9 offset:36864
  ds_read_b64_tr_b16 v[38:39], v9 offset:37632
  s_waitcnt lgkmcnt(11)
  v_mfma_f32_32x32x16_bf16 v[136:151], v[64:67], v[20:23], v[136:151]
  ds_read_b64_tr_b16 v[40:41], v9 offset:36928
  ds_read_b64_tr_b16 v[42:43], v9 offset:37696
  s_waitcnt lgkmcnt(11)
  v_mfma_f32_32x32x16_bf16 v[152:167], v[68:71], v[20:23], v[152:167]
  ds_read_b64_tr_b16 v[44:45], v9 offset:36992
  ds_read_b64_tr_b16 v[46:47], v9 offset:37760
  s_waitcnt lgkmcnt(10)
  v_mfma_f32_32x32x16_bf16 v[72:87], v[24:27], v[16:19], v[72:87]
  ds_read_b128 v[20:23], v5 offset:49152
  ds_read_b64_tr_b16 v[48:49], v9 offset:27648
  ds_read_b64_tr_b16 v[50:51], v9 offset:28416
  s_waitcnt lgkmcnt(11)
  v_mfma_f32_32x32x16_bf16 v[88:103], v[28:31], v[16:19], v[88:103]
  ds_read_b64_tr_b16 v[52:53], v9 offset:27712
  ds_read_b64_tr_b16 v[54:55], v9 offset:28480
  s_waitcnt lgkmcnt(11)
  v_mfma_f32_32x32x16_bf16 v[104:119], v[32:35], v[16:19], v[104:119]
  ds_read_b64_tr_b16 v[56:57], v9 offset:27776
  ds_read_b64_tr_b16 v[58:59], v9 offset:28544
  s_waitcnt lgkmcnt(11)
  v_mfma_f32_32x32x16_bf16 v[120:135], v[36:39], v[16:19], v[120:135]
  ds_read_b64_tr_b16 v[60:61], v9 offset:39936
  ds_read_b64_tr_b16 v[62:63], v9 offset:40704
  s_waitcnt lgkmcnt(11)
  v_mfma_f32_32x32x16_bf16 v[136:151], v[40:43], v[16:19], v[136:151]
  ds_read_b64_tr_b16 v[64:65], v9 offset:40000
  ds_read_b64_tr_b16 v[66:67], v9 offset:40768
  s_waitcnt lgkmcnt(11)
  v_mfma_f32_32x32x16_bf16 v[152:167], v[44:47], v[16:19], v[152:167]
  ds_read_b64_tr_b16 v[68:69], v9 offset:40064
  ds_read_b64_tr_b16 v[70:71], v9 offset:40832
  s_waitcnt lgkmcnt(10)
  v_mfma_f32_32x32x16_bf16 v[72:87], v[48:51], v[20:23], v[72:87]
  ds_read_b128 v[16:19], v6 offset:49152
  ds_read_b64_tr_b16 v[24:25], v9 offset:30720
  ds_read_b64_tr_b16 v[26:27], v9 offset:31488
  s_waitcnt lgkmcnt(11)
  v_mfma_f32_32x32x16_bf16 v[88:103], v[52:55], v[20:23], v[88:103]
  ds_read_b64_tr_b16 v[28:29], v9 offset:30784
  ds_read_b64_tr_b16 v[30:31], v9 offset:31552
  s_waitcnt lgkmcnt(11)
  v_mfma_f32_32x32x16_bf16 v[104:119], v[56:59], v[20:23], v[104:119]
  ds_read_b64_tr_b16 v[32:33], v9 offset:30848
  ds_read_b64_tr_b16 v[34:35], v9 offset:31616
  s_waitcnt lgkmcnt(11)
  v_mfma_f32_32x32x16_bf16 v[120:135], v[60:63], v[20:23], v[120:135]
  ds_read_b64_tr_b16 v[36:37], v9 offset:43008
  ds_read_b64_tr_b16 v[38:39], v9 offset:43776
  s_waitcnt lgkmcnt(11)
  v_mfma_f32_32x32x16_bf16 v[136:151], v[64:67], v[20:23], v[136:151]
  ds_read_b64_tr_b16 v[40:41], v9 offset:43072
  ds_read_b64_tr_b16 v[42:43], v9 offset:43840
  s_waitcnt lgkmcnt(11)
  v_mfma_f32_32x32x16_bf16 v[152:167], v[68:71], v[20:23], v[152:167]
  ds_read_b64_tr_b16 v[44:45], v9 offset:43136
  ds_read_b64_tr_b16 v[46:47], v9 offset:43904
  s_waitcnt lgkmcnt(10)
  v_mfma_f32_32x32x16_bf16 v[72:87], v[24:27], v[16:19], v[72:87]
  ds_read_b128 v[20:23], v7 offset:49152
  ds_read_b64_tr_b16 v[48:49], v9 offset:33792
  ds_read_b64_tr_b16 v[50:51], v9 offset:34560
  s_waitcnt lgkmcnt(11)
  v_mfma_f32_32x32x16_bf16 v[88:103], v[28:31], v[16:19], v[88:103]
  ds_read_b64_tr_b16 v[52:53], v9 offset:33856
  ds_read_b64_tr_b16 v[54:55], v9 offset:34624
  s_waitcnt lgkmcnt(11)
  v_mfma_f32_32x32x16_bf16 v[104:119], v[32:35], v[16:19], v[104:119]
  ds_read_b64_tr_b16 v[56:57], v9 offset:33920
  ds_read_b64_tr_b16 v[58:59], v9 offset:34688
  s_waitcnt lgkmcnt(11)
  v_mfma_f32_32x32x16_bf16 v[120:135], v[36:39], v[16:19], v[120:135]
  ds_read_b64_tr_b16 v[60:61], v9 offset:46080
  ds_read_b64_tr_b16 v[62:63], v9 offset:46848
  s_waitcnt lgkmcnt(11)
  v_mfma_f32_32x32x16_bf16 v[136:151], v[40:43], v[16:19], v[136:151]
  ds_read_b64_tr_b16 v[64:65], v9 offset:46144
  ds_read_b64_tr_b16 v[66:67], v9 offset:46912
  s_waitcnt lgkmcnt(11)
  v_mfma_f32_32x32x16_bf16 v[152:167], v[44:47], v[16:19], v[152:167]
  ds_read_b64_tr_b16 v[68:69], v9 offset:46208
  ds_read_b64_tr_b16 v[70:71], v9 offset:46976
  s_barrier
  s_waitcnt lgkmcnt(10)
  v_mfma_f32_32x32x16_bf16 v[72:87], v[48:51], v[20:23], v[72:87]
  ds_read_b128 v[16:19], v4 offset:0
  ds_read_b64_tr_b16 v[24:25], v8 offset:0
  ds_read_b64_tr_b16 v[26:27], v8 offset:768
  s_waitcnt lgkmcnt(11)
  v_mfma_f32_32x32x16_bf16 v[88:103], v[52:55], v[20:23], v[88:103]
  ds_read_b64_tr_b16 v[28:29], v8 offset:64
  ds_read_b64_tr_b16 v[30:31], v8 offset:832
  s_waitcnt lgkmcnt(11)
  v_mfma_f32_32x32x16_bf16 v[104:119], v[56:59], v[20:23], v[104:119]
  ds_read_b64_tr_b16 v[32:33], v8 offset:128
  ds_read_b64_tr_b16 v[34:35], v8 offset:896
  s_waitcnt lgkmcnt(11)
  v_mfma_f32_32x32x16_bf16 v[120:135], v[60:63], v[20:23], v[120:135]
  ds_read_b64_tr_b16 v[36:37], v8 offset:12288
  ds_read_b64_tr_b16 v[38:39], v8 offset:13056
  s_waitcnt lgkmcnt(11)
  v_mfma_f32_32x32x16_bf16 v[136:151], v[64:67], v[20:23], v[136:151]
  ds_read_b64_tr_b16 v[40:41], v8 offset:12352
  ds_read_b64_tr_b16 v[42:43], v8 offset:13120
  s_waitcnt lgkmcnt(11)
  v_mfma_f32_32x32x16_bf16 v[152:167], v[68:71], v[20:23], v[152:167]
  ds_read_b64_tr_b16 v[44:45], v8 offset:12416
  ds_read_b64_tr_b16 v[46:47], v8 offset:13184
  s_waitcnt lgkmcnt(10)
  v_mfma_f32_32x32x16_bf16 v[72:87], v[24:27], v[16:19], v[72:87]
  ds_read_b128 v[20:23], v5 offset:0
  ds_read_b64_tr_b16 v[48:49], v8 offset:3072
  ds_read_b64_tr_b16 v[50:51], v8 offset:3840
  s_waitcnt lgkmcnt(11)
  v_mfma_f32_32x32x16_bf16 v[88:103], v[28:31], v[16:19], v[88:103]
  ds_read_b64_tr_b16 v[52:53], v8 offset:3136
  ds_read_b64_tr_b16 v[54:55], v8 offset:3904
  s_waitcnt lgkmcnt(11)
  v_mfma_f32_32x32x16_bf16 v[104:119], v[32:35], v[16:19], v[104:119]
  ds_read_b64_tr_b16 v[56:57], v8 offset:3200
  ds_read_b64_tr_b16 v[58:59], v8 offset:3968
  s_waitcnt lgkmcnt(11)
  v_mfma_f32_32x32x16_bf16 v[120:135], v[36:39], v[16:19], v[120:135]
  ds_read_b64_tr_b16 v[60:61], v8 offset:15360
  ds_read_b64_tr_b16 v[62:63], v8 offset:16128
  s_waitcnt lgkmcnt(11)
  v_mfma_f32_32x32x16_bf16 v[136:151], v[40:43], v[16:19], v[136:151]
  ds_read_b64_tr_b16 v[64:65], v8 offset:15424
  ds_read_b64_tr_b16 v[66:67], v8 offset:16192
  s_waitcnt lgkmcnt(11)
  v_mfma_f32_32x32x16_bf16 v[152:167], v[44:47], v[16:19], v[152:167]
  ds_read_b64_tr_b16 v[68:69], v8 offset:15488
  ds_read_b64_tr_b16 v[70:71], v8 offset:16256
  s_waitcnt lgkmcnt(10)
  v_mfma_f32_32x32x16_bf16 v[72:87], v[48:51], v[20:23], v[72:87]
  ds_read_b128 v[16:19], v6 offset:0
  ds_read_b64_tr_b16 v[24:25], v8 offset:6144
  ds_read_b64_tr_b16 v[26:27], v8 offset:6912
  s_waitcnt lgkmcnt(11)
  v_mfma_f32_32x32x16_bf16 v[88:103], v[52:55], v[20:23], v[88:103]
  ds_read_b64_tr_b16 v[28:29], v8 offset:6208
  ds_read_b64_tr_b16 v[30:31], v8 offset:6976
  s_waitcnt lgkmcnt(11)
  v_mfma_f32_32x32x16_bf16 v[104:119], v[56:59], v[20:23], v[104:119]
  ds_read_b64_tr_b16 v[32:33], v8 offset:6272
  ds_read_b64_tr_b16 v[34:35], v8 offset:7040
  s_waitcnt lgkmcnt(11)
  v_mfma_f32_32x32x16_bf16 v[120:135], v[60:63], v[20:23], v[120:135]
  ds_read_b64_tr_b16 v[36:37], v8 offset:18432
  ds_read_b64_tr_b16 v[38:39], v8 offset:19200
  s_waitcnt lgkmcnt(11)
  v_mfma_f32_32x32x16_bf16 v[136:151], v[64:67], v[20:23], v[136:151]
  ds_read_b64_tr_b16 v[40:41], v8 offset:18496
  ds_read_b64_tr_b16 v[42:43], v8 offset:19264
  s_waitcnt lgkmcnt(11)
  v_mfma_f32_32x32x16_bf16 v[152:167], v[68:71], v[20:23], v[152:167]
  ds_read_b64_tr_b16 v[44:45], v8 offset:18560
  ds_read_b64_tr_b16 v[46:47], v8 offset:19328
  s_waitcnt lgkmcnt(10)
  v_mfma_f32_32x32x16_bf16 v[72:87], v[24:27], v[16:19], v[72:87]
  ds_read_b128 v[20:23], v7 offset:0
  ds_read_b64_tr_b16 v[48:49], v8 offset:9216
  ds_read_b64_tr_b16 v[50:51], v8 offset:9984
  s_waitcnt lgkmcnt(11)
  v_mfma_f32_32x32x16_bf16 v[88:103], v[28:31], v[16:19], v[88:103]
  ds_read_b64_tr_b16 v[52:53], v8 offset:9280
  ds_read_b64_tr_b16 v[54:55], v8 offset:10048
  s_waitcnt lgkmcnt(11)
  v_mfma_f32_32x32x16_bf16 v[104:119], v[32:35], v[16:19], v[104:119]
  ds_read_b64_tr_b16 v[56:57], v8 offset:9344
  ds_read_b64_tr_b16 v[58:59], v8 offset:10112
  s_waitcnt lgkmcnt(11)
  v_mfma_f32_32x32x16_bf16 v[120:135], v[36:39], v[16:19], v[120:135]
  ds_read_b64_tr_b16 v[60:61], v8 offset:21504
  ds_read_b64_tr_b16 v[62:63], v8 offset:22272
  s_waitcnt lgkmcnt(11)
  v_mfma_f32_32x32x16_bf16 v[136:151], v[40:43], v[16:19], v[136:151]
  ds_read_b64_tr_b16 v[64:65], v8 offset:21568
  ds_read_b64_tr_b16 v[66:67], v8 offset:22336
  s_waitcnt lgkmcnt(11)
  v_mfma_f32_32x32x16_bf16 v[152:167], v[44:47], v[16:19], v[152:167]
  ds_read_b64_tr_b16 v[68:69], v8 offset:21632
  ds_read_b64_tr_b16 v[70:71], v8 offset:22400
  s_barrier
  s_waitcnt lgkmcnt(10)
  v_mfma_f32_32x32x16_bf16 v[72:87], v[48:51], v[20:23], v[72:87]
  ds_read_b128 v[16:19], v4 offset:16384
  ds_read_b64_tr_b16 v[24:25], v8 offset:24576
  ds_read_b64_tr_b16 v[26:27], v8 offset:25344
  s_waitcnt lgkmcnt(11)
  v_mfma_f32_32x32x16_bf16 v[88:103], v[52:55], v[20:23], v[88:103]
  ds_read_b64_tr_b16 v[28:29], v8 offset:24640
  ds_read_b64_tr_b16 v[30:31], v8 offset:25408
  s_waitcnt lgkmcnt(11)
  v_mfma_f32_32x32x16_bf16 v[104:119], v[56:59], v[20:23], v[104:119]
  ds_read_b64_tr_b16 v[32:33], v8 offset:24704
  ds_read_b64_tr_b16 v[34:35], v8 offset:25472
  s_waitcnt lgkmcnt(11)
  v_mfma_f32_32x32x16_bf16 v[120:135], v[60:63], v[20:23], v[120:135]
  ds_read_b64_tr_b16 v[36:37], v8 offset:36864
  ds_read_b64_tr_b16 v[38:39], v8 offset:37632
  s_waitcnt lgkmcnt(11)
  v_mfma_f32_32x32x16_bf16 v[136:151], v[64:67], v[20:23], v[136:151]
  ds_read_b64_tr_b16 v[40:41], v8 offset:36928
  ds_read_b64_tr_b16 v[42:43], v8 offset:37696
  s_waitcnt lgkmcnt(11)
  v_mfma_f32_32x32x16_bf16 v[152:167], v[68:71], v[20:23], v[152:167]
  ds_read_b64_tr_b16 v[44:45], v8 offset:36992
  ds_read_b64_tr_b16 v[46:47], v8 offset:37760
  s_waitcnt lgkmcnt(10)
  v_mfma_f32_32x32x16_bf16 v[72:87], v[24:27], v[16:19], v[72:87]
  ds_read_b128 v[20:23], v5 offset:16384
  ds_read_b64_tr_b16 v[48:49], v8 offset:27648
  ds_read_b64_tr_b16 v[50:51], v8 offset:28416
  s_waitcnt lgkmcnt(11)
  v_mfma_f32_32x32x16_bf16 v[88:103], v[28:31], v[16:19], v[88:103]
  ds_read_b64_tr_b16 v[52:53], v8 offset:27712
  ds_read_b64_tr_b16 v[54:55], v8 offset:28480
  s_waitcnt lgkmcnt(11)
  v_mfma_f32_32x32x16_bf16 v[104:119], v[32:35], v[16:19], v[104:119]
  ds_read_b64_tr_b16 v[56:57], v8 offset:27776
  ds_read_b64_tr_b16 v[58:59], v8 offset:28544
  s_waitcnt lgkmcnt(11)
  v_mfma_f32_32x32x16_bf16 v[120:135], v[36:39], v[16:19], v[120:135]
  ds_read_b64_tr_b16 v[60:61], v8 offset:39936
  ds_read_b64_tr_b16 v[62:63], v8 offset:40704
  s_waitcnt lgkmcnt(11)
  v_mfma_f32_32x32x16_bf16 v[136:151], v[40:43], v[16:19], v[136:151]
  ds_read_b64_tr_b16 v[64:65], v8 offset:40000
  ds_read_b64_tr_b16 v[66:67], v8 offset:40768
  s_waitcnt lgkmcnt(11)
  v_mfma_f32_32x32x16_bf16 v[152:167], v[44:47], v[16:19], v[152:167]
  ds_read_b64_tr_b16 v[68:69], v8 offset:40064
  ds_read_b64_tr_b16 v[70:71], v8 offset:40832
  s_waitcnt lgkmcnt(10)
  v_mfma_f32_32x32x16_bf16 v[72:87], v[48:51], v[20:23], v[72:87]
  ds_read_b128 v[16:19], v6 offset:16384
  ds_read_b64_tr_b16 v[24:25], v8 offset:30720
  ds_read_b64_tr_b16 v[26:27], v8 offset:31488
  s_waitcnt lgkmcnt(11)
  v_mfma_f32_32x32x16_bf16 v[88:103], v[52:55], v[20:23], v[88:103]
  ds_read_b64_tr_b16 v[28:29], v8 offset:30784
  ds_read_b64_tr_b16 v[30:31], v8 offset:31552
  s_waitcnt lgkmcnt(11)
  v_mfma_f32_32x32x16_bf16 v[104:119], v[56:59], v[20:23], v[104:119]
  ds_read_b64_tr_b16 v[32:33], v8 offset:30848
  ds_read_b64_tr_b16 v[34:35], v8 offset:31616
  s_waitcnt lgkmcnt(11)
  v_mfma_f32_32x32x16_bf16 v[120:135], v[60:63], v[20:23], v[120:135]
  ds_read_b64_tr_b16 v[36:37], v8 offset:43008
  ds_read_b64_tr_b16 v[38:39], v8 offset:43776
  s_waitcnt lgkmcnt(11)
  v_mfma_f32_32x32x16_bf16 v[136:151], v[64:67], v[20:23], v[136:151]
  ds_read_b64_tr_b16 v[40:41], v8 offset:43072
  ds_read_b64_tr_b16 v[42:43], v8 offset:43840
  s_waitcnt lgkmcnt(11)
  v_mfma_f32_32x32x16_bf16 v[152:167], v[68:71], v[20:23], v[152:167]
  ds_read_b64_tr_b16 v[44:45], v8 offset:43136
  ds_read_b64_tr_b16 v[46:47], v8 offset:43904
  s_waitcnt lgkmcnt(10)
  v_mfma_f32_32x32x16_bf16 v[72:87], v[24:27], v[16:19], v[72:87]
  ds_read_b128 v[20:23], v7 offset:16384
  ds_read_b64_tr_b16 v[48:49], v8 offset:33792
  ds_read_b64_tr_b16 v[50:51], v8 offset:34560
  s_waitcnt lgkmcnt(11)
  v_mfma_f32_32x32x16_bf16 v[88:103], v[28:31], v[16:19], v[88:103]
  ds_read_b64_tr_b16 v[52:53], v8 offset:33856
  ds_read_b64_tr_b16 v[54:55], v8 offset:34624
  s_waitcnt lgkmcnt(11)
  v_mfma_f32_32x32x16_bf16 v[104:119], v[32:35], v[16:19], v[104:119]
  ds_read_b64_tr_b16 v[56:57], v8 offset:33920
  ds_read_b64_tr_b16 v[58:59], v8 offset:34688
  s_waitcnt lgkmcnt(11)
  v_mfma_f32_32x32x16_bf16 v[120:135], v[36:39], v[16:19], v[120:135]
  ds_read_b64_tr_b16 v[60:61], v8 offset:46080
  ds_read_b64_tr_b16 v[62:63], v8 offset:46848
  s_waitcnt lgkmcnt(11)
  v_mfma_f32_32x32x16_bf16 v[136:151], v[40:43], v[16:19], v[136:151]
  ds_read_b64_tr_b16 v[64:65], v8 offset:46144
  ds_read_b64_tr_b16 v[66:67], v8 offset:46912
  s_waitcnt lgkmcnt(11)
  v_mfma_f32_32x32x16_bf16 v[152:167], v[44:47], v[16:19], v[152:167]
  ds_read_b64_tr_b16 v[68:69], v8 offset:46208
  ds_read_b64_tr_b16 v[70:71], v8 offset:46976
  s_waitcnt lgkmcnt(10)
  v_mfma_f32_32x32x16_bf16 v[72:87], v[48:51], v[20:23], v[72:87]
  s_waitcnt lgkmcnt(8)
  v_mfma_f32_32x32x16_bf16 v[88:103], v[52:55], v[20:23], v[88:103]
  s_waitcnt lgkmcnt(6)
  v_mfma_f32_32x32x16_bf16 v[104:119], v[56:59], v[20:23], v[104:119]
  s_waitcnt lgkmcnt(4)
  v_mfma_f32_32x32x16_bf16 v[120:135], v[60:63], v[20:23], v[120:135]
  s_waitcnt lgkmcnt(2)
  v_mfma_f32_32x32x16_bf16 v[136:151], v[64:67], v[20:23], v[136:151]
  s_waitcnt lgkmcnt(0)
  v_mfma_f32_32x32x16_bf16 v[152:167], v[68:71], v[20:23], v[152:167]
  s_barrier
  v_and_b32 v2, 31, v1
  s_and_b32 s9, s8, 1
  s_lshl_b32 s9, s9, 8
  s_lshr_b32 s10, s8, 1
  s_lshl_b32 s10, s10, 12
  s_add_u32 s9, s9, s10
  v_lshlrev_b32 v2, 3, v2
  v_add_u32 v2, s9, v2
  v_add_u32 v2, 36864, v2
  ds_read_b64 v[168:169], v2 offset:0
  ds_read_b64 v[170:171], v2 offset:512
  ds_read_b64 v[172:173], v2 offset:1024
  ds_read_b64 v[174:175], v2 offset:1536
  ds_read_b64 v[176:177], v2 offset:2048
  ds_read_b64 v[178:179], v2 offset:2560
  ds_read_b64 v[180:181], v2 offset:3072
  ds_read_b64 v[182:183], v2 offset:3584
  s_waitcnt lgkmcnt(0)
  v_add_f32 v10, v168, v170
  v_add_f32 v11, v169, v171
  v_add_f32 v10, v10, v172
  v_add_f32 v11, v11, v173
  v_add_f32 v10, v10, v174
  v_add_f32 v11, v11, v175
  v_add_f32 v10, v10, v176
  v_add_f32 v11, v11, v177
  v_add_f32 v10, v10, v178
  v_add_f32 v11, v11, v179
  v_add_f32 v10, v10, v180
  v_add_f32 v11, v11, v181
  v_add_f32 v10, v10, v182
  v_add_f32 v11, v11, v183
  s_mov_b32 s9, 0x3acccccd
  v_mul_f32 v10, s9, v10
  v_mul_f32 v13, v10, v10
  v_fma_f32 v11, v11, s9, -v13
  v_max_f32 v11, 0, v11
  v_add_f32 v11, 0x3727c5ac, v11
  v_rsq_f32 v11, v11
  s_nop 0
  v_mul_f32 v13, v10, v11
  v_sub_f32 v12, 0, v13
  v_mov_b32 v13, v12
  v_mov_b32 v10, v11
  v_lshrrev_b32 v14, 5, v1
  v_lshlrev_b32 v14, 4, v14
  v_add_u32 v14, 32768, v14
  s_add_u32 s24, s86, 16318464
  s_addc_u32 s25, s87, 0
  s_mov_b32 s26, 6291456
  s_mov_b32 s27, 0x00020000
  v_and_b32 v2, 31, v1
  s_lshl_b32 s9, s11, 7
  s_lshl_b32 s10, s8, 5
  s_add_u32 s9, s9, s10
  v_add_u32 v2, s9, v2
  v_mul_u32_u24 v2, 3072, v2
  v_lshrrev_b32 v3, 5, v1
  v_lshlrev_b32 v3, 4, v3
  s_mul_i32 s9, s12, 192
  v_add3_u32 v2, v2, v3, s9
  v_mov_b32 v4, 0xc0135761
  v_mov_b32 v5, 0xc0135761
  v_mov_b32 v6, 0xbdd2d3e8
  v_mov_b32 v7, 0xbdd2d3e8
  v_mov_b32 v8, 0x3f800000
  v_mov_b32 v9, 0x3f800000
  ds_read_b128 v[40:43], v14 offset:0
  ds_read_b128 v[56:59], v14 offset:768
  ds_read_b128 v[44:47], v14 offset:32
  ds_read_b128 v[60:63], v14 offset:800
  ds_read_b128 v[48:51], v14 offset:384
  ds_read_b128 v[64:67], v14 offset:1152
  ds_read_b128 v[52:55], v14 offset:416
  ds_read_b128 v[68:71], v14 offset:1184
  ds_read_b128 v[168:171], v14 offset:64
  ds_read_b128 v[184:187], v14 offset:832
  ds_read_b128 v[172:175], v14 offset:96
  ds_read_b128 v[188:191], v14 offset:864
  ds_read_b128 v[176:179], v14 offset:448
  ds_read_b128 v[192:195], v14 offset:1216
  ds_read_b128 v[180:183], v14 offset:480
  ds_read_b128 v[196:199], v14 offset:1248
  s_waitcnt lgkmcnt(8)
  v_pk_fma_f32 v[56:57], v[40:41], v[12:13], v[56:57]
  v_pk_fma_f32 v[58:59], v[42:43], v[12:13], v[58:59]
  v_pk_fma_f32 v[60:61], v[44:45], v[12:13], v[60:61]
  v_pk_fma_f32 v[62:63], v[46:47], v[12:13], v[62:63]
  v_pk_fma_f32 v[64:65], v[48:49], v[12:13], v[64:65]
  v_pk_fma_f32 v[66:67], v[50:51], v[12:13], v[66:67]
  v_pk_fma_f32 v[68:69], v[52:53], v[12:13], v[68:69]
  v_pk_fma_f32 v[70:71], v[54:55], v[12:13], v[70:71]
  v_pk_fma_f32 v[72:73], v[72:73], v[10:11], v[56:57]
  v_pk_fma_f32 v[74:75], v[74:75], v[10:11], v[58:59]
  v_pk_fma_f32 v[76:77], v[76:77], v[10:11], v[60:61]
  v_pk_fma_f32 v[78:79], v[78:79], v[10:11], v[62:63]
  v_pk_fma_f32 v[120:121], v[120:121], v[10:11], v[64:65]
  v_pk_fma_f32 v[122:123], v[122:123], v[10:11], v[66:67]
  v_pk_fma_f32 v[124:125], v[124:125], v[10:11], v[68:69]
  v_pk_fma_f32 v[126:127], v[126:127], v[10:11], v[70:71]
  v_pk_mul_f32 v[16:17], v[72:73], v[72:73]
  v_pk_mul_f32 v[18:19], v[74:75], v[74:75]
  v_pk_mul_f32 v[20:21], v[76:77], v[76:77]
  v_pk_mul_f32 v[22:23], v[78:79], v[78:79]
  v_pk_fma_f32 v[16:17], v[16:17], v[6:7], v[4:5]
  v_pk_fma_f32 v[18:19], v[18:19], v[6:7], v[4:5]
  v_pk_fma_f32 v[20:21], v[20:21], v[6:7], v[4:5]
  v_pk_fma_f32 v[22:23], v[22:23], v[6:7], v[4:5]
  v_pk_mul_f32 v[16:17], v[16:17], v[72:73]
  v_pk_mul_f32 v[18:19], v[18:19], v[74:75]
  v_pk_mul_f32 v[20:21], v[20:21], v[76:77]
  v_pk_mul_f32 v[22:23], v[22:23], v[78:79]
  v_exp_f32 v16, v16
  v_exp_f32 v17, v17
  v_exp_f32 v18, v18
  v_exp_f32 v19, v19
  v_exp_f32 v20, v20
  v_exp_f32 v21, v21
  v_exp_f32 v22, v22
  v_exp_f32 v23, v23
  v_pk_mul_f32 v[72:73], v[72:73], v[120:121]
  v_pk_mul_f32 v[74:75], v[74:75], v[122:123]
  v_pk_mul_f32 v[76:77], v[76:77], v[124:125]
  v_pk_mul_f32 v[78:79], v[78:79], v[126:127]
  v_pk_add_f32 v[16:17], v[16:17], v[8:9]
  v_pk_add_f32 v[18:19], v[18:19], v[8:9]
  v_pk_add_f32 v[20:21], v[20:21], v[8:9]
  v_pk_add_f32 v[22:23], v[22:23], v[8:9]
  v_rcp_f32 v16, v16
  v_rcp_f32 v17, v17
  v_rcp_f32 v18, v18
  v_rcp_f32 v19, v19
  v_rcp_f32 v20, v20
  v_rcp_f32 v21, v21
  v_rcp_f32 v22, v22
  v_rcp_f32 v23, v23
  v_pk_mul_f32 v[16:17], v[16:17], v[72:73]
  v_pk_mul_f32 v[18:19], v[18:19], v[74:75]
  v_pk_mul_f32 v[20:21], v[20:21], v[76:77]
  v_pk_mul_f32 v[22:23], v[22:23], v[78:79]
  v_cvt_pk_bf16_f32 v32, v16, v17
  v_cvt_pk_bf16_f32 v33, v18, v19
  v_cvt_pk_bf16_f32 v34, v20, v21
  v_cvt_pk_bf16_f32 v35, v22, v23
  s_nop 0
  v_permlane32_swap_b32 v32, v34
  v_permlane32_swap_b32 v33, v35
  ds_write_b128 v212, v[32:35] offset:0
  ds_read_b128 v[40:43], v14 offset:128
  ds_read_b128 v[56:59], v14 offset:896
  ds_read_b128 v[44:47], v14 offset:160
  ds_read_b128 v[60:63], v14 offset:928
  ds_read_b128 v[48:51], v14 offset:512
  ds_read_b128 v[64:67], v14 offset:1280
  ds_read_b128 v[52:55], v14 offset:544
  ds_read_b128 v[68:71], v14 offset:1312
  s_waitcnt lgkmcnt(8)
  v_pk_fma_f32 v[184:185], v[168:169], v[12:13], v[184:185]
  v_pk_fma_f32 v[186:187], v[170:171], v[12:13], v[186:187]
  v_pk_fma_f32 v[188:189], v[172:173], v[12:13], v[188:189]
  v_pk_fma_f32 v[190:191], v[174:175], v[12:13], v[190:191]
  v_pk_fma_f32 v[192:193], v[176:177], v[12:13], v[192:193]
  v_pk_fma_f32 v[194:195], v[178:179], v[12:13], v[194:195]
  v_pk_fma_f32 v[196:197], v[180:181], v[12:13], v[196:197]
  v_pk_fma_f32 v[198:199], v[182:183], v[12:13], v[198:199]
  v_pk_fma_f32 v[80:81], v[80:81], v[10:11], v[184:185]
  v_pk_fma_f32 v[82:83], v[82:83], v[10:11], v[186:187]
  v_pk_fma_f32 v[84:85], v[84:85], v[10:11], v[188:189]
  v_pk_fma_f32 v[86:87], v[86:87], v[10:11], v[190:191]
  v_pk_fma_f32 v[128:129], v[128:129], v[10:11], v[192:193]
  v_pk_fma_f32 v[130:131], v[130:131], v[10:11], v[194:195]
  v_pk_fma_f32 v[132:133], v[132:133], v[10:11], v[196:197]
  v_pk_fma_f32 v[134:135], v[134:135], v[10:11], v[198:199]
  v_pk_mul_f32 v[24:25], v[80:81], v[80:81]
  v_pk_mul_f32 v[26:27], v[82:83], v[82:83]
  v_pk_mul_f32 v[28:29], v[84:85], v[84:85]
  v_pk_mul_f32 v[30:31], v[86:87], v[86:87]
  v_pk_fma_f32 v[24:25], v[24:25], v[6:7], v[4:5]
  v_pk_fma_f32 v[26:27], v[26:27], v[6:7], v[4:5]
  v_pk_fma_f32 v[28:29], v[28:29], v[6:7], v[4:5]
  v_pk_fma_f32 v[30:31], v[30:31], v[6:7], v[4:5]
  v_pk_mul_f32 v[24:25], v[24:25], v[80:81]
  v_pk_mul_f32 v[26:27], v[26:27], v[82:83]
  v_pk_mul_f32 v[28:29], v[28:29], v[84:85]
  v_pk_mul_f32 v[30:31], v[30:31], v[86:87]
  v_exp_f32 v24, v24
  v_exp_f32 v25, v25
  v_exp_f32 v26, v26
  v_exp_f32 v27, v27
  v_exp_f32 v28, v28
  v_exp_f32 v29, v29
  v_exp_f32 v30, v30
  v_exp_f32 v31, v31
  v_pk_mul_f32 v[80:81], v[80:81], v[128:129]
  v_pk_mul_f32 v[82:83], v[82:83], v[130:131]
  v_pk_mul_f32 v[84:85], v[84:85], v[132:133]
  v_pk_mul_f32 v[86:87], v[86:87], v[134:135]
  v_pk_add_f32 v[24:25], v[24:25], v[8:9]
  v_pk_add_f32 v[26:27], v[26:27], v[8:9]
  v_pk_add_f32 v[28:29], v[28:29], v[8:9]
  v_pk_add_f32 v[30:31], v[30:31], v[8:9]
  v_rcp_f32 v24, v24
  v_rcp_f32 v25, v25
  v_rcp_f32 v26, v26
  v_rcp_f32 v27, v27
  v_rcp_f32 v28, v28
  v_rcp_f32 v29, v29
  v_rcp_f32 v30, v30
  v_rcp_f32 v31, v31
  v_pk_mul_f32 v[24:25], v[24:25], v[80:81]
  v_pk_mul_f32 v[26:27], v[26:27], v[82:83]
  v_pk_mul_f32 v[28:29], v[28:29], v[84:85]
  v_pk_mul_f32 v[30:31], v[30:31], v[86:87]
  v_cvt_pk_bf16_f32 v36, v24, v25
  v_cvt_pk_bf16_f32 v37, v26, v27
  v_cvt_pk_bf16_f32 v38, v28, v29
  v_cvt_pk_bf16_f32 v39, v30, v31
  s_nop 0
  v_permlane32_swap_b32 v36, v38
  v_permlane32_swap_b32 v37, v39
  ds_write_b128 v212, v[36:39] offset:32
  ds_read_b128 v[168:171], v14 offset:192
  ds_read_b128 v[184:187], v14 offset:960
  ds_read_b128 v[172:175], v14 offset:224
  ds_read_b128 v[188:191], v14 offset:992
  ds_read_b128 v[176:179], v14 offset:576
  ds_read_b128 v[192:195], v14 offset:1344
  ds_read_b128 v[180:183], v14 offset:608
  ds_read_b128 v[196:199], v14 offset:1376
  s_waitcnt lgkmcnt(8)
  v_pk_fma_f32 v[56:57], v[40:41], v[12:13], v[56:57]
  v_pk_fma_f32 v[58:59], v[42:43], v[12:13], v[58:59]
  v_pk_fma_f32 v[60:61], v[44:45], v[12:13], v[60:61]
  v_pk_fma_f32 v[62:63], v[46:47], v[12:13], v[62:63]
  v_pk_fma_f32 v[64:65], v[48:49], v[12:13], v[64:65]
  v_pk_fma_f32 v[66:67], v[50:51], v[12:13], v[66:67]
  v_pk_fma_f32 v[68:69], v[52:53], v[12:13], v[68:69]
  v_pk_fma_f32 v[70:71], v[54:55], v[12:13], v[70:71]
  v_pk_fma_f32 v[88:89], v[88:89], v[10:11], v[56:57]
  v_pk_fma_f32 v[90:91], v[90:91], v[10:11], v[58:59]
  v_pk_fma_f32 v[92:93], v[92:93], v[10:11], v[60:61]
  v_pk_fma_f32 v[94:95], v[94:95], v[10:11], v[62:63]
  v_pk_fma_f32 v[136:137], v[136:137], v[10:11], v[64:65]
  v_pk_fma_f32 v[138:139], v[138:139], v[10:11], v[66:67]
  v_pk_fma_f32 v[140:141], v[140:141], v[10:11], v[68:69]
  v_pk_fma_f32 v[142:143], v[142:143], v[10:11], v[70:71]
  v_pk_mul_f32 v[16:17], v[88:89], v[88:89]
  v_pk_mul_f32 v[18:19], v[90:91], v[90:91]
  v_pk_mul_f32 v[20:21], v[92:93], v[92:93]
  v_pk_mul_f32 v[22:23], v[94:95], v[94:95]
  v_pk_fma_f32 v[16:17], v[16:17], v[6:7], v[4:5]
  v_pk_fma_f32 v[18:19], v[18:19], v[6:7], v[4:5]
  v_pk_fma_f32 v[20:21], v[20:21], v[6:7], v[4:5]
  v_pk_fma_f32 v[22:23], v[22:23], v[6:7], v[4:5]
  v_pk_mul_f32 v[16:17], v[16:17], v[88:89]
  v_pk_mul_f32 v[18:19], v[18:19], v[90:91]
  v_pk_mul_f32 v[20:21], v[20:21], v[92:93]
  v_pk_mul_f32 v[22:23], v[22:23], v[94:95]
  v_exp_f32 v16, v16
  v_exp_f32 v17, v17
  v_exp_f32 v18, v18
  v_exp_f32 v19, v19
  v_exp_f32 v20, v20
  v_exp_f32 v21, v21
  v_exp_f32 v22, v22
  v_exp_f32 v23, v23
  v_pk_mul_f32 v[88:89], v[88:89], v[136:137]
  v_pk_mul_f32 v[90:91], v[90:91], v[138:139]
  v_pk_mul_f32 v[92:93], v[92:93], v[140:141]
  v_pk_mul_f32 v[94:95], v[94:95], v[142:143]
  v_pk_add_f32 v[16:17], v[16:17], v[8:9]
  v_pk_add_f32 v[18:19], v[18:19], v[8:9]
  v_pk_add_f32 v[20:21], v[20:21], v[8:9]
  v_pk_add_f32 v[22:23], v[22:23], v[8:9]
  v_rcp_f32 v16, v16
  v_rcp_f32 v17, v17
  v_rcp_f32 v18, v18
  v_rcp_f32 v19, v19
  v_rcp_f32 v20, v20
  v_rcp_f32 v21, v21
  v_rcp_f32 v22, v22
  v_rcp_f32 v23, v23
  v_pk_mul_f32 v[16:17], v[16:17], v[88:89]
  v_pk_mul_f32 v[18:19], v[18:19], v[90:91]
  v_pk_mul_f32 v[20:21], v[20:21], v[92:93]
  v_pk_mul_f32 v[22:23], v[22:23], v[94:95]
  v_cvt_pk_bf16_f32 v32, v16, v17
  v_cvt_pk_bf16_f32 v33, v18, v19
  v_cvt_pk_bf16_f32 v34, v20, v21
  v_cvt_pk_bf16_f32 v35, v22, v23
  s_nop 0
  v_permlane32_swap_b32 v32, v34
  v_permlane32_swap_b32 v33, v35
  ds_write_b128 v212, v[32:35] offset:64
  ds_read_b128 v[40:43], v14 offset:256
  ds_read_b128 v[56:59], v14 offset:1024
  ds_read_b128 v[44:47], v14 offset:288
  ds_read_b128 v[60:63], v14 offset:1056
  ds_read_b128 v[48:51], v14 offset:640
  ds_read_b128 v[64:67], v14 offset:1408
  ds_read_b128 v[52:55], v14 offset:672
  ds_read_b128 v[68:71], v14 offset:1440
  s_waitcnt lgkmcnt(8)
  v_pk_fma_f32 v[184:185], v[168:169], v[12:13], v[184:185]
  v_pk_fma_f32 v[186:187], v[170:171], v[12:13], v[186:187]
  v_pk_fma_f32 v[188:189], v[172:173], v[12:13], v[188:189]
  v_pk_fma_f32 v[190:191], v[174:175], v[12:13], v[190:191]
  v_pk_fma_f32 v[192:193], v[176:177], v[12:13], v[192:193]
  v_pk_fma_f32 v[194:195], v[178:179], v[12:13], v[194:195]
  v_pk_fma_f32 v[196:197], v[180:181], v[12:13], v[196:197]
  v_pk_fma_f32 v[198:199], v[182:183], v[12:13], v[198:199]
  v_pk_fma_f32 v[96:97], v[96:97], v[10:11], v[184:185]
  v_pk_fma_f32 v[98:99], v[98:99], v[10:11], v[186:187]
  v_pk_fma_f32 v[100:101], v[100:101], v[10:11], v[188:189]
  v_pk_fma_f32 v[102:103], v[102:103], v[10:11], v[190:191]
  v_pk_fma_f32 v[144:145], v[144:145], v[10:11], v[192:193]
  v_pk_fma_f32 v[146:147], v[146:147], v[10:11], v[194:195]
  v_pk_fma_f32 v[148:149], v[148:149], v[10:11], v[196:197]
  v_pk_fma_f32 v[150:151], v[150:151], v[10:11], v[198:199]
  v_pk_mul_f32 v[24:25], v[96:97], v[96:97]
  v_pk_mul_f32 v[26:27], v[98:99], v[98:99]
  v_pk_mul_f32 v[28:29], v[100:101], v[100:101]
  v_pk_mul_f32 v[30:31], v[102:103], v[102:103]
  v_pk_fma_f32 v[24:25], v[24:25], v[6:7], v[4:5]
  v_pk_fma_f32 v[26:27], v[26:27], v[6:7], v[4:5]
  v_pk_fma_f32 v[28:29], v[28:29], v[6:7], v[4:5]
  v_pk_fma_f32 v[30:31], v[30:31], v[6:7], v[4:5]
  v_pk_mul_f32 v[24:25], v[24:25], v[96:97]
  v_pk_mul_f32 v[26:27], v[26:27], v[98:99]
  v_pk_mul_f32 v[28:29], v[28:29], v[100:101]
  v_pk_mul_f32 v[30:31], v[30:31], v[102:103]
  v_exp_f32 v24, v24
  v_exp_f32 v25, v25
  v_exp_f32 v26, v26
  v_exp_f32 v27, v27
  v_exp_f32 v28, v28
  v_exp_f32 v29, v29
  v_exp_f32 v30, v30
  v_exp_f32 v31, v31
  v_pk_mul_f32 v[96:97], v[96:97], v[144:145]
  v_pk_mul_f32 v[98:99], v[98:99], v[146:147]
  v_pk_mul_f32 v[100:101], v[100:101], v[148:149]
  v_pk_mul_f32 v[102:103], v[102:103], v[150:151]
  v_pk_add_f32 v[24:25], v[24:25], v[8:9]
  v_pk_add_f32 v[26:27], v[26:27], v[8:9]
  v_pk_add_f32 v[28:29], v[28:29], v[8:9]
  v_pk_add_f32 v[30:31], v[30:31], v[8:9]
  v_rcp_f32 v24, v24
  v_rcp_f32 v25, v25
  v_rcp_f32 v26, v26
  v_rcp_f32 v27, v27
  v_rcp_f32 v28, v28
  v_rcp_f32 v29, v29
  v_rcp_f32 v30, v30
  v_rcp_f32 v31, v31
  v_pk_mul_f32 v[24:25], v[24:25], v[96:97]
  v_pk_mul_f32 v[26:27], v[26:27], v[98:99]
  v_pk_mul_f32 v[28:29], v[28:29], v[100:101]
  v_pk_mul_f32 v[30:31], v[30:31], v[102:103]
  v_cvt_pk_bf16_f32 v36, v24, v25
  v_cvt_pk_bf16_f32 v37, v26, v27
  v_cvt_pk_bf16_f32 v38, v28, v29
  v_cvt_pk_bf16_f32 v39, v30, v31
  s_nop 0
  v_permlane32_swap_b32 v36, v38
  v_permlane32_swap_b32 v37, v39
  ds_write_b128 v212, v[36:39] offset:96
  ds_read_b128 v[168:171], v14 offset:320
  ds_read_b128 v[184:187], v14 offset:1088
  ds_read_b128 v[172:175], v14 offset:352
  ds_read_b128 v[188:191], v14 offset:1120
  ds_read_b128 v[176:179], v14 offset:704
  ds_read_b128 v[192:195], v14 offset:1472
  ds_read_b128 v[180:183], v14 offset:736
  ds_read_b128 v[196:199], v14 offset:1504
  s_waitcnt lgkmcnt(8)
  v_pk_fma_f32 v[56:57], v[40:41], v[12:13], v[56:57]
  v_pk_fma_f32 v[58:59], v[42:43], v[12:13], v[58:59]
  v_pk_fma_f32 v[60:61], v[44:45], v[12:13], v[60:61]
  v_pk_fma_f32 v[62:63], v[46:47], v[12:13], v[62:63]
  v_pk_fma_f32 v[64:65], v[48:49], v[12:13], v[64:65]
  v_pk_fma_f32 v[66:67], v[50:51], v[12:13], v[66:67]
  v_pk_fma_f32 v[68:69], v[52:53], v[12:13], v[68:69]
  v_pk_fma_f32 v[70:71], v[54:55], v[12:13], v[70:71]
  v_pk_fma_f32 v[104:105], v[104:105], v[10:11], v[56:57]
  v_pk_fma_f32 v[106:107], v[106:107], v[10:11], v[58:59]
  v_pk_fma_f32 v[108:109], v[108:109], v[10:11], v[60:61]
  v_pk_fma_f32 v[110:111], v[110:111], v[10:11], v[62:63]
  v_pk_fma_f32 v[152:153], v[152:153], v[10:11], v[64:65]
  v_pk_fma_f32 v[154:155], v[154:155], v[10:11], v[66:67]
  v_pk_fma_f32 v[156:157], v[156:157], v[10:11], v[68:69]
  v_pk_fma_f32 v[158:159], v[158:159], v[10:11], v[70:71]
  v_pk_mul_f32 v[16:17], v[104:105], v[104:105]
  v_pk_mul_f32 v[18:19], v[106:107], v[106:107]
  v_pk_mul_f32 v[20:21], v[108:109], v[108:109]
  v_pk_mul_f32 v[22:23], v[110:111], v[110:111]
  v_pk_fma_f32 v[16:17], v[16:17], v[6:7], v[4:5]
  v_pk_fma_f32 v[18:19], v[18:19], v[6:7], v[4:5]
  v_pk_fma_f32 v[20:21], v[20:21], v[6:7], v[4:5]
  v_pk_fma_f32 v[22:23], v[22:23], v[6:7], v[4:5]
  v_pk_mul_f32 v[16:17], v[16:17], v[104:105]
  v_pk_mul_f32 v[18:19], v[18:19], v[106:107]
  v_pk_mul_f32 v[20:21], v[20:21], v[108:109]
  v_pk_mul_f32 v[22:23], v[22:23], v[110:111]
  v_exp_f32 v16, v16
  v_exp_f32 v17, v17
  v_exp_f32 v18, v18
  v_exp_f32 v19, v19
  v_exp_f32 v20, v20
  v_exp_f32 v21, v21
  v_exp_f32 v22, v22
  v_exp_f32 v23, v23
  v_pk_mul_f32 v[104:105], v[104:105], v[152:153]
  v_pk_mul_f32 v[106:107], v[106:107], v[154:155]
  v_pk_mul_f32 v[108:109], v[108:109], v[156:157]
  v_pk_mul_f32 v[110:111], v[110:111], v[158:159]
  v_pk_add_f32 v[16:17], v[16:17], v[8:9]
  v_pk_add_f32 v[18:19], v[18:19], v[8:9]
  v_pk_add_f32 v[20:21], v[20:21], v[8:9]
  v_pk_add_f32 v[22:23], v[22:23], v[8:9]
  v_rcp_f32 v16, v16
  v_rcp_f32 v17, v17
  v_rcp_f32 v18, v18
  v_rcp_f32 v19, v19
  v_rcp_f32 v20, v20
  v_rcp_f32 v21, v21
  v_rcp_f32 v22, v22
  v_rcp_f32 v23, v23
  v_pk_mul_f32 v[16:17], v[16:17], v[104:105]
  v_pk_mul_f32 v[18:19], v[18:19], v[106:107]
  v_pk_mul_f32 v[20:21], v[20:21], v[108:109]
  v_pk_mul_f32 v[22:23], v[22:23], v[110:111]
  v_cvt_pk_bf16_f32 v32, v16, v17
  v_cvt_pk_bf16_f32 v33, v18, v19
  v_cvt_pk_bf16_f32 v34, v20, v21
  v_cvt_pk_bf16_f32 v35, v22, v23
  s_nop 0
  v_permlane32_swap_b32 v32, v34
  v_permlane32_swap_b32 v33, v35
  ds_write_b128 v212, v[32:35] offset:128
  s_waitcnt lgkmcnt(0)
  v_pk_fma_f32 v[184:185], v[168:169], v[12:13], v[184:185]
  v_pk_fma_f32 v[186:187], v[170:171], v[12:13], v[186:187]
  v_pk_fma_f32 v[188:189], v[172:173], v[12:13], v[188:189]
  v_pk_fma_f32 v[190:191], v[174:175], v[12:13], v[190:191]
  v_pk_fma_f32 v[192:193], v[176:177], v[12:13], v[192:193]
  v_pk_fma_f32 v[194:195], v[178:179], v[12:13], v[194:195]
  v_pk_fma_f32 v[196:197], v[180:181], v[12:13], v[196:197]
  v_pk_fma_f32 v[198:199], v[182:183], v[12:13], v[198:199]
  v_pk_fma_f32 v[112:113], v[112:113], v[10:11], v[184:185]
  v_pk_fma_f32 v[114:115], v[114:115], v[10:11], v[186:187]
  v_pk_fma_f32 v[116:117], v[116:117], v[10:11], v[188:189]
  v_pk_fma_f32 v[118:119], v[118:119], v[10:11], v[190:191]
  v_pk_fma_f32 v[160:161], v[160:161], v[10:11], v[192:193]
  v_pk_fma_f32 v[162:163], v[162:163], v[10:11], v[194:195]
  v_pk_fma_f32 v[164:165], v[164:165], v[10:11], v[196:197]
  v_pk_fma_f32 v[166:167], v[166:167], v[10:11], v[198:199]
  v_pk_mul_f32 v[24:25], v[112:113], v[112:113]
  v_pk_mul_f32 v[26:27], v[114:115], v[114:115]
  v_pk_mul_f32 v[28:29], v[116:117], v[116:117]
  v_pk_mul_f32 v[30:31], v[118:119], v[118:119]
  v_pk_fma_f32 v[24:25], v[24:25], v[6:7], v[4:5]
  v_pk_fma_f32 v[26:27], v[26:27], v[6:7], v[4:5]
  v_pk_fma_f32 v[28:29], v[28:29], v[6:7], v[4:5]
  v_pk_fma_f32 v[30:31], v[30:31], v[6:7], v[4:5]
  v_pk_mul_f32 v[24:25], v[24:25], v[112:113]
  v_pk_mul_f32 v[26:27], v[26:27], v[114:115]
  v_pk_mul_f32 v[28:29], v[28:29], v[116:117]
  v_pk_mul_f32 v[30:31], v[30:31], v[118:119]
  v_exp_f32 v24, v24
  v_exp_f32 v25, v25
  v_exp_f32 v26, v26
  v_exp_f32 v27, v27
  v_exp_f32 v28, v28
  v_exp_f32 v29, v29
  v_exp_f32 v30, v30
  v_exp_f32 v31, v31
  v_pk_mul_f32 v[112:113], v[112:113], v[160:161]
  v_pk_mul_f32 v[114:115], v[114:115], v[162:163]
  v_pk_mul_f32 v[116:117], v[116:117], v[164:165]
  v_pk_mul_f32 v[118:119], v[118:119], v[166:167]
  v_pk_add_f32 v[24:25], v[24:25], v[8:9]
  v_pk_add_f32 v[26:27], v[26:27], v[8:9]
  v_pk_add_f32 v[28:29], v[28:29], v[8:9]
  v_pk_add_f32 v[30:31], v[30:31], v[8:9]
  v_rcp_f32 v24, v24
  v_rcp_f32 v25, v25
  v_rcp_f32 v26, v26
  v_rcp_f32 v27, v27
  v_rcp_f32 v28, v28
  v_rcp_f32 v29, v29
  v_rcp_f32 v30, v30
  v_rcp_f32 v31, v31
  v_pk_mul_f32 v[24:25], v[24:25], v[112:113]
  v_pk_mul_f32 v[26:27], v[26:27], v[114:115]
  v_pk_mul_f32 v[28:29], v[28:29], v[116:117]
  v_pk_mul_f32 v[30:31], v[30:31], v[118:119]
  v_cvt_pk_bf16_f32 v36, v24, v25
  v_cvt_pk_bf16_f32 v37, v26, v27
  v_cvt_pk_bf16_f32 v38, v28, v29
  v_cvt_pk_bf16_f32 v39, v30, v31
  s_nop 0
  v_permlane32_swap_b32 v36, v38
  v_permlane32_swap_b32 v37, v39
  ds_write_b128 v212, v[36:39] offset:160
  s_waitcnt lgkmcnt(0)
  ds_read_b128 v[72:75], v200
  ds_read_b128 v[76:79], v201
  ds_read_b128 v[80:83], v202
  ds_read_b128 v[84:87], v203
  ds_read_b128 v[88:91], v204
  ds_read_b128 v[92:95], v205
  s_waitcnt lgkmcnt(5)
  buffer_store_dwordx4 v[72:75], v206, s[24:27], 0 offen sc1
  s_waitcnt lgkmcnt(4)
  buffer_store_dwordx4 v[76:79], v207, s[24:27], 0 offen sc1
  s_waitcnt lgkmcnt(3)
  buffer_store_dwordx4 v[80:83], v208, s[24:27], 0 offen sc1
  s_waitcnt lgkmcnt(2)
  buffer_store_dwordx4 v[84:87], v209, s[24:27], 0 offen sc1
  s_waitcnt lgkmcnt(1)
  buffer_store_dwordx4 v[88:91], v210, s[24:27], 0 offen sc1
  s_waitcnt lgkmcnt(0)
  buffer_store_dwordx4 v[92:95], v211, s[24:27], 0 offen sc1
  s_waitcnt vmcnt(0)
  s_barrier
  s_and_b32 s3, s2, 7
  s_lshr_b32 s13, s2, 3
  s_lshl_b32 s14, s3, 2
  s_and_b32 s15, s13, 3
  s_add_u32 s11, s14, s15
  s_lshr_b32 s12, s13, 2
  s_and_b32 s28, s31, 1
  s_lshr_b32 s29, s31, 1
  s_lshl_b32 s9, s11, 6
  s_lshl_b32 s10, s28, 5
  s_add_u32 s30, s9, s10
  v_and_b32 v2, 15, v1
  v_lshrrev_b32 v3, 4, v1
  v_lshrrev_b32 v10, 1, v2
  v_lshlrev_b32 v2, 7, v2
  s_lshl_b32 s13, s8, 12
  v_add_u32 v2, s13, v2
  v_add_u32 v11, 0, v3
  v_xor_b32 v11, v11, v10
  v_lshl_add_u32 v4, v11, 4, v2
  v_add_u32 v11, 4, v3
  v_xor_b32 v11, v11, v10
  v_lshl_add_u32 v5, v11, 4, v2
  v_lshrrev_b32 v2, 5, v1
  v_lshlrev_b32 v2, 4, v2
  v_bfe_u32 v10, v1, 4, 1
  v_lshl_add_u32 v2, v10, 2, v2
  v_bfe_u32 v10, v1, 2, 2
  v_add_u32 v2, v2, v10
  v_mul_u32_u24 v2, 160, v2
  v_and_b32 v10, 3, v1
  v_lshl_add_u32 v2, v10, 3, v2
  s_mul_i32 s10, s29, 10240
  s_add_u32 s10, s10, 65536
  v_add_u32 v6, s10, v2
  v_add_u32 v7, 40960, v6
  v_and_b32 v2, 15, v1
  s_lshl_b32 s10, s29, 4
  s_add_u32 s10, s10, s30
  v_add_u32 v2, s10, v2
  v_mul_u32_u24 v8, 1280, v2
  s_mul_i32 s10, s12, 160
  v_lshl_add_u32 v8, v3, 3, v8
  v_add_u32 v8, s10, v8
  s_mul_i32 s10, s12, 320
  v_lshlrev_b32 v9, 4, v3
  v_add_u32 v9, s10, v9
  s_mov_b32 s32, s82
  s_mov_b32 s33, s83
  s_mov_b32 s34, 2621440
  s_mov_b32 s35, 0x00020000
  v_lshlrev_b32 v10, 4, v1
  s_mul_i32 s9, s8, 5120
  s_add_u32 s9, s9, 0
  v_add_u32 v151, s9, v10
  s_xor_b32 s10, s8, 2
  s_mul_i32 s10, s10, 5120
  s_add_u32 s10, s10, 0
  v_add_u32 v152, s10, v10
  v_and_b32 v10, 15, v1
  s_lshl_b32 s10, s29, 4
  s_lshl_b32 s9, s28, 5
  s_add_u32 s10, s10, s9
  v_add_u32 v11, s10, v10
  v_mul_u32_u24 v11, 160, v11
  v_lshrrev_b32 v140, 4, v1
  v_lshl_add_u32 v11, v140, 3, v11
  v_add_u32 v153, 147456, v11
  v_lshlrev_b32 v140, 4, v140
  v_add_u32 v154, 157696, v140
  s_lshl_b32 s10, s29, 4
  s_lshl_b32 s9, s28, 5
  s_add_u32 s10, s10, s9
  v_add_u32 v11, s10, v10
  v_lshlrev_b32 v155, 3, v11
  s_lshl_b32 s9, s11, 12
  s_lshl_b32 s10, s12, 9
  s_add_u32 s9, s9, s10
  v_add_u32 v155, s9, v155
  s_mul_i32 s9, s8, 3072
  s_add_u32 s9, s9, 20480
  s_lshl_b32 s10, s29, 4
  s_add_u32 s10, s10, s30
  s_mul_i32 s40, s12, 160
  v_add_u32 v10, 0, v1
  v_mul_u32_u24 v11, 6554, v10
  v_lshrrev_b32 v11, 16, v11
  v_mul_u32_u24 v140, 10, v11
  v_sub_u32 v140, v10, v140
  v_lshlrev_b32 v140, 4, v140
  v_mul_u32_u24 v141, 176, v11
  v_add3_u32 v144, v141, v140, s9
  v_add_u32 v11, s10, v11
  v_mul_u32_u24 v11, 1280, v11
  v_add3_u32 v148, v11, v140, s40
  v_add_u32 v10, 64, v1
  v_mul_u32_u24 v11, 6554, v10
  v_lshrrev_b32 v11, 16, v11
  v_mul_u32_u24 v140, 10, v11
  v_sub_u32 v140, v10, v140
  v_lshlrev_b32 v140, 4, v140
  v_mul_u32_u24 v141, 176, v11
  v_add3_u32 v145, v141, v140, s9
  v_add_u32 v11, s10, v11
  v_mul_u32_u24 v11, 1280, v11
  v_add3_u32 v149, v11, v140, s40
  v_add_u32 v10, 128, v1
  v_mul_u32_u24 v11, 6554, v10
  v_lshrrev_b32 v11, 16, v11
  v_mul_u32_u24 v140, 10, v11
  v_sub_u32 v140, v10, v140
  v_lshlrev_b32 v140, 4, v140
  v_mul_u32_u24 v141, 176, v11
  v_add3_u32 v146, v141, v140, s9
  v_add_u32 v11, s10, v11
  v_mul_u32_u24 v11, 1280, v11
  v_add3_u32 v150, v11, v140, s40
  v_cmp_gt_u32 vcc, 32, v1
  v_mov_b32 v10, 0x7ffffff0
  s_nop 0
  v_cndmask_b32 v150, v10, v150, vcc
  v_and_b32 v10, 15, v1
  v_mul_u32_u24 v10, 176, v10
  v_lshrrev_b32 v11, 4, v1
  v_lshlrev_b32 v11, 3, v11
  v_add3_u32 v147, v10, v11, s9
  s_barrier
  s_barrier
  ds_read_b128 v[12:15], v4 offset:0
  ds_read_b128 v[16:19], v4 offset:2048
  ds_read_b64_tr_b16 v[28:29], v6 offset:0
  ds_read_b64_tr_b16 v[30:31], v6 offset:1280
  ds_read_b64_tr_b16 v[32:33], v6 offset:32
  ds_read_b64_tr_b16 v[34:35], v6 offset:1312
  ds_read_b64_tr_b16 v[36:37], v6 offset:64
  ds_read_b64_tr_b16 v[38:39], v6 offset:1344
  ds_read_b64_tr_b16 v[40:41], v6 offset:96
  ds_read_b64_tr_b16 v[42:43], v6 offset:1376
  ds_read_b64_tr_b16 v[44:45], v6 offset:128
  ds_read_b64_tr_b16 v[46:47], v6 offset:1408
  s_waitcnt lgkmcnt(8)
  v_mfma_f32_16x16x32_bf16 v[68:71], v[28:31], v[12:15], 0
  v_mfma_f32_16x16x32_bf16 v[72:75], v[28:31], v[16:19], 0
  ds_read_b128 v[20:23], v5 offset:0
  ds_read_b128 v[24:27], v5 offset:2048
  ds_read_b64_tr_b16 v[48:49], v6 offset:5120
  ds_read_b64_tr_b16 v[50:51], v6 offset:6400
  s_waitcnt lgkmcnt(10)
  v_mfma_f32_16x16x32_bf16 v[76:79], v[32:35], v[12:15], 0
  v_mfma_f32_16x16x32_bf16 v[80:83], v[32:35], v[16:19], 0
  ds_read_b64_tr_b16 v[52:53], v6 offset:5152
  ds_read_b64_tr_b16 v[54:55], v6 offset:6432
  s_waitcnt lgkmcnt(10)
  v_mfma_f32_16x16x32_bf16 v[84:87], v[36:39], v[12:15], 0
  v_mfma_f32_16x16x32_bf16 v[88:91], v[36:39], v[16:19], 0
  ds_read_b64_tr_b16 v[56:57], v6 offset:5184
  ds_read_b64_tr_b16 v[58:59], v6 offset:6464
  s_waitcnt lgkmcnt(10)
  v_mfma_f32_16x16x32_bf16 v[92:95], v[40:43], v[12:15], 0
  v_mfma_f32_16x16x32_bf16 v[96:99], v[40:43], v[16:19], 0
  ds_read_b64_tr_b16 v[60:61], v6 offset:5216
  ds_read_b64_tr_b16 v[62:63], v6 offset:6496
  s_waitcnt lgkmcnt(10)
  v_mfma_f32_16x16x32_bf16 v[100:103], v[44:47], v[12:15], 0
  v_mfma_f32_16x16x32_bf16 v[104:107], v[44:47], v[16:19], 0
  ds_read_b64_tr_b16 v[64:65], v6 offset:5248
  ds_read_b64_tr_b16 v[66:67], v6 offset:6528
  s_barrier
  s_waitcnt lgkmcnt(8)
  v_mfma_f32_16x16x32_bf16 v[68:71], v[48:51], v[20:23], v[68:71]
  v_mfma_f32_16x16x32_bf16 v[72:75], v[48:51], v[24:27], v[72:75]
  ds_read_b128 v[12:15], v4 offset:16384
  ds_read_b128 v[16:19], v4 offset:18432
  ds_read_b64_tr_b16 v[28:29], v6 offset:20480
  ds_read_b64_tr_b16 v[30:31], v6 offset:21760
  s_waitcnt lgkmcnt(10)
  v_mfma_f32_16x16x32_bf16 v[76:79], v[52:55], v[20:23], v[76:79]
  v_mfma_f32_16x16x32_bf16 v[80:83], v[52:55], v[24:27], v[80:83]
  ds_read_b64_tr_b16 v[32:33], v6 offset:20512
  ds_read_b64_tr_b16 v[34:35], v6 offset:21792
  s_waitcnt lgkmcnt(10)
  v_mfma_f32_16x16x32_bf16 v[84:87], v[56:59], v[20:23], v[84:87]
  v_mfma_f32_16x16x32_bf16 v[88:91], v[56:59], v[24:27], v[88:91]
  ds_read_b64_tr_b16 v[36:37], v6 offset:20544
  ds_read_b64_tr_b16 v[38:39], v6 offset:21824
  s_waitcnt lgkmcnt(10)
  v_mfma_f32_16x16x32_bf16 v[92:95], v[60:63], v[20:23], v[92:95]
  v_mfma_f32_16x16x32_bf16 v[96:99], v[60:63], v[24:27], v[96:99]
  ds_read_b64_tr_b16 v[40:41], v6 offset:20576
  ds_read_b64_tr_b16 v[42:43], v6 offset:21856
  s_waitcnt lgkmcnt(10)
  v_mfma_f32_16x16x32_bf16 v[100:103], v[64:67], v[20:23], v[100:103]
  v_mfma_f32_16x16x32_bf16 v[104:107], v[64:67], v[24:27], v[104:107]
  ds_read_b64_tr_b16 v[44:45], v6 offset:20608
  ds_read_b64_tr_b16 v[46:47], v6 offset:21888
  s_waitcnt lgkmcnt(8)
  v_mfma_f32_16x16x32_bf16 v[68:71], v[28:31], v[12:15], v[68:71]
  v_mfma_f32_16x16x32_bf16 v[72:75], v[28:31], v[16:19], v[72:75]
  ds_read_b128 v[20:23], v5 offset:16384
  ds_read_b128 v[24:27], v5 offset:18432
  ds_read_b64_tr_b16 v[48:49], v6 offset:25600
  ds_read_b64_tr_b16 v[50:51], v6 offset:26880
  s_waitcnt lgkmcnt(10)
  v_mfma_f32_16x16x32_bf16 v[76:79], v[32:35], v[12:15], v[76:79]
  v_mfma_f32_16x16x32_bf16 v[80:83], v[32:35], v[16:19], v[80:83]
  ds_read_b64_tr_b16 v[52:53], v6 offset:25632
  ds_read_b64_tr_b16 v[54:55], v6 offset:26912
  s_waitcnt lgkmcnt(10)
  v_mfma_f32_16x16x32_bf16 v[84:87], v[36:39], v[12:15], v[84:87]
  v_mfma_f32_16x16x32_bf16 v[88:91], v[36:39], v[16:19], v[88:91]
  ds_read_b64_tr_b16 v[56:57], v6 offset:25664
  ds_read_b64_tr_b16 v[58:59], v6 offset:26944
  s_waitcnt lgkmcnt(10)
  v_mfma_f32_16x16x32_bf16 v[92:95], v[40:43], v[12:15], v[92:95]
  v_mfma_f32_16x16x32_bf16 v[96:99], v[40:43], v[16:19], v[96:99]
  ds_read_b64_tr_b16 v[60:61], v6 offset:25696
  ds_read_b64_tr_b16 v[62:63], v6 offset:26976
  s_waitcnt lgkmcnt(10)
  v_mfma_f32_16x16x32_bf16 v[100:103], v[44:47], v[12:15], v[100:103]
  v_mfma_f32_16x16x32_bf16 v[104:107], v[44:47], v[16:19], v[104:107]
  ds_read_b64_tr_b16 v[64:65], v6 offset:25728
  ds_read_b64_tr_b16 v[66:67], v6 offset:27008
  s_barrier
  s_waitcnt lgkmcnt(8)
  v_mfma_f32_16x16x32_bf16 v[68:71], v[48:51], v[20:23], v[68:71]
  v_mfma_f32_16x16x32_bf16 v[72:75], v[48:51], v[24:27], v[72:75]
  ds_read_b128 v[12:15], v4 offset:32768
  ds_read_b128 v[16:19], v4 offset:34816
  ds_read_b64_tr_b16 v[28:29], v7 offset:0
  ds_read_b64_tr_b16 v[30:31], v7 offset:1280
  s_waitcnt lgkmcnt(10)
  v_mfma_f32_16x16x32_bf16 v[76:79], v[52:55], v[20:23], v[76:79]
  v_mfma_f32_16x16x32_bf16 v[80:83], v[52:55], v[24:27], v[80:83]
  ds_read_b64_tr_b16 v[32:33], v7 offset:32
  ds_read_b64_tr_b16 v[34:35], v7 offset:1312
  s_waitcnt lgkmcnt(10)
  v_mfma_f32_16x16x32_bf16 v[84:87], v[56:59], v[20:23], v[84:87]
  v_mfma_f32_16x16x32_bf16 v[88:91], v[56:59], v[24:27], v[88:91]
  ds_read_b64_tr_b16 v[36:37], v7 offset:64
  ds_read_b64_tr_b16 v[38:39], v7 offset:1344
  s_waitcnt lgkmcnt(10)
  v_mfma_f32_16x16x32_bf16 v[92:95], v[60:63], v[20:23], v[92:95]
  v_mfma_f32_16x16x32_bf16 v[96:99], v[60:63], v[24:27], v[96:99]
  ds_read_b64_tr_b16 v[40:41], v7 offset:96
  ds_read_b64_tr_b16 v[42:43], v7 offset:1376
  s_waitcnt lgkmcnt(10)
  v_mfma_f32_16x16x32_bf16 v[100:103], v[64:67], v[20:23], v[100:103]
  v_mfma_f32_16x16x32_bf16 v[104:107], v[64:67], v[24:27], v[104:107]
  ds_read_b64_tr_b16 v[44:45], v7 offset:128
  ds_read_b64_tr_b16 v[46:47], v7 offset:1408
  s_waitcnt lgkmcnt(8)
  v_mfma_f32_16x16x32_bf16 v[68:71], v[28:31], v[12:15], v[68:71]
  v_mfma_f32_16x16x32_bf16 v[72:75], v[28:31], v[16:19], v[72:75]
  ds_read_b128 v[20:23], v5 offset:32768
  ds_read_b128 v[24:27], v5 offset:34816
  ds_read_b64_tr_b16 v[48:49], v7 offset:5120
  ds_read_b64_tr_b16 v[50:51], v7 offset:6400
  s_waitcnt lgkmcnt(10)
  v_mfma_f32_16x16x32_bf16 v[76:79], v[32:35], v[12:15], v[76:79]
  v_mfma_f32_16x16x32_bf16 v[80:83], v[32:35], v[16:19], v[80:83]
  ds_read_b64_tr_b16 v[52:53], v7 offset:5152
  ds_read_b64_tr_b16 v[54:55], v7 offset:6432
  s_waitcnt lgkmcnt(10)
  v_mfma_f32_16x16x32_bf16 v[84:87], v[36:39], v[12:15], v[84:87]
  v_mfma_f32_16x16x32_bf16 v[88:91], v[36:39], v[16:19], v[88:91]
  ds_read_b64_tr_b16 v[56:57], v7 offset:5184
  ds_read_b64_tr_b16 v[58:59], v7 offset:6464
  s_waitcnt lgkmcnt(10)
  v_mfma_f32_16x16x32_bf16 v[92:95], v[40:43], v[12:15], v[92:95]
  v_mfma_f32_16x16x32_bf16 v[96:99], v[40:43], v[16:19], v[96:99]
  ds_read_b64_tr_b16 v[60:61], v7 offset:5216
  ds_read_b64_tr_b16 v[62:63], v7 offset:6496
  s_waitcnt lgkmcnt(10)
  v_mfma_f32_16x16x32_bf16 v[100:103], v[44:47], v[12:15], v[100:103]
  v_mfma_f32_16x16x32_bf16 v[104:107], v[44:47], v[16:19], v[104:107]
  ds_read_b64_tr_b16 v[64:65], v7 offset:5248
  ds_read_b64_tr_b16 v[66:67], v7 offset:6528
  s_barrier
  s_waitcnt lgkmcnt(8)
  v_mfma_f32_16x16x32_bf16 v[68:71], v[48:51], v[20:23], v[68:71]
  v_mfma_f32_16x16x32_bf16 v[72:75], v[48:51], v[24:27], v[72:75]
  ds_read_b128 v[12:15], v4 offset:49152
  ds_read_b128 v[16:19], v4 offset:51200
  ds_read_b64_tr_b16 v[28:29], v7 offset:20480
  ds_read_b64_tr_b16 v[30:31], v7 offset:21760
  s_waitcnt lgkmcnt(10)
  v_mfma_f32_16x16x32_bf16 v[76:79], v[52:55], v[20:23], v[76:79]
  v_mfma_f32_16x16x32_bf16 v[80:83], v[52:55], v[24:27], v[80:83]
  ds_read_b64_tr_b16 v[32:33], v7 offset:20512
  ds_read_b64_tr_b16 v[34:35], v7 offset:21792
  s_waitcnt lgkmcnt(10)
  v_mfma_f32_16x16x32_bf16 v[84:87], v[56:59], v[20:23], v[84:87]
  v_mfma_f32_16x16x32_bf16 v[88:91], v[56:59], v[24:27], v[88:91]
  ds_read_b64_tr_b16 v[36:37], v7 offset:20544
  ds_read_b64_tr_b16 v[38:39], v7 offset:21824
  s_waitcnt lgkmcnt(10)
  v_mfma_f32_16x16x32_bf16 v[92:95], v[60:63], v[20:23], v[92:95]
  v_mfma_f32_16x16x32_bf16 v[96:99], v[60:63], v[24:27], v[96:99]
  ds_read_b64_tr_b16 v[40:41], v7 offset:20576
  ds_read_b64_tr_b16 v[42:43], v7 offset:21856
  s_waitcnt lgkmcnt(10)
  v_mfma_f32_16x16x32_bf16 v[100:103], v[64:67], v[20:23], v[100:103]
  v_mfma_f32_16x16x32_bf16 v[104:107], v[64:67], v[24:27], v[104:107]
  ds_read_b64_tr_b16 v[44:45], v7 offset:20608
  ds_read_b64_tr_b16 v[46:47], v7 offset:21888
  s_waitcnt lgkmcnt(8)
  v_mfma_f32_16x16x32_bf16 v[68:71], v[28:31], v[12:15], v[68:71]
  v_mfma_f32_16x16x32_bf16 v[72:75], v[28:31], v[16:19], v[72:75]
  ds_read_b128 v[20:23], v5 offset:49152
  ds_read_b128 v[24:27], v5 offset:51200
  ds_read_b64_tr_b16 v[48:49], v7 offset:25600
  ds_read_b64_tr_b16 v[50:51], v7 offset:26880
  s_waitcnt lgkmcnt(10)
  v_mfma_f32_16x16x32_bf16 v[76:79], v[32:35], v[12:15], v[76:79]
  v_mfma_f32_16x16x32_bf16 v[80:83], v[32:35], v[16:19], v[80:83]
  ds_read_b64_tr_b16 v[52:53], v7 offset:25632
  ds_read_b64_tr_b16 v[54:55], v7 offset:26912
  s_waitcnt lgkmcnt(10)
  v_mfma_f32_16x16x32_bf16 v[84:87], v[36:39], v[12:15], v[84:87]
  v_mfma_f32_16x16x32_bf16 v[88:91], v[36:39], v[16:19], v[88:91]
  ds_read_b64_tr_b16 v[56:57], v7 offset:25664
  ds_read_b64_tr_b16 v[58:59], v7 offset:26944
  s_waitcnt lgkmcnt(10)
  v_mfma_f32_16x16x32_bf16 v[92:95], v[40:43], v[12:15], v[92:95]
  v_mfma_f32_16x16x32_bf16 v[96:99], v[40:43], v[16:19], v[96:99]
  ds_read_b64_tr_b16 v[60:61], v7 offset:25696
  ds_read_b64_tr_b16 v[62:63], v7 offset:26976
  s_waitcnt lgkmcnt(10)
  v_mfma_f32_16x16x32_bf16 v[100:103], v[44:47], v[12:15], v[100:103]
  v_mfma_f32_16x16x32_bf16 v[104:107], v[44:47], v[16:19], v[104:107]
  ds_read_b64_tr_b16 v[64:65], v7 offset:25728
  ds_read_b64_tr_b16 v[66:67], v7 offset:27008
  s_barrier
  s_waitcnt lgkmcnt(8)
  v_mfma_f32_16x16x32_bf16 v[68:71], v[48:51], v[20:23], v[68:71]
  v_mfma_f32_16x16x32_bf16 v[72:75], v[48:51], v[24:27], v[72:75]
  ds_read_b128 v[12:15], v4 offset:0
  ds_read_b128 v[16:19], v4 offset:2048
  ds_read_b64_tr_b16 v[28:29], v6 offset:0
  ds_read_b64_tr_b16 v[30:31], v6 offset:1280
  s_waitcnt lgkmcnt(10)
  v_mfma_f32_16x16x32_bf16 v[76:79], v[52:55], v[20:23], v[76:79]
  v_mfma_f32_16x16x32_bf16 v[80:83], v[52:55], v[24:27], v[80:83]
  ds_read_b64_tr_b16 v[32:33], v6 offset:32
  ds_read_b64_tr_b16 v[34:35], v6 offset:1312
  s_waitcnt lgkmcnt(10)
  v_mfma_f32_16x16x32_bf16 v[84:87], v[56:59], v[20:23], v[84:87]
  v_mfma_f32_16x16x32_bf16 v[88:91], v[56:59], v[24:27], v[88:91]
  ds_read_b64_tr_b16 v[36:37], v6 offset:64
  ds_read_b64_tr_b16 v[38:39], v6 offset:1344
  s_waitcnt lgkmcnt(10)
  v_mfma_f32_16x16x32_bf16 v[92:95], v[60:63], v[20:23], v[92:95]
  v_mfma_f32_16x16x32_bf16 v[96:99], v[60:63], v[24:27], v[96:99]
  ds_read_b64_tr_b16 v[40:41], v6 offset:96
  ds_read_b64_tr_b16 v[42:43], v6 offset:1376
  s_waitcnt lgkmcnt(10)
  v_mfma_f32_16x16x32_bf16 v[100:103], v[64:67], v[20:23], v[100:103]
  v_mfma_f32_16x16x32_bf16 v[104:107], v[64:67], v[24:27], v[104:107]
  ds_read_b64_tr_b16 v[44:45], v6 offset:128
  ds_read_b64_tr_b16 v[46:47], v6 offset:1408
  s_waitcnt lgkmcnt(8)
  v_mfma_f32_16x16x32_bf16 v[68:71], v[28:31], v[12:15], v[68:71]
  v_mfma_f32_16x16x32_bf16 v[72:75], v[28:31], v[16:19], v[72:75]
  ds_read_b128 v[20:23], v5 offset:0
  ds_read_b128 v[24:27], v5 offset:2048
  ds_read_b64_tr_b16 v[48:49], v6 offset:5120
  ds_read_b64_tr_b16 v[50:51], v6 offset:6400
  s_waitcnt lgkmcnt(10)
  v_mfma_f32_16x16x32_bf16 v[76:79], v[32:35], v[12:15], v[76:79]
  v_mfma_f32_16x16x32_bf16 v[80:83], v[32:35], v[16:19], v[80:83]
  ds_read_b64_tr_b16 v[52:53], v6 offset:5152
  ds_read_b64_tr_b16 v[54:55], v6 offset:6432
  s_waitcnt lgkmcnt(10)
  v_mfma_f32_16x16x32_bf16 v[84:87], v[36:39], v[12:15], v[84:87]
  v_mfma_f32_16x16x32_bf16 v[88:91], v[36:39], v[16:19], v[88:91]
  ds_read_b64_tr_b16 v[56:57], v6 offset:5184
  ds_read_b64_tr_b16 v[58:59], v6 offset:6464
  s_waitcnt lgkmcnt(10)
  v_mfma_f32_16x16x32_bf16 v[92:95], v[40:43], v[12:15], v[92:95]
  v_mfma_f32_16x16x32_bf16 v[96:99], v[40:43], v[16:19], v[96:99]
  ds_read_b64_tr_b16 v[60:61], v6 offset:5216
  ds_read_b64_tr_b16 v[62:63], v6 offset:6496
  s_waitcnt lgkmcnt(10)
  v_mfma_f32_16x16x32_bf16 v[100:103], v[44:47], v[12:15], v[100:103]
  v_mfma_f32_16x16x32_bf16 v[104:107], v[44:47], v[16:19], v[104:107]
  ds_read_b64_tr_b16 v[64:65], v6 offset:5248
  ds_read_b64_tr_b16 v[66:67], v6 offset:6528
  s_barrier
  s_waitcnt lgkmcnt(8)
  v_mfma_f32_16x16x32_bf16 v[68:71], v[48:51], v[20:23], v[68:71]
  v_mfma_f32_16x16x32_bf16 v[72:75], v[48:51], v[24:27], v[72:75]
  ds_read_b128 v[12:15], v4 offset:16384
  ds_read_b128 v[16:19], v4 offset:18432
  ds_read_b64_tr_b16 v[28:29], v6 offset:20480
  ds_read_b64_tr_b16 v[30:31], v6 offset:21760
  s_waitcnt lgkmcnt(10)
  v_mfma_f32_16x16x32_bf16 v[76:79], v[52:55], v[20:23], v[76:79]
  v_mfma_f32_16x16x32_bf16 v[80:83], v[52:55], v[24:27], v[80:83]
  ds_read_b64_tr_b16 v[32:33], v6 offset:20512
  ds_read_b64_tr_b16 v[34:35], v6 offset:21792
  s_waitcnt lgkmcnt(10)
  v_mfma_f32_16x16x32_bf16 v[84:87], v[56:59], v[20:23], v[84:87]
  v_mfma_f32_16x16x32_bf16 v[88:91], v[56:59], v[24:27], v[88:91]
  ds_read_b64_tr_b16 v[36:37], v6 offset:20544
  ds_read_b64_tr_b16 v[38:39], v6 offset:21824
  s_waitcnt lgkmcnt(10)
  v_mfma_f32_16x16x32_bf16 v[92:95], v[60:63], v[20:23], v[92:95]
  v_mfma_f32_16x16x32_bf16 v[96:99], v[60:63], v[24:27], v[96:99]
  ds_read_b64_tr_b16 v[40:41], v6 offset:20576
  ds_read_b64_tr_b16 v[42:43], v6 offset:21856
  s_waitcnt lgkmcnt(10)
  v_mfma_f32_16x16x32_bf16 v[100:103], v[64:67], v[20:23], v[100:103]
  v_mfma_f32_16x16x32_bf16 v[104:107], v[64:67], v[24:27], v[104:107]
  ds_read_b64_tr_b16 v[44:45], v6 offset:20608
  ds_read_b64_tr_b16 v[46:47], v6 offset:21888
  s_waitcnt lgkmcnt(8)
  v_mfma_f32_16x16x32_bf16 v[68:71], v[28:31], v[12:15], v[68:71]
  v_mfma_f32_16x16x32_bf16 v[72:75], v[28:31], v[16:19], v[72:75]
  ds_read_b128 v[20:23], v5 offset:16384
  ds_read_b128 v[24:27], v5 offset:18432
  ds_read_b64_tr_b16 v[48:49], v6 offset:25600
  ds_read_b64_tr_b16 v[50:51], v6 offset:26880
  s_waitcnt lgkmcnt(10)
  v_mfma_f32_16x16x32_bf16 v[76:79], v[32:35], v[12:15], v[76:79]
  v_mfma_f32_16x16x32_bf16 v[80:83], v[32:35], v[16:19], v[80:83]
  ds_read_b64_tr_b16 v[52:53], v6 offset:25632
  ds_read_b64_tr_b16 v[54:55], v6 offset:26912
  s_waitcnt lgkmcnt(10)
  v_mfma_f32_16x16x32_bf16 v[84:87], v[36:39], v[12:15], v[84:87]
  v_mfma_f32_16x16x32_bf16 v[88:91], v[36:39], v[16:19], v[88:91]
  ds_read_b64_tr_b16 v[56:57], v6 offset:25664
  ds_read_b64_tr_b16 v[58:59], v6 offset:26944
  s_waitcnt lgkmcnt(10)
  v_mfma_f32_16x16x32_bf16 v[92:95], v[40:43], v[12:15], v[92:95]
  v_mfma_f32_16x16x32_bf16 v[96:99], v[40:43], v[16:19], v[96:99]
  ds_read_b64_tr_b16 v[60:61], v6 offset:25696
  ds_read_b64_tr_b16 v[62:63], v6 offset:26976
  s_waitcnt lgkmcnt(10)
  v_mfma_f32_16x16x32_bf16 v[100:103], v[44:47], v[12:15], v[100:103]
  v_mfma_f32_16x16x32_bf16 v[104:107], v[44:47], v[16:19], v[104:107]
  ds_read_b64_tr_b16 v[64:65], v6 offset:25728
  ds_read_b64_tr_b16 v[66:67], v6 offset:27008
  s_barrier
  s_waitcnt lgkmcnt(8)
  v_mfma_f32_16x16x32_bf16 v[68:71], v[48:51], v[20:23], v[68:71]
  v_mfma_f32_16x16x32_bf16 v[72:75], v[48:51], v[24:27], v[72:75]
  ds_read_b128 v[12:15], v4 offset:32768
  ds_read_b128 v[16:19], v4 offset:34816
  ds_read_b64_tr_b16 v[28:29], v7 offset:0
  ds_read_b64_tr_b16 v[30:31], v7 offset:1280
  s_waitcnt lgkmcnt(10)
  v_mfma_f32_16x16x32_bf16 v[76:79], v[52:55], v[20:23], v[76:79]
  v_mfma_f32_16x16x32_bf16 v[80:83], v[52:55], v[24:27], v[80:83]
  ds_read_b64_tr_b16 v[32:33], v7 offset:32
  ds_read_b64_tr_b16 v[34:35], v7 offset:1312
  s_waitcnt lgkmcnt(10)
  v_mfma_f32_16x16x32_bf16 v[84:87], v[56:59], v[20:23], v[84:87]
  v_mfma_f32_16x16x32_bf16 v[88:91], v[56:59], v[24:27], v[88:91]
  ds_read_b64_tr_b16 v[36:37], v7 offset:64
  ds_read_b64_tr_b16 v[38:39], v7 offset:1344
  s_waitcnt lgkmcnt(10)
  v_mfma_f32_16x16x32_bf16 v[92:95], v[60:63], v[20:23], v[92:95]
  v_mfma_f32_16x16x32_bf16 v[96:99], v[60:63], v[24:27], v[96:99]
  ds_read_b64_tr_b16 v[40:41], v7 offset:96
  ds_read_b64_tr_b16 v[42:43], v7 offset:1376
  s_waitcnt lgkmcnt(10)
  v_mfma_f32_16x16x32_bf16 v[100:103], v[64:67], v[20:23], v[100:103]
  v_mfma_f32_16x16x32_bf16 v[104:107], v[64:67], v[24:27], v[104:107]
  ds_read_b64_tr_b16 v[44:45], v7 offset:128
  ds_read_b64_tr_b16 v[46:47], v7 offset:1408
  s_waitcnt lgkmcnt(8)
  v_mfma_f32_16x16x32_bf16 v[68:71], v[28:31], v[12:15], v[68:71]
  v_mfma_f32_16x16x32_bf16 v[72:75], v[28:31], v[16:19], v[72:75]
  ds_read_b128 v[20:23], v5 offset:32768
  ds_read_b128 v[24:27], v5 offset:34816
  ds_read_b64_tr_b16 v[48:49], v7 offset:5120
  ds_read_b64_tr_b16 v[50:51], v7 offset:6400
  s_waitcnt lgkmcnt(10)
  v_mfma_f32_16x16x32_bf16 v[76:79], v[32:35], v[12:15], v[76:79]
  v_mfma_f32_16x16x32_bf16 v[80:83], v[32:35], v[16:19], v[80:83]
  ds_read_b64_tr_b16 v[52:53], v7 offset:5152
  ds_read_b64_tr_b16 v[54:55], v7 offset:6432
  s_waitcnt lgkmcnt(10)
  v_mfma_f32_16x16x32_bf16 v[84:87], v[36:39], v[12:15], v[84:87]
  v_mfma_f32_16x16x32_bf16 v[88:91], v[36:39], v[16:19], v[88:91]
  ds_read_b64_tr_b16 v[56:57], v7 offset:5184
  ds_read_b64_tr_b16 v[58:59], v7 offset:6464
  s_waitcnt lgkmcnt(10)
  v_mfma_f32_16x16x32_bf16 v[92:95], v[40:43], v[12:15], v[92:95]
  v_mfma_f32_16x16x32_bf16 v[96:99], v[40:43], v[16:19], v[96:99]
  ds_read_b64_tr_b16 v[60:61], v7 offset:5216
  ds_read_b64_tr_b16 v[62:63], v7 offset:6496
  s_waitcnt lgkmcnt(10)
  v_mfma_f32_16x16x32_bf16 v[100:103], v[44:47], v[12:15], v[100:103]
  v_mfma_f32_16x16x32_bf16 v[104:107], v[44:47], v[16:19], v[104:107]
  ds_read_b64_tr_b16 v[64:65], v7 offset:5248
  ds_read_b64_tr_b16 v[66:67], v7 offset:6528
  s_barrier
  s_waitcnt lgkmcnt(8)
  v_mfma_f32_16x16x32_bf16 v[68:71], v[48:51], v[20:23], v[68:71]
  v_mfma_f32_16x16x32_bf16 v[72:75], v[48:51], v[24:27], v[72:75]
  ds_read_b128 v[12:15], v4 offset:49152
  ds_read_b128 v[16:19], v4 offset:51200
  ds_read_b64_tr_b16 v[28:29], v7 offset:20480
  ds_read_b64_tr_b16 v[30:31], v7 offset:21760
  s_waitcnt lgkmcnt(10)
  v_mfma_f32_16x16x32_bf16 v[76:79], v[52:55], v[20:23], v[76:79]
  v_mfma_f32_16x16x32_bf16 v[80:83], v[52:55], v[24:27], v[80:83]
  ds_read_b64_tr_b16 v[32:33], v7 offset:20512
  ds_read_b64_tr_b16 v[34:35], v7 offset:21792
  s_waitcnt lgkmcnt(10)
  v_mfma_f32_16x16x32_bf16 v[84:87], v[56:59], v[20:23], v[84:87]
  v_mfma_f32_16x16x32_bf16 v[88:91], v[56:59], v[24:27], v[88:91]
  ds_read_b64_tr_b16 v[36:37], v7 offset:20544
  ds_read_b64_tr_b16 v[38:39], v7 offset:21824
  s_waitcnt lgkmcnt(10)
  v_mfma_f32_16x16x32_bf16 v[92:95], v[60:63], v[20:23], v[92:95]
  v_mfma_f32_16x16x32_bf16 v[96:99], v[60:63], v[24:27], v[96:99]
  ds_read_b64_tr_b16 v[40:41], v7 offset:20576
  ds_read_b64_tr_b16 v[42:43], v7 offset:21856
  s_waitcnt lgkmcnt(10)
  v_mfma_f32_16x16x32_bf16 v[100:103], v[64:67], v[20:23], v[100:103]
  v_mfma_f32_16x16x32_bf16 v[104:107], v[64:67], v[24:27], v[104:107]
  ds_read_b64_tr_b16 v[44:45], v7 offset:20608
  ds_read_b64_tr_b16 v[46:47], v7 offset:21888
  s_waitcnt lgkmcnt(8)
  v_mfma_f32_16x16x32_bf16 v[68:71], v[28:31], v[12:15], v[68:71]
  v_mfma_f32_16x16x32_bf16 v[72:75], v[28:31], v[16:19], v[72:75]
  ds_read_b128 v[20:23], v5 offset:49152
  ds_read_b128 v[24:27], v5 offset:51200
  ds_read_b64_tr_b16 v[48:49], v7 offset:25600
  ds_read_b64_tr_b16 v[50:51], v7 offset:26880
  s_waitcnt lgkmcnt(10)
  v_mfma_f32_16x16x32_bf16 v[76:79], v[32:35], v[12:15], v[76:79]
  v_mfma_f32_16x16x32_bf16 v[80:83], v[32:35], v[16:19], v[80:83]
  ds_read_b64_tr_b16 v[52:53], v7 offset:25632
  ds_read_b64_tr_b16 v[54:55], v7 offset:26912
  s_waitcnt lgkmcnt(10)
  v_mfma_f32_16x16x32_bf16 v[84:87], v[36:39], v[12:15], v[84:87]
  v_mfma_f32_16x16x32_bf16 v[88:91], v[36:39], v[16:19], v[88:91]
  ds_read_b64_tr_b16 v[56:57], v7 offset:25664
  ds_read_b64_tr_b16 v[58:59], v7 offset:26944
  s_waitcnt lgkmcnt(10)
  v_mfma_f32_16x16x32_bf16 v[92:95], v[40:43], v[12:15], v[92:95]
  v_mfma_f32_16x16x32_bf16 v[96:99], v[40:43], v[16:19], v[96:99]
  ds_read_b64_tr_b16 v[60:61], v7 offset:25696
  ds_read_b64_tr_b16 v[62:63], v7 offset:26976
  s_waitcnt lgkmcnt(10)
  v_mfma_f32_16x16x32_bf16 v[100:103], v[44:47], v[12:15], v[100:103]
  v_mfma_f32_16x16x32_bf16 v[104:107], v[44:47], v[16:19], v[104:107]
  ds_read_b64_tr_b16 v[64:65], v7 offset:25728
  ds_read_b64_tr_b16 v[66:67], v7 offset:27008
  s_barrier
  s_waitcnt lgkmcnt(8)
  v_mfma_f32_16x16x32_bf16 v[68:71], v[48:51], v[20:23], v[68:71]
  v_mfma_f32_16x16x32_bf16 v[72:75], v[48:51], v[24:27], v[72:75]
  ds_read_b128 v[12:15], v4 offset:0
  ds_read_b128 v[16:19], v4 offset:2048
  ds_read_b64_tr_b16 v[28:29], v6 offset:0
  ds_read_b64_tr_b16 v[30:31], v6 offset:1280
  s_waitcnt lgkmcnt(10)
  v_mfma_f32_16x16x32_bf16 v[76:79], v[52:55], v[20:23], v[76:79]
  v_mfma_f32_16x16x32_bf16 v[80:83], v[52:55], v[24:27], v[80:83]
  ds_read_b64_tr_b16 v[32:33], v6 offset:32
  ds_read_b64_tr_b16 v[34:35], v6 offset:1312
  s_waitcnt lgkmcnt(10)
  v_mfma_f32_16x16x32_bf16 v[84:87], v[56:59], v[20:23], v[84:87]
  v_mfma_f32_16x16x32_bf16 v[88:91], v[56:59], v[24:27], v[88:91]
  ds_read_b64_tr_b16 v[36:37], v6 offset:64
  ds_read_b64_tr_b16 v[38:39], v6 offset:1344
  s_waitcnt lgkmcnt(10)
  v_mfma_f32_16x16x32_bf16 v[92:95], v[60:63], v[20:23], v[92:95]
  v_mfma_f32_16x16x32_bf16 v[96:99], v[60:63], v[24:27], v[96:99]
  ds_read_b64_tr_b16 v[40:41], v6 offset:96
  ds_read_b64_tr_b16 v[42:43], v6 offset:1376
  s_waitcnt lgkmcnt(10)
  v_mfma_f32_16x16x32_bf16 v[100:103], v[64:67], v[20:23], v[100:103]
  v_mfma_f32_16x16x32_bf16 v[104:107], v[64:67], v[24:27], v[104:107]
  ds_read_b64_tr_b16 v[44:45], v6 offset:128
  ds_read_b64_tr_b16 v[46:47], v6 offset:1408
  s_waitcnt lgkmcnt(8)
  v_mfma_f32_16x16x32_bf16 v[68:71], v[28:31], v[12:15], v[68:71]
  v_mfma_f32_16x16x32_bf16 v[72:75], v[28:31], v[16:19], v[72:75]
  ds_read_b128 v[20:23], v5 offset:0
  ds_read_b128 v[24:27], v5 offset:2048
  ds_read_b64_tr_b16 v[48:49], v6 offset:5120
  ds_read_b64_tr_b16 v[50:51], v6 offset:6400
  s_waitcnt lgkmcnt(10)
  v_mfma_f32_16x16x32_bf16 v[76:79], v[32:35], v[12:15], v[76:79]
  v_mfma_f32_16x16x32_bf16 v[80:83], v[32:35], v[16:19], v[80:83]
  ds_read_b64_tr_b16 v[52:53], v6 offset:5152
  ds_read_b64_tr_b16 v[54:55], v6 offset:6432
  s_waitcnt lgkmcnt(10)
  v_mfma_f32_16x16x32_bf16 v[84:87], v[36:39], v[12:15], v[84:87]
  v_mfma_f32_16x16x32_bf16 v[88:91], v[36:39], v[16:19], v[88:91]
  ds_read_b64_tr_b16 v[56:57], v6 offset:5184
  ds_read_b64_tr_b16 v[58:59], v6 offset:6464
  s_waitcnt lgkmcnt(10)
  v_mfma_f32_16x16x32_bf16 v[92:95], v[40:43], v[12:15], v[92:95]
  v_mfma_f32_16x16x32_bf16 v[96:99], v[40:43], v[16:19], v[96:99]
  ds_read_b64_tr_b16 v[60:61], v6 offset:5216
  ds_read_b64_tr_b16 v[62:63], v6 offset:6496
  s_waitcnt lgkmcnt(10)
  v_mfma_f32_16x16x32_bf16 v[100:103], v[44:47], v[12:15], v[100:103]
  v_mfma_f32_16x16x32_bf16 v[104:107], v[44:47], v[16:19], v[104:107]
  ds_read_b64_tr_b16 v[64:65], v6 offset:5248
  ds_read_b64_tr_b16 v[66:67], v6 offset:6528
  s_barrier
  s_waitcnt lgkmcnt(8)
  v_mfma_f32_16x16x32_bf16 v[68:71], v[48:51], v[20:23], v[68:71]
  v_mfma_f32_16x16x32_bf16 v[72:75], v[48:51], v[24:27], v[72:75]
  ds_read_b128 v[12:15], v4 offset:16384
  ds_read_b128 v[16:19], v4 offset:18432
  ds_read_b64_tr_b16 v[28:29], v6 offset:20480
  ds_read_b64_tr_b16 v[30:31], v6 offset:21760
  s_waitcnt lgkmcnt(10)
  v_mfma_f32_16x16x32_bf16 v[76:79], v[52:55], v[20:23], v[76:79]
  v_mfma_f32_16x16x32_bf16 v[80:83], v[52:55], v[24:27], v[80:83]
  ds_read_b64_tr_b16 v[32:33], v6 offset:20512
  ds_read_b64_tr_b16 v[34:35], v6 offset:21792
  s_waitcnt lgkmcnt(10)
  v_mfma_f32_16x16x32_bf16 v[84:87], v[56:59], v[20:23], v[84:87]
  v_mfma_f32_16x16x32_bf16 v[88:91], v[56:59], v[24:27], v[88:91]
  ds_read_b64_tr_b16 v[36:37], v6 offset:20544
  ds_read_b64_tr_b16 v[38:39], v6 offset:21824
  s_waitcnt lgkmcnt(10)
  v_mfma_f32_16x16x32_bf16 v[92:95], v[60:63], v[20:23], v[92:95]
  v_mfma_f32_16x16x32_bf16 v[96:99], v[60:63], v[24:27], v[96:99]
  ds_read_b64_tr_b16 v[40:41], v6 offset:20576
  ds_read_b64_tr_b16 v[42:43], v6 offset:21856
  s_waitcnt lgkmcnt(10)
  v_mfma_f32_16x16x32_bf16 v[100:103], v[64:67], v[20:23], v[100:103]
  v_mfma_f32_16x16x32_bf16 v[104:107], v[64:67], v[24:27], v[104:107]
  ds_read_b64_tr_b16 v[44:45], v6 offset:20608
  ds_read_b64_tr_b16 v[46:47], v6 offset:21888
  s_waitcnt lgkmcnt(8)
  v_mfma_f32_16x16x32_bf16 v[68:71], v[28:31], v[12:15], v[68:71]
  v_mfma_f32_16x16x32_bf16 v[72:75], v[28:31], v[16:19], v[72:75]
  ds_read_b128 v[20:23], v5 offset:16384
  ds_read_b128 v[24:27], v5 offset:18432
  ds_read_b64_tr_b16 v[48:49], v6 offset:25600
  ds_read_b64_tr_b16 v[50:51], v6 offset:26880
  s_waitcnt lgkmcnt(10)
  v_mfma_f32_16x16x32_bf16 v[76:79], v[32:35], v[12:15], v[76:79]
  v_mfma_f32_16x16x32_bf16 v[80:83], v[32:35], v[16:19], v[80:83]
  ds_read_b64_tr_b16 v[52:53], v6 offset:25632
  ds_read_b64_tr_b16 v[54:55], v6 offset:26912
  s_waitcnt lgkmcnt(10)
  v_mfma_f32_16x16x32_bf16 v[84:87], v[36:39], v[12:15], v[84:87]
  v_mfma_f32_16x16x32_bf16 v[88:91], v[36:39], v[16:19], v[88:91]
  ds_read_b64_tr_b16 v[56:57], v6 offset:25664
  ds_read_b64_tr_b16 v[58:59], v6 offset:26944
  s_waitcnt lgkmcnt(10)
  v_mfma_f32_16x16x32_bf16 v[92:95], v[40:43], v[12:15], v[92:95]
  v_mfma_f32_16x16x32_bf16 v[96:99], v[40:43], v[16:19], v[96:99]
  ds_read_b64_tr_b16 v[60:61], v6 offset:25696
  ds_read_b64_tr_b16 v[62:63], v6 offset:26976
  s_waitcnt lgkmcnt(10)
  v_mfma_f32_16x16x32_bf16 v[100:103], v[44:47], v[12:15], v[100:103]
  v_mfma_f32_16x16x32_bf16 v[104:107], v[44:47], v[16:19], v[104:107]
  ds_read_b64_tr_b16 v[64:65], v6 offset:25728
  ds_read_b64_tr_b16 v[66:67], v6 offset:27008
  s_barrier
  s_waitcnt lgkmcnt(8)
  v_mfma_f32_16x16x32_bf16 v[68:71], v[48:51], v[20:23], v[68:71]
  v_mfma_f32_16x16x32_bf16 v[72:75], v[48:51], v[24:27], v[72:75]
  ds_read_b128 v[12:15], v4 offset:32768
  ds_read_b128 v[16:19], v4 offset:34816
  ds_read_b64_tr_b16 v[28:29], v7 offset:0
  ds_read_b64_tr_b16 v[30:31], v7 offset:1280
  s_waitcnt lgkmcnt(10)
  v_mfma_f32_16x16x32_bf16 v[76:79], v[52:55], v[20:23], v[76:79]
  v_mfma_f32_16x16x32_bf16 v[80:83], v[52:55], v[24:27], v[80:83]
  ds_read_b64_tr_b16 v[32:33], v7 offset:32
  ds_read_b64_tr_b16 v[34:35], v7 offset:1312
  s_waitcnt lgkmcnt(10)
  v_mfma_f32_16x16x32_bf16 v[84:87], v[56:59], v[20:23], v[84:87]
  v_mfma_f32_16x16x32_bf16 v[88:91], v[56:59], v[24:27], v[88:91]
  ds_read_b64_tr_b16 v[36:37], v7 offset:64
  ds_read_b64_tr_b16 v[38:39], v7 offset:1344
  s_waitcnt lgkmcnt(10)
  v_mfma_f32_16x16x32_bf16 v[92:95], v[60:63], v[20:23], v[92:95]
  v_mfma_f32_16x16x32_bf16 v[96:99], v[60:63], v[24:27], v[96:99]
  ds_read_b64_tr_b16 v[40:41], v7 offset:96
  ds_read_b64_tr_b16 v[42:43], v7 offset:1376
  s_waitcnt lgkmcnt(10)
  v_mfma_f32_16x16x32_bf16 v[100:103], v[64:67], v[20:23], v[100:103]
  v_mfma_f32_16x16x32_bf16 v[104:107], v[64:67], v[24:27], v[104:107]
  ds_read_b64_tr_b16 v[44:45], v7 offset:128
  ds_read_b64_tr_b16 v[46:47], v7 offset:1408
  s_waitcnt lgkmcnt(8)
  v_mfma_f32_16x16x32_bf16 v[68:71], v[28:31], v[12:15], v[68:71]
  v_mfma_f32_16x16x32_bf16 v[72:75], v[28:31], v[16:19], v[72:75]
  ds_read_b128 v[20:23], v5 offset:32768
  ds_read_b128 v[24:27], v5 offset:34816
  ds_read_b64_tr_b16 v[48:49], v7 offset:5120
  ds_read_b64_tr_b16 v[50:51], v7 offset:6400
  s_waitcnt lgkmcnt(10)
  v_mfma_f32_16x16x32_bf16 v[76:79], v[32:35], v[12:15], v[76:79]
  v_mfma_f32_16x16x32_bf16 v[80:83], v[32:35], v[16:19], v[80:83]
  ds_read_b64_tr_b16 v[52:53], v7 offset:5152
  ds_read_b64_tr_b16 v[54:55], v7 offset:6432
  s_waitcnt lgkmcnt(10)
  v_mfma_f32_16x16x32_bf16 v[84:87], v[36:39], v[12:15], v[84:87]
  v_mfma_f32_16x16x32_bf16 v[88:91], v[36:39], v[16:19], v[88:91]
  ds_read_b64_tr_b16 v[56:57], v7 offset:5184
  ds_read_b64_tr_b16 v[58:59], v7 offset:6464
  s_waitcnt lgkmcnt(10)
  v_mfma_f32_16x16x32_bf16 v[92:95], v[40:43], v[12:15], v[92:95]
  v_mfma_f32_16x16x32_bf16 v[96:99], v[40:43], v[16:19], v[96:99]
  ds_read_b64_tr_b16 v[60:61], v7 offset:5216
  ds_read_b64_tr_b16 v[62:63], v7 offset:6496
  s_waitcnt lgkmcnt(10)
  v_mfma_f32_16x16x32_bf16 v[100:103], v[44:47], v[12:15], v[100:103]
  v_mfma_f32_16x16x32_bf16 v[104:107], v[44:47], v[16:19], v[104:107]
  ds_read_b64_tr_b16 v[64:65], v7 offset:5248
  ds_read_b64_tr_b16 v[66:67], v7 offset:6528
  s_barrier
  s_waitcnt lgkmcnt(8)
  v_mfma_f32_16x16x32_bf16 v[68:71], v[48:51], v[20:23], v[68:71]
  v_mfma_f32_16x16x32_bf16 v[72:75], v[48:51], v[24:27], v[72:75]
  ds_read_b128 v[12:15], v4 offset:49152
  ds_read_b128 v[16:19], v4 offset:51200
  ds_read_b64_tr_b16 v[28:29], v7 offset:20480
  ds_read_b64_tr_b16 v[30:31], v7 offset:21760
  s_waitcnt lgkmcnt(10)
  v_mfma_f32_16x16x32_bf16 v[76:79], v[52:55], v[20:23], v[76:79]
  v_mfma_f32_16x16x32_bf16 v[80:83], v[52:55], v[24:27], v[80:83]
  ds_read_b64_tr_b16 v[32:33], v7 offset:20512
  ds_read_b64_tr_b16 v[34:35], v7 offset:21792
  s_waitcnt lgkmcnt(10)
  v_mfma_f32_16x16x32_bf16 v[84:87], v[56:59], v[20:23], v[84:87]
  v_mfma_f32_16x16x32_bf16 v[88:91], v[56:59], v[24:27], v[88:91]
  ds_read_b64_tr_b16 v[36:37], v7 offset:20544
  ds_read_b64_tr_b16 v[38:39], v7 offset:21824
  s_waitcnt lgkmcnt(10)
  v_mfma_f32_16x16x32_bf16 v[92:95], v[60:63], v[20:23], v[92:95]
  v_mfma_f32_16x16x32_bf16 v[96:99], v[60:63], v[24:27], v[96:99]
  ds_read_b64_tr_b16 v[40:41], v7 offset:20576
  ds_read_b64_tr_b16 v[42:43], v7 offset:21856
  s_waitcnt lgkmcnt(10)
  v_mfma_f32_16x16x32_bf16 v[100:103], v[64:67], v[20:23], v[100:103]
  v_mfma_f32_16x16x32_bf16 v[104:107], v[64:67], v[24:27], v[104:107]
  ds_read_b64_tr_b16 v[44:45], v7 offset:20608
  ds_read_b64_tr_b16 v[46:47], v7 offset:21888
  s_waitcnt lgkmcnt(8)
  v_mfma_f32_16x16x32_bf16 v[68:71], v[28:31], v[12:15], v[68:71]
  v_mfma_f32_16x16x32_bf16 v[72:75], v[28:31], v[16:19], v[72:75]
  ds_read_b128 v[20:23], v5 offset:49152
  ds_read_b128 v[24:27], v5 offset:51200
  ds_read_b64_tr_b16 v[48:49], v7 offset:25600
  ds_read_b64_tr_b16 v[50:51], v7 offset:26880
  s_waitcnt lgkmcnt(10)
  v_mfma_f32_16x16x32_bf16 v[76:79], v[32:35], v[12:15], v[76:79]
  v_mfma_f32_16x16x32_bf16 v[80:83], v[32:35], v[16:19], v[80:83]
  ds_read_b64_tr_b16 v[52:53], v7 offset:25632
  ds_read_b64_tr_b16 v[54:55], v7 offset:26912
  s_waitcnt lgkmcnt(10)
  v_mfma_f32_16x16x32_bf16 v[84:87], v[36:39], v[12:15], v[84:87]
  v_mfma_f32_16x16x32_bf16 v[88:91], v[36:39], v[16:19], v[88:91]
  ds_read_b64_tr_b16 v[56:57], v7 offset:25664
  ds_read_b64_tr_b16 v[58:59], v7 offset:26944
  s_waitcnt lgkmcnt(10)
  v_mfma_f32_16x16x32_bf16 v[92:95], v[40:43], v[12:15], v[92:95]
  v_mfma_f32_16x16x32_bf16 v[96:99], v[40:43], v[16:19], v[96:99]
  ds_read_b64_tr_b16 v[60:61], v7 offset:25696
  ds_read_b64_tr_b16 v[62:63], v7 offset:26976
  s_waitcnt lgkmcnt(10)
  v_mfma_f32_16x16x32_bf16 v[100:103], v[44:47], v[12:15], v[100:103]
  v_mfma_f32_16x16x32_bf16 v[104:107], v[44:47], v[16:19], v[104:107]
  ds_read_b64_tr_b16 v[64:65], v7 offset:25728
  ds_read_b64_tr_b16 v[66:67], v7 offset:27008
  s_waitcnt lgkmcnt(8)
  v_mfma_f32_16x16x32_bf16 v[68:71], v[48:51], v[20:23], v[68:71]
  v_mfma_f32_16x16x32_bf16 v[72:75], v[48:51], v[24:27], v[72:75]
  s_waitcnt lgkmcnt(6)
  v_mfma_f32_16x16x32_bf16 v[76:79], v[52:55], v[20:23], v[76:79]
  v_mfma_f32_16x16x32_bf16 v[80:83], v[52:55], v[24:27], v[80:83]
  s_waitcnt lgkmcnt(4)
  v_mfma_f32_16x16x32_bf16 v[84:87], v[56:59], v[20:23], v[84:87]
  v_mfma_f32_16x16x32_bf16 v[88:91], v[56:59], v[24:27], v[88:91]
  s_waitcnt lgkmcnt(2)
  v_mfma_f32_16x16x32_bf16 v[92:95], v[60:63], v[20:23], v[92:95]
  v_mfma_f32_16x16x32_bf16 v[96:99], v[60:63], v[24:27], v[96:99]
  s_waitcnt lgkmcnt(0)
  v_mfma_f32_16x16x32_bf16 v[100:103], v[64:67], v[20:23], v[100:103]
  v_mfma_f32_16x16x32_bf16 v[104:107], v[64:67], v[24:27], v[104:107]
  s_cmp_eq_u32 s29, 0
  s_cbranch_scc1 P6C_KH0
  ds_write_b128 v151, v[68:71] offset:0
  ds_write_b128 v151, v[76:79] offset:1024
  ds_write_b128 v151, v[84:87] offset:2048
  ds_write_b128 v151, v[92:95] offset:3072
  s_nop 0
  ds_write_b128 v151, v[100:103] offset:4096
  v_pk_mov_b32 v[68:69], v[72:73], v[72:73] op_sel:[0,1]
  v_pk_mov_b32 v[70:71], v[74:75], v[74:75] op_sel:[0,1]
  v_pk_mov_b32 v[76:77], v[80:81], v[80:81] op_sel:[0,1]
  v_pk_mov_b32 v[78:79], v[82:83], v[82:83] op_sel:[0,1]
  v_pk_mov_b32 v[84:85], v[88:89], v[88:89] op_sel:[0,1]
  v_pk_mov_b32 v[86:87], v[90:91], v[90:91] op_sel:[0,1]
  v_pk_mov_b32 v[92:93], v[96:97], v[96:97] op_sel:[0,1]
  v_pk_mov_b32 v[94:95], v[98:99], v[98:99] op_sel:[0,1]
  v_pk_mov_b32 v[100:101], v[104:105], v[104:105] op_sel:[0,1]
  v_pk_mov_b32 v[102:103], v[106:107], v[106:107] op_sel:[0,1]
  s_branch P6C_JOIN
P6C_KH0:
  ds_write_b128 v151, v[72:75] offset:0
  ds_write_b128 v151, v[80:83] offset:1024
  ds_write_b128 v151, v[88:91] offset:2048
  ds_write_b128 v151, v[96:99] offset:3072
  s_nop 1
  ds_write_b128 v151, v[104:107] offset:4096
P6C_JOIN:
  ds_read_b64 v[108:109], v153 offset:0
  ds_read_b128 v[120:123], v154 offset:0
  ds_read_b64 v[110:111], v153 offset:32
  ds_read_b128 v[124:127], v154 offset:64
  ds_read_b64 v[112:113], v153 offset:64
  ds_read_b128 v[128:131], v154 offset:128
  ds_read_b64 v[114:115], v153 offset:96
  ds_read_b128 v[132:135], v154 offset:192
  ds_read_b64 v[116:117], v153 offset:128
  ds_read_b128 v[136:139], v154 offset:256
  s_waitcnt lgkmcnt(10)
  s_barrier
  ds_read_b128 v[28:31], v152 offset:0
  ds_read_b128 v[32:35], v152 offset:1024
  ds_read_b128 v[36:39], v152 offset:2048
  ds_read_b128 v[40:43], v152 offset:3072
  ds_read_b128 v[44:47], v152 offset:4096
  s_waitcnt lgkmcnt(4)
  v_pk_add_f32 v[68:69], v[68:69], v[28:29]
  v_pk_add_f32 v[70:71], v[70:71], v[30:31]
  v_lshlrev_b32 v22, 16, v108
  v_and_b32 v23, 0xffff0000, v108
  v_lshlrev_b32 v24, 16, v109
  v_and_b32 v25, 0xffff0000, v109
  v_pk_fma_f32 v[22:23], v[68:69], v[120:121], v[22:23]
  v_pk_fma_f32 v[24:25], v[70:71], v[122:123], v[24:25]
  v_cvt_pk_bf16_f32 v12, v22, v23
  v_cvt_pk_bf16_f32 v13, v24, v25
  ds_write_b64 v147, v[12:13] offset:0
  s_waitcnt lgkmcnt(4)
  v_pk_add_f32 v[76:77], v[76:77], v[32:33]
  v_pk_add_f32 v[78:79], v[78:79], v[34:35]
  v_lshlrev_b32 v22, 16, v110
  v_and_b32 v23, 0xffff0000, v110
  v_lshlrev_b32 v24, 16, v111
  v_and_b32 v25, 0xffff0000, v111
  v_pk_fma_f32 v[22:23], v[76:77], v[124:125], v[22:23]
  v_pk_fma_f32 v[24:25], v[78:79], v[126:127], v[24:25]
  v_cvt_pk_bf16_f32 v14, v22, v23
  v_cvt_pk_bf16_f32 v15, v24, v25
  ds_write_b64 v147, v[14:15] offset:32
  s_waitcnt lgkmcnt(4)
  v_pk_add_f32 v[84:85], v[84:85], v[36:37]
  v_pk_add_f32 v[86:87], v[86:87], v[38:39]
  v_lshlrev_b32 v22, 16, v112
  v_and_b32 v23, 0xffff0000, v112
  v_lshlrev_b32 v24, 16, v113
  v_and_b32 v25, 0xffff0000, v113
  v_pk_fma_f32 v[22:23], v[84:85], v[128:129], v[22:23]
  v_pk_fma_f32 v[24:25], v[86:87], v[130:131], v[24:25]
  v_cvt_pk_bf16_f32 v16, v22, v23
  v_cvt_pk_bf16_f32 v17, v24, v25
  ds_write_b64 v147, v[16:17] offset:64
  s_waitcnt lgkmcnt(4)
  v_pk_add_f32 v[92:93], v[92:93], v[40:41]
  v_pk_add_f32 v[94:95], v[94:95], v[42:43]
  v_lshlrev_b32 v22, 16, v114
  v_and_b32 v23, 0xffff0000, v114
  v_lshlrev_b32 v24, 16, v115
  v_and_b32 v25, 0xffff0000, v115
  v_pk_fma_f32 v[22:23], v[92:93], v[132:133], v[22:23]
  v_pk_fma_f32 v[24:25], v[94:95], v[134:135], v[24:25]
  v_cvt_pk_bf16_f32 v18, v22, v23
  v_cvt_pk_bf16_f32 v19, v24, v25
  ds_write_b64 v147, v[18:19] offset:96
  s_waitcnt lgkmcnt(4)
  v_pk_add_f32 v[100:101], v[100:101], v[44:45]
  v_pk_add_f32 v[102:103], v[102:103], v[46:47]
  v_lshlrev_b32 v22, 16, v116
  v_and_b32 v23, 0xffff0000, v116
  v_lshlrev_b32 v24, 16, v117
  v_and_b32 v25, 0xffff0000, v117
  v_pk_fma_f32 v[22:23], v[100:101], v[136:137], v[22:23]
  v_pk_fma_f32 v[24:25], v[102:103], v[138:139], v[24:25]
  v_cvt_pk_bf16_f32 v20, v22, v23
  v_cvt_pk_bf16_f32 v21, v24, v25
  ds_write_b64 v147, v[20:21] offset:128
  s_waitcnt lgkmcnt(0)
  ds_read_b128 v[28:31], v144
  ds_read_b128 v[32:35], v145
  ds_read_b128 v[36:39], v146
  s_waitcnt lgkmcnt(2)
  buffer_store_dwordx4 v[28:31], v148, s[32:35], 0 offen
  s_waitcnt lgkmcnt(1)
  buffer_store_dwordx4 v[32:35], v149, s[32:35], 0 offen
  s_waitcnt lgkmcnt(0)
  buffer_store_dwordx4 v[36:39], v150, s[32:35], 0 offen
F_END:
  s_endpgm
.section .rodata,"a"
.p2align 6
.amdhsa_kernel adaLN_cond__mha_block__geglu_ffn__prompt_kernel
  .amdhsa_next_free_vgpr 232
  .amdhsa_next_free_sgpr 102
  .amdhsa_accum_offset 232
  .amdhsa_group_segment_fixed_size 0
  .amdhsa_kernarg_size 96
  .amdhsa_user_sgpr_count 2
  .amdhsa_user_sgpr_kernarg_segment_ptr 1
  .amdhsa_system_sgpr_workgroup_id_x 1
  .amdhsa_float_denorm_mode_32 3
.end_amdhsa_kernel
.text
```
